```python
import torch

def _softmax(x, axis=-1):
    return torch.softmax(x, dim=axis)
def _gelu(x):
    return torch.nn.functional.gelu(x, approximate="tanh")
def _silu(x):
    return torch.nn.functional.silu(x)
def _sigmoid(x):
    return torch.sigmoid(x)
def _layernorm(x, axis=-1, eps=1e-5):
    m = x.mean(dim=axis, keepdim=True)
    v = x.var(dim=axis, keepdim=True, unbiased=False)
    return (x - m) / torch.sqrt(v + eps)
def _scatter_add(tgt, idx, src, axis=0):
    return tgt.clone().index_add_(axis, idx, src)
def _segment_sum(src, seg, n):
    out = torch.zeros((n,) + src.shape[1:], dtype=src.dtype)
    return out.index_add_(0, seg, src)
def _pad(x, pw):
    flat = tuple(v for pair in reversed(pw) for v in pair)
    return torch.nn.functional.pad(x, flat)

kernel_name = 'gated_mix__mha_block__glu_gated_geglu__prompt'

def setup_inputs():

    _w = (lambda a: (lambda t: t.to(torch.bfloat16) if t.is_floating_point() else t)(torch.as_tensor(a)))
    def _A_setup():
        B, S, D, H = 1, 2048, 512, 32
        return {
            "x": _w((lambda *s: torch.randn(*s, dtype=torch.bfloat16) * 0.05)(B, S, D)),
            "wqkv": _w((lambda *s: torch.randn(*s, dtype=torch.bfloat16) * 0.8)(D, 3 * D)),
            "wo": _w((lambda *s: torch.randn(*s, dtype=torch.bfloat16) * 0.05)(D, D)),
        }
    _A_in = _A_setup()

    def _B_setup():
        B, S, Dm, Df = 1, 2048, 512, 1376
        return {
            "x": _w((lambda *s: torch.randn(*s, dtype=torch.bfloat16) * 0.05)(B, S, Dm)),
            "w_gate": _w((lambda *s: torch.randn(*s, dtype=torch.bfloat16) * 3.2)(Dm, Df) * (Dm ** -0.5)),
            "w_up": _w((lambda *s: torch.randn(*s, dtype=torch.bfloat16) * 3.2)(Dm, Df) * (Dm ** -0.5)),
            "w_down": _w((lambda *s: torch.randn(*s, dtype=torch.bfloat16) * 3.2)(Df, Dm) * (Df ** -0.5)),
        }
    _B_in = _B_setup()

    return {
        "A_x": _A_in["x"],
        "A_wqkv": _A_in["wqkv"],
        "A_wo": _A_in["wo"],
        "B_x": _B_in["x"],
        "B_w_gate": _B_in["w_gate"],
        "B_w_up": _B_in["w_up"],
        "B_w_down": _B_in["w_down"],
        "gate_w": _w((lambda *s: torch.randn(*s, dtype=torch.bfloat16) * 0.05)(512) * 16.0),
    }

def reference(A_x, A_wqkv, A_wo, B_x, B_w_gate, B_w_up, B_w_down, gate_w):
    def _A_ref(x, wqkv, wo):
        B, S, D = x.shape
        H = 32
        Dh = D // H
        qkv = (lambda x, *d: x.permute(*d))((x @ wqkv).reshape(B, S, 3, H, Dh), 2, 0, 3, 1, 4)
        q, k, v = qkv[0], qkv[1], qkv[2]
        scores = torch.einsum("bhqd,bhkd->bhqk", q, k) * (Dh ** -0.5)
        p = _softmax(scores, axis=-1)
        o = torch.einsum("bhqk,bhkd->bhqd", p, v)
        return (lambda x, *d: x.permute(*d))(o, 0, 2, 1, 3).reshape(B, S, D) @ wo

    def _B_ref(x, w_gate, w_up, w_down):
        g = torch.einsum("bsd,df->bsf", x, w_gate)
        u = torch.einsum("bsd,df->bsf", x, w_up)
        h = _gelu(g) * u
        return torch.einsum("bsf,fd->bsd", h, w_down)

    x = A_x
    g = _sigmoid((x * gate_w).sum(-1, keepdims=True))
    a = _A_ref(x, A_wqkv, A_wo)
    b = _B_ref(x, B_w_gate, B_w_up, B_w_down)
    return g * a + (1 - g) * b
```

```asm
; @launch grid=(512,1,1) block=(256,1,1) lds=81920
.amdgcn_target "amdgcn-amd-amdhsa--gfx950"
.text
.globl gated_mix__mha_block__glu_gated_geglu__prompt_kernel
.p2align 8
.type gated_mix__mha_block__glu_gated_geglu__prompt_kernel,@function
gated_mix__mha_block__glu_gated_geglu__prompt_kernel:
  s_cmp_ge_u32 s2, 512
  s_cbranch_scc1 k_done
  s_load_dwordx16 s[32:47], s[0:1], 0
  s_load_dwordx2 s[4:5], s[0:1], 80
  s_load_dwordx2 s[48:49], s[0:1], 72
  v_lshrrev_b32 v12, 6, v0
  v_and_b32 v0, 63, v0
  v_readfirstlane_b32 s8, v12
  s_waitcnt lgkmcnt(0)
  s_cmp_ge_u32 s2, 256
  s_cbranch_scc1 k_ffn
  s_setprio 2
  s_and_b32 s9, s2, 1
  s_lshl_b32 s9, s9, 4
  s_bfe_u32 s24, s2, 0x40003
  s_add_u32 s9, s9, s24
  s_bfe_u32 s10, s2, 0x20001
  s_lshl_b32 s10, s10, 1
  s_lshr_b32 s24, s2, 7
  s_add_u32 s10, s10, s24
  s_mov_b32 s12, s32
  s_mov_b32 s13, s33
  s_and_b32 s13, s13, 0xffff
  s_mov_b32 s14, 2097152
  s_mov_b32 s15, 0x20000
  s_mov_b32 s16, s34
  s_mov_b32 s17, s35
  s_and_b32 s17, s17, 0xffff
  s_mov_b32 s18, 1572864
  s_mov_b32 s19, 0x20000
  s_lshl_b32 s20, s9, 16
  s_mov_b32 s21, 0
  s_lshl_b32 s24, s8, 14
  v_lshrrev_b32 v12, 4, v0
  v_and_b32 v13, 7, v0
  v_xor_b32 v12, v12, v13
  v_lshlrev_b32 v12, 4, v12
  v_lshrrev_b32 v13, 3, v0
  v_lshlrev_b32 v13, 10, v13
  v_add_u32 v1, v12, v13
  v_add_u32 v1, s24, v1
  v_lshrrev_b32 v12, 4, v0
  v_add_u32 v12, 4, v12
  v_and_b32 v13, 7, v0
  v_xor_b32 v12, v12, v13
  v_lshlrev_b32 v12, 4, v12
  v_lshrrev_b32 v13, 3, v0
  v_lshlrev_b32 v13, 10, v13
  v_add_u32 v2, v12, v13
  v_add_u32 v2, s24, v2
  v_add_u32 v2, 7168, v2
  s_lshl_b32 s22, s8, 11
  v_lshrrev_b32 v12, 3, v0
  v_mul_u32_u24 v12, 3072, v12
  v_bfe_u32 v13, v0, 4, 1
  v_lshlrev_b32 v13, 2, v13
  v_and_b32 v14, 7, v0
  v_xor_b32 v13, v13, v14
  v_lshlrev_b32 v13, 4, v13
  s_mul_i32 s24, s8, 24576
  s_lshl_b32 s25, s10, 7
  s_add_u32 s24, s24, s25
  v_add3_u32 v5, v12, v13, s24
  s_mul_i32 s23, s8, 3072
  s_add_u32 m0, s22, 0
  s_nop 0
  buffer_load_dwordx4 v1, s[12:15], s20 offen lds
  buffer_load_dwordx4 v2, s[12:15], s20 offen offset:1024 lds
  s_add_u32 s20, s20, 128
  s_add_u32 m0, s23, 24576
  s_nop 0
  buffer_load_dwordx4 v5, s[16:19], s21 offen lds
  buffer_load_dwordx4 v5, s[16:19], s21 offen offset:1024 lds
  buffer_load_dwordx4 v5, s[16:19], s21 offen offset:2048 lds
  s_add_u32 s21, s21, 98304
  s_add_u32 m0, s23, 36864
  s_nop 0
  buffer_load_dwordx4 v5, s[16:19], s21 offen lds
  buffer_load_dwordx4 v5, s[16:19], s21 offen offset:1024 lds
  buffer_load_dwordx4 v5, s[16:19], s21 offen offset:2048 lds
  s_add_u32 s21, s21, 98304
  s_add_u32 m0, s22, 8192
  s_nop 0
  buffer_load_dwordx4 v1, s[12:15], s20 offen lds
  buffer_load_dwordx4 v2, s[12:15], s20 offen offset:1024 lds
  s_add_u32 s20, s20, 128
  s_add_u32 m0, s23, 49152
  s_nop 0
  buffer_load_dwordx4 v5, s[16:19], s21 offen lds
  buffer_load_dwordx4 v5, s[16:19], s21 offen offset:1024 lds
  buffer_load_dwordx4 v5, s[16:19], s21 offen offset:2048 lds
  s_add_u32 s21, s21, 98304
  s_add_u32 m0, s23, 61440
  s_nop 0
  buffer_load_dwordx4 v5, s[16:19], s21 offen lds
  buffer_load_dwordx4 v5, s[16:19], s21 offen offset:1024 lds
  buffer_load_dwordx4 v5, s[16:19], s21 offen offset:2048 lds
  s_add_u32 s21, s21, 98304
  s_add_u32 m0, s22, 16384
  s_nop 0
  buffer_load_dwordx4 v1, s[12:15], s20 offen lds
  buffer_load_dwordx4 v2, s[12:15], s20 offen offset:1024 lds
  s_add_u32 s20, s20, 128
  v_mov_b32 v179, 0
  s_nop 0
  global_load_dword v179, v179, s[48:49] sc1
  s_and_b32 s24, s8, 1
  s_lshl_b32 s24, s24, 12
  v_and_b32 v12, 31, v0
  v_lshrrev_b32 v13, 5, v0
  v_bfe_u32 v14, v0, 1, 3
  v_xor_b32 v13, v13, v14
  v_lshlrev_b32 v13, 4, v13
  v_lshlrev_b32 v12, 7, v12
  v_add3_u32 v8, v12, v13, s24
  v_xor_b32 v9, 32, v8
  v_xor_b32 v10, 64, v8
  v_xor_b32 v11, 96, v8
  v_add_u32 v142, 32768, v8
  v_add_u32 v143, 32768, v9
  v_add_u32 v144, 32768, v10
  v_add_u32 v145, 32768, v11
  v_lshrrev_b32 v12, 5, v0
  v_mul_u32_u24 v12, 3072, v12
  v_bfe_u32 v13, v0, 2, 2
  v_lshlrev_b32 v13, 7, v13
  v_add_u32 v12, v12, v13
  s_lshr_b32 s24, s8, 1
  v_bfe_u32 v13, v0, 3, 1
  v_xor_b32 v13, s24, v13
  v_lshlrev_b32 v13, 6, v13
  v_add_u32 v12, v12, v13
  v_bfe_u32 v13, v0, 4, 1
  v_lshlrev_b32 v13, 5, v13
  v_and_b32 v14, 3, v0
  v_lshlrev_b32 v14, 3, v14
  v_add3_u32 v140, v12, v13, v14
  v_add_u32 v141, 32768, v140
  s_lshl_b32 s24, s9, 6
  s_lshl_b32 s25, s10, 3
  s_add_u32 s24, s24, s25
  s_lshl_b32 s25, s8, 1
  s_add_u32 s31, s24, s25
  s_lshl_b32 s27, s31, 10
  v_lshlrev_b32 v12, 4, v0
  v_add_u32 v13, s27, v12
  global_load_dwordx4 v[128:131], v13, s[32:33]
  global_load_dwordx4 v[132:135], v13, s[32:33] offset:1024
  global_load_dwordx4 v[136:139], v12, s[46:47]
  v_mov_b32 v80, 0
  v_mov_b32 v81, 0
  v_mov_b32 v82, 0
  v_mov_b32 v83, 0
  v_mov_b32 v84, 0
  v_mov_b32 v85, 0
  v_mov_b32 v86, 0
  v_mov_b32 v87, 0
  v_mov_b32 v88, 0
  v_mov_b32 v89, 0
  v_mov_b32 v90, 0
  v_mov_b32 v91, 0
  v_mov_b32 v92, 0
  v_mov_b32 v93, 0
  v_mov_b32 v94, 0
  v_mov_b32 v95, 0
  v_mov_b32 v96, 0
  v_mov_b32 v97, 0
  v_mov_b32 v98, 0
  v_mov_b32 v99, 0
  v_mov_b32 v100, 0
  v_mov_b32 v101, 0
  v_mov_b32 v102, 0
  v_mov_b32 v103, 0
  v_mov_b32 v104, 0
  v_mov_b32 v105, 0
  v_mov_b32 v106, 0
  v_mov_b32 v107, 0
  v_mov_b32 v108, 0
  v_mov_b32 v109, 0
  v_mov_b32 v110, 0
  v_mov_b32 v111, 0
  v_mov_b32 v112, 0
  v_mov_b32 v113, 0
  v_mov_b32 v114, 0
  v_mov_b32 v115, 0
  v_mov_b32 v116, 0
  v_mov_b32 v117, 0
  v_mov_b32 v118, 0
  v_mov_b32 v119, 0
  v_mov_b32 v120, 0
  v_mov_b32 v121, 0
  v_mov_b32 v122, 0
  v_mov_b32 v123, 0
  v_mov_b32 v124, 0
  v_mov_b32 v125, 0
  v_mov_b32 v126, 0
  v_mov_b32 v127, 0
  s_waitcnt vmcnt(17)
  s_barrier
  ds_read_b128 v[16:19], v8 offset:0
  ds_read_b64_tr_b16 v[32:33], v140 offset:24576
  ds_read_b64_tr_b16 v[34:35], v140 offset:25088
  ds_read_b64_tr_b16 v[36:37], v140 offset:25600
  ds_read_b64_tr_b16 v[38:39], v140 offset:26112
  ds_read_b64_tr_b16 v[40:41], v140 offset:26624
  ds_read_b64_tr_b16 v[42:43], v140 offset:27136
  ds_read_b128 v[20:23], v9 offset:0
  ds_read_b64_tr_b16 v[44:45], v140 offset:30720
  ds_read_b64_tr_b16 v[46:47], v140 offset:31232
  ds_read_b64_tr_b16 v[48:49], v140 offset:31744
  ds_read_b64_tr_b16 v[50:51], v140 offset:32256
  ds_read_b64_tr_b16 v[52:53], v140 offset:32768
  ds_read_b64_tr_b16 v[54:55], v140 offset:33280
  s_waitcnt vmcnt(14) lgkmcnt(0)
  s_barrier
  v_mfma_f32_32x32x16_bf16 v[80:95], v[32:35], v[16:19], v[80:95]
  ds_read_b128 v[24:27], v10 offset:0
  ds_read_b64_tr_b16 v[56:57], v140 offset:36864
  ds_read_b64_tr_b16 v[58:59], v140 offset:37376
  v_mfma_f32_32x32x16_bf16 v[96:111], v[36:39], v[16:19], v[96:111]
  s_add_u32 m0, s23, 24576
  s_nop 0
  buffer_load_dwordx4 v5, s[16:19], s21 offen lds
  buffer_load_dwordx4 v5, s[16:19], s21 offen offset:1024 lds
  buffer_load_dwordx4 v5, s[16:19], s21 offen offset:2048 lds
  s_add_u32 s21, s21, 98304
  v_mfma_f32_32x32x16_bf16 v[112:127], v[16:19], v[40:43], v[112:127]
  ds_read_b64_tr_b16 v[60:61], v140 offset:37888
  ds_read_b64_tr_b16 v[62:63], v140 offset:38400
  ds_read_b64_tr_b16 v[64:65], v140 offset:38912
  v_mfma_f32_32x32x16_bf16 v[80:95], v[44:47], v[20:23], v[80:95]
  ds_read_b64_tr_b16 v[66:67], v140 offset:39424
  ds_read_b128 v[28:31], v11 offset:0
  ds_read_b64_tr_b16 v[68:69], v140 offset:43008
  v_mfma_f32_32x32x16_bf16 v[96:111], v[48:51], v[20:23], v[96:111]
  ds_read_b64_tr_b16 v[70:71], v140 offset:43520
  ds_read_b64_tr_b16 v[72:73], v140 offset:44032
  ds_read_b64_tr_b16 v[74:75], v140 offset:44544
  v_mfma_f32_32x32x16_bf16 v[112:127], v[20:23], v[52:55], v[112:127]
  ds_read_b64_tr_b16 v[76:77], v140 offset:45056
  ds_read_b64_tr_b16 v[78:79], v140 offset:45568
  s_waitcnt vmcnt(12) lgkmcnt(0)
  s_barrier
  v_mfma_f32_32x32x16_bf16 v[80:95], v[56:59], v[24:27], v[80:95]
  ds_read_b128 v[16:19], v8 offset:8192
  ds_read_b64_tr_b16 v[32:33], v141 offset:16384
  ds_read_b64_tr_b16 v[34:35], v141 offset:16896
  v_mfma_f32_32x32x16_bf16 v[96:111], v[60:63], v[24:27], v[96:111]
  s_add_u32 m0, s23, 36864
  s_nop 0
  buffer_load_dwordx4 v5, s[16:19], s21 offen lds
  buffer_load_dwordx4 v5, s[16:19], s21 offen offset:1024 lds
  buffer_load_dwordx4 v5, s[16:19], s21 offen offset:2048 lds
  s_add_u32 s21, s21, 98304
  s_add_u32 m0, s22, 0
  s_nop 0
  buffer_load_dwordx4 v1, s[12:15], s20 offen lds
  buffer_load_dwordx4 v2, s[12:15], s20 offen offset:1024 lds
  s_add_u32 s20, s20, 128
  v_mfma_f32_32x32x16_bf16 v[112:127], v[24:27], v[64:67], v[112:127]
  ds_read_b64_tr_b16 v[36:37], v141 offset:17408
  ds_read_b64_tr_b16 v[38:39], v141 offset:17920
  ds_read_b64_tr_b16 v[40:41], v141 offset:18432
  v_mfma_f32_32x32x16_bf16 v[80:95], v[68:71], v[28:31], v[80:95]
  ds_read_b64_tr_b16 v[42:43], v141 offset:18944
  ds_read_b128 v[20:23], v9 offset:8192
  ds_read_b64_tr_b16 v[44:45], v141 offset:22528
  v_mfma_f32_32x32x16_bf16 v[96:111], v[72:75], v[28:31], v[96:111]
  ds_read_b64_tr_b16 v[46:47], v141 offset:23040
  ds_read_b64_tr_b16 v[48:49], v141 offset:23552
  ds_read_b64_tr_b16 v[50:51], v141 offset:24064
  v_mfma_f32_32x32x16_bf16 v[112:127], v[28:31], v[76:79], v[112:127]
  ds_read_b64_tr_b16 v[52:53], v141 offset:24576
  ds_read_b64_tr_b16 v[54:55], v141 offset:25088
  s_waitcnt vmcnt(14) lgkmcnt(0)
  s_barrier
  v_mfma_f32_32x32x16_bf16 v[80:95], v[32:35], v[16:19], v[80:95]
  ds_read_b128 v[24:27], v10 offset:8192
  ds_read_b64_tr_b16 v[56:57], v141 offset:28672
  ds_read_b64_tr_b16 v[58:59], v141 offset:29184
  v_mfma_f32_32x32x16_bf16 v[96:111], v[36:39], v[16:19], v[96:111]
  s_add_u32 m0, s23, 49152
  s_nop 0
  buffer_load_dwordx4 v5, s[16:19], s21 offen lds
  buffer_load_dwordx4 v5, s[16:19], s21 offen offset:1024 lds
  buffer_load_dwordx4 v5, s[16:19], s21 offen offset:2048 lds
  s_add_u32 s21, s21, 98304
  v_mfma_f32_32x32x16_bf16 v[112:127], v[16:19], v[40:43], v[112:127]
  ds_read_b64_tr_b16 v[60:61], v141 offset:29696
  ds_read_b64_tr_b16 v[62:63], v141 offset:30208
  ds_read_b64_tr_b16 v[64:65], v141 offset:30720
  v_mfma_f32_32x32x16_bf16 v[80:95], v[44:47], v[20:23], v[80:95]
  ds_read_b64_tr_b16 v[66:67], v141 offset:31232
  ds_read_b128 v[28:31], v11 offset:8192
  ds_read_b64_tr_b16 v[68:69], v141 offset:34816
  v_mfma_f32_32x32x16_bf16 v[96:111], v[48:51], v[20:23], v[96:111]
  ds_read_b64_tr_b16 v[70:71], v141 offset:35328
  ds_read_b64_tr_b16 v[72:73], v141 offset:35840
  ds_read_b64_tr_b16 v[74:75], v141 offset:36352
  v_mfma_f32_32x32x16_bf16 v[112:127], v[20:23], v[52:55], v[112:127]
  ds_read_b64_tr_b16 v[76:77], v141 offset:36864
  ds_read_b64_tr_b16 v[78:79], v141 offset:37376
  s_waitcnt vmcnt(8) lgkmcnt(0)
  s_barrier
  v_mfma_f32_32x32x16_bf16 v[80:95], v[56:59], v[24:27], v[80:95]
  ds_read_b128 v[16:19], v8 offset:16384
  ds_read_b64_tr_b16 v[32:33], v140 offset:24576
  ds_read_b64_tr_b16 v[34:35], v140 offset:25088
  v_mfma_f32_32x32x16_bf16 v[96:111], v[60:63], v[24:27], v[96:111]
  s_add_u32 m0, s23, 61440
  s_nop 0
  buffer_load_dwordx4 v5, s[16:19], s21 offen lds
  buffer_load_dwordx4 v5, s[16:19], s21 offen offset:1024 lds
  buffer_load_dwordx4 v5, s[16:19], s21 offen offset:2048 lds
  s_add_u32 s21, s21, 98304
  s_add_u32 m0, s22, 8192
  s_nop 0
  buffer_load_dwordx4 v1, s[12:15], s20 offen lds
  buffer_load_dwordx4 v2, s[12:15], s20 offen offset:1024 lds
  s_add_u32 s20, s20, 128
  v_mfma_f32_32x32x16_bf16 v[112:127], v[24:27], v[64:67], v[112:127]
  ds_read_b64_tr_b16 v[36:37], v140 offset:25600
  ds_read_b64_tr_b16 v[38:39], v140 offset:26112
  ds_read_b64_tr_b16 v[40:41], v140 offset:26624
  v_mfma_f32_32x32x16_bf16 v[80:95], v[68:71], v[28:31], v[80:95]
  ds_read_b64_tr_b16 v[42:43], v140 offset:27136
  ds_read_b128 v[20:23], v9 offset:16384
  ds_read_b64_tr_b16 v[44:45], v140 offset:30720
  v_mfma_f32_32x32x16_bf16 v[96:111], v[72:75], v[28:31], v[96:111]
  ds_read_b64_tr_b16 v[46:47], v140 offset:31232
  ds_read_b64_tr_b16 v[48:49], v140 offset:31744
  ds_read_b64_tr_b16 v[50:51], v140 offset:32256
  v_mfma_f32_32x32x16_bf16 v[112:127], v[28:31], v[76:79], v[112:127]
  ds_read_b64_tr_b16 v[52:53], v140 offset:32768
  ds_read_b64_tr_b16 v[54:55], v140 offset:33280
  s_waitcnt vmcnt(10) lgkmcnt(0)
  s_barrier
  v_mfma_f32_32x32x16_bf16 v[80:95], v[32:35], v[16:19], v[80:95]
  ds_read_b128 v[24:27], v10 offset:16384
  ds_read_b64_tr_b16 v[56:57], v140 offset:36864
  ds_read_b64_tr_b16 v[58:59], v140 offset:37376
  v_mfma_f32_32x32x16_bf16 v[96:111], v[36:39], v[16:19], v[96:111]
  s_add_u32 m0, s23, 24576
  s_nop 0
  buffer_load_dwordx4 v5, s[16:19], s21 offen lds
  buffer_load_dwordx4 v5, s[16:19], s21 offen offset:1024 lds
  buffer_load_dwordx4 v5, s[16:19], s21 offen offset:2048 lds
  s_add_u32 s21, s21, 98304
  v_mfma_f32_32x32x16_bf16 v[112:127], v[16:19], v[40:43], v[112:127]
  ds_read_b64_tr_b16 v[60:61], v140 offset:37888
  ds_read_b64_tr_b16 v[62:63], v140 offset:38400
  ds_read_b64_tr_b16 v[64:65], v140 offset:38912
  v_mfma_f32_32x32x16_bf16 v[80:95], v[44:47], v[20:23], v[80:95]
  ds_read_b64_tr_b16 v[66:67], v140 offset:39424
  ds_read_b128 v[28:31], v11 offset:16384
  ds_read_b64_tr_b16 v[68:69], v140 offset:43008
  v_mfma_f32_32x32x16_bf16 v[96:111], v[48:51], v[20:23], v[96:111]
  ds_read_b64_tr_b16 v[70:71], v140 offset:43520
  ds_read_b64_tr_b16 v[72:73], v140 offset:44032
  ds_read_b64_tr_b16 v[74:75], v140 offset:44544
  v_mfma_f32_32x32x16_bf16 v[112:127], v[20:23], v[52:55], v[112:127]
  ds_read_b64_tr_b16 v[76:77], v140 offset:45056
  ds_read_b64_tr_b16 v[78:79], v140 offset:45568
  s_waitcnt vmcnt(8) lgkmcnt(0)
  s_barrier
  v_mfma_f32_32x32x16_bf16 v[80:95], v[56:59], v[24:27], v[80:95]
  ds_read_b128 v[16:19], v8 offset:0
  ds_read_b64_tr_b16 v[32:33], v141 offset:16384
  ds_read_b64_tr_b16 v[34:35], v141 offset:16896
  v_mfma_f32_32x32x16_bf16 v[96:111], v[60:63], v[24:27], v[96:111]
  s_add_u32 m0, s23, 36864
  s_nop 0
  buffer_load_dwordx4 v5, s[16:19], s21 offen lds
  buffer_load_dwordx4 v5, s[16:19], s21 offen offset:1024 lds
  buffer_load_dwordx4 v5, s[16:19], s21 offen offset:2048 lds
  s_add_u32 s21, s21, 98304
  s_add_u32 m0, s22, 16384
  s_nop 0
  buffer_load_dwordx4 v1, s[12:15], s20 offen lds
  buffer_load_dwordx4 v2, s[12:15], s20 offen offset:1024 lds
  s_add_u32 s20, s20, 128
  v_mfma_f32_32x32x16_bf16 v[112:127], v[24:27], v[64:67], v[112:127]
  ds_read_b64_tr_b16 v[36:37], v141 offset:17408
  ds_read_b64_tr_b16 v[38:39], v141 offset:17920
  ds_read_b64_tr_b16 v[40:41], v141 offset:18432
  v_mfma_f32_32x32x16_bf16 v[80:95], v[68:71], v[28:31], v[80:95]
  ds_read_b64_tr_b16 v[42:43], v141 offset:18944
  ds_read_b128 v[20:23], v9 offset:0
  ds_read_b64_tr_b16 v[44:45], v141 offset:22528
  v_mfma_f32_32x32x16_bf16 v[96:111], v[72:75], v[28:31], v[96:111]
  ds_read_b64_tr_b16 v[46:47], v141 offset:23040
  ds_read_b64_tr_b16 v[48:49], v141 offset:23552
  ds_read_b64_tr_b16 v[50:51], v141 offset:24064
  v_mfma_f32_32x32x16_bf16 v[112:127], v[28:31], v[76:79], v[112:127]
  ds_read_b64_tr_b16 v[52:53], v141 offset:24576
  ds_read_b64_tr_b16 v[54:55], v141 offset:25088
  s_waitcnt vmcnt(10) lgkmcnt(0)
  s_barrier
  v_mfma_f32_32x32x16_bf16 v[80:95], v[32:35], v[16:19], v[80:95]
  ds_read_b128 v[24:27], v10 offset:0
  ds_read_b64_tr_b16 v[56:57], v141 offset:28672
  ds_read_b64_tr_b16 v[58:59], v141 offset:29184
  v_mfma_f32_32x32x16_bf16 v[96:111], v[36:39], v[16:19], v[96:111]
  s_add_u32 m0, s23, 49152
  s_nop 0
  buffer_load_dwordx4 v5, s[16:19], s21 offen lds
  buffer_load_dwordx4 v5, s[16:19], s21 offen offset:1024 lds
  buffer_load_dwordx4 v5, s[16:19], s21 offen offset:2048 lds
  s_add_u32 s21, s21, 98304
  v_mfma_f32_32x32x16_bf16 v[112:127], v[16:19], v[40:43], v[112:127]
  ds_read_b64_tr_b16 v[60:61], v141 offset:29696
  ds_read_b64_tr_b16 v[62:63], v141 offset:30208
  ds_read_b64_tr_b16 v[64:65], v141 offset:30720
  v_mfma_f32_32x32x16_bf16 v[80:95], v[44:47], v[20:23], v[80:95]
  ds_read_b64_tr_b16 v[66:67], v141 offset:31232
  ds_read_b128 v[28:31], v11 offset:0
  ds_read_b64_tr_b16 v[68:69], v141 offset:34816
  v_mfma_f32_32x32x16_bf16 v[96:111], v[48:51], v[20:23], v[96:111]
  ds_read_b64_tr_b16 v[70:71], v141 offset:35328
  ds_read_b64_tr_b16 v[72:73], v141 offset:35840
  ds_read_b64_tr_b16 v[74:75], v141 offset:36352
  v_mfma_f32_32x32x16_bf16 v[112:127], v[20:23], v[52:55], v[112:127]
  ds_read_b64_tr_b16 v[76:77], v141 offset:36864
  ds_read_b64_tr_b16 v[78:79], v141 offset:37376
  s_waitcnt vmcnt(8) lgkmcnt(0)
  s_barrier
  v_mfma_f32_32x32x16_bf16 v[80:95], v[56:59], v[24:27], v[80:95]
  ds_read_b128 v[16:19], v8 offset:8192
  ds_read_b64_tr_b16 v[32:33], v140 offset:24576
  ds_read_b64_tr_b16 v[34:35], v140 offset:25088
  v_mfma_f32_32x32x16_bf16 v[96:111], v[60:63], v[24:27], v[96:111]
  s_add_u32 m0, s23, 61440
  s_nop 0
  buffer_load_dwordx4 v5, s[16:19], s21 offen lds
  buffer_load_dwordx4 v5, s[16:19], s21 offen offset:1024 lds
  buffer_load_dwordx4 v5, s[16:19], s21 offen offset:2048 lds
  s_add_u32 s21, s21, 98304
  s_add_u32 m0, s22, 0
  s_nop 0
  buffer_load_dwordx4 v1, s[12:15], s20 offen lds
  buffer_load_dwordx4 v2, s[12:15], s20 offen offset:1024 lds
  s_add_u32 s20, s20, 128
  v_mfma_f32_32x32x16_bf16 v[112:127], v[24:27], v[64:67], v[112:127]
  ds_read_b64_tr_b16 v[36:37], v140 offset:25600
  ds_read_b64_tr_b16 v[38:39], v140 offset:26112
  ds_read_b64_tr_b16 v[40:41], v140 offset:26624
  v_mfma_f32_32x32x16_bf16 v[80:95], v[68:71], v[28:31], v[80:95]
  ds_read_b64_tr_b16 v[42:43], v140 offset:27136
  ds_read_b128 v[20:23], v9 offset:8192
  ds_read_b64_tr_b16 v[44:45], v140 offset:30720
  v_mfma_f32_32x32x16_bf16 v[96:111], v[72:75], v[28:31], v[96:111]
  ds_read_b64_tr_b16 v[46:47], v140 offset:31232
  ds_read_b64_tr_b16 v[48:49], v140 offset:31744
  ds_read_b64_tr_b16 v[50:51], v140 offset:32256
  v_mfma_f32_32x32x16_bf16 v[112:127], v[28:31], v[76:79], v[112:127]
  ds_read_b64_tr_b16 v[52:53], v140 offset:32768
  ds_read_b64_tr_b16 v[54:55], v140 offset:33280
  v_mov_b32 v146, 0
  v_mov_b32 v147, 0
  v_dot2_f32_bf16 v146, v128, v136, v146
  v_dot2_f32_bf16 v147, v132, v136, v147
  v_dot2_f32_bf16 v146, v129, v137, v146
  v_dot2_f32_bf16 v147, v133, v137, v147
  v_dot2_f32_bf16 v146, v130, v138, v146
  v_dot2_f32_bf16 v147, v134, v138, v147
  v_dot2_f32_bf16 v146, v131, v139, v146
  v_dot2_f32_bf16 v147, v135, v139, v147
  s_nop 1
  v_add_f32_dpp v146, v146, v146 row_ror:8 row_mask:0xf bank_mask:0xf
  v_add_f32_dpp v147, v147, v147 row_ror:8 row_mask:0xf bank_mask:0xf
  s_nop 1
  v_add_f32_dpp v146, v146, v146 row_ror:4 row_mask:0xf bank_mask:0xf
  v_add_f32_dpp v147, v147, v147 row_ror:4 row_mask:0xf bank_mask:0xf
  s_nop 1
  v_add_f32_dpp v146, v146, v146 row_ror:2 row_mask:0xf bank_mask:0xf
  v_add_f32_dpp v147, v147, v147 row_ror:2 row_mask:0xf bank_mask:0xf
  s_nop 1
  v_add_f32_dpp v146, v146, v146 row_ror:1 row_mask:0xf bank_mask:0xf
  v_add_f32_dpp v147, v147, v147 row_ror:1 row_mask:0xf bank_mask:0xf
  s_nop 1
  v_readlane_b32 s24, v146, 0
  v_readlane_b32 s25, v146, 16
  v_readlane_b32 s26, v146, 32
  v_readlane_b32 s27, v146, 48
  s_nop 1
  v_mov_b32 v12, s24
  v_add_f32 v12, s25, v12
  v_add_f32 v12, s26, v12
  v_add_f32 v12, s27, v12
  v_readlane_b32 s24, v147, 0
  v_readlane_b32 s25, v147, 16
  v_readlane_b32 s26, v147, 32
  v_readlane_b32 s27, v147, 48
  s_nop 1
  v_mov_b32 v13, s24
  v_add_f32 v13, s25, v13
  v_add_f32 v13, s26, v13
  v_add_f32 v13, s27, v13
  v_and_b32 v14, 1, v0
  v_cmp_eq_u32 vcc, 1, v14
  s_nop 1
  v_cndmask_b32 v12, v12, v13, vcc
  v_mul_f32 v12, 3216550459, v12
  v_exp_f32 v12, v12
  s_nop 0
  v_add_f32 v12, 1.0, v12
  v_rcp_f32 v12, v12
  v_lshlrev_b32 v13, 2, v0
  s_lshl_b32 s24, s31, 6
  s_add_u32 s24, s24, 19136512
  v_add_u32 v13, s24, v13
  s_mov_b32 exec_hi, 0
  global_store_dword v13, v12, s[4:5] sc1
  s_mov_b32 exec_hi, -1
  s_waitcnt vmcnt(10) lgkmcnt(0)
  s_barrier
  v_mfma_f32_32x32x16_bf16 v[80:95], v[32:35], v[16:19], v[80:95]
  ds_read_b128 v[24:27], v10 offset:8192
  ds_read_b64_tr_b16 v[56:57], v140 offset:36864
  ds_read_b64_tr_b16 v[58:59], v140 offset:37376
  v_mfma_f32_32x32x16_bf16 v[96:111], v[36:39], v[16:19], v[96:111]
  s_add_u32 m0, s23, 24576
  s_nop 0
  buffer_load_dwordx4 v5, s[16:19], s21 offen lds
  buffer_load_dwordx4 v5, s[16:19], s21 offen offset:1024 lds
  buffer_load_dwordx4 v5, s[16:19], s21 offen offset:2048 lds
  s_add_u32 s21, s21, 98304
  v_mfma_f32_32x32x16_bf16 v[112:127], v[16:19], v[40:43], v[112:127]
  ds_read_b64_tr_b16 v[60:61], v140 offset:37888
  ds_read_b64_tr_b16 v[62:63], v140 offset:38400
  ds_read_b64_tr_b16 v[64:65], v140 offset:38912
  v_mfma_f32_32x32x16_bf16 v[80:95], v[44:47], v[20:23], v[80:95]
  ds_read_b64_tr_b16 v[66:67], v140 offset:39424
  ds_read_b128 v[28:31], v11 offset:8192
  ds_read_b64_tr_b16 v[68:69], v140 offset:43008
  v_mfma_f32_32x32x16_bf16 v[96:111], v[48:51], v[20:23], v[96:111]
  ds_read_b64_tr_b16 v[70:71], v140 offset:43520
  ds_read_b64_tr_b16 v[72:73], v140 offset:44032
  ds_read_b64_tr_b16 v[74:75], v140 offset:44544
  v_mfma_f32_32x32x16_bf16 v[112:127], v[20:23], v[52:55], v[112:127]
  ds_read_b64_tr_b16 v[76:77], v140 offset:45056
  ds_read_b64_tr_b16 v[78:79], v140 offset:45568
  s_waitcnt vmcnt(8) lgkmcnt(0)
  s_barrier
  v_mfma_f32_32x32x16_bf16 v[80:95], v[56:59], v[24:27], v[80:95]
  ds_read_b128 v[16:19], v8 offset:16384
  ds_read_b64_tr_b16 v[32:33], v141 offset:16384
  ds_read_b64_tr_b16 v[34:35], v141 offset:16896
  v_mfma_f32_32x32x16_bf16 v[96:111], v[60:63], v[24:27], v[96:111]
  s_add_u32 m0, s23, 36864
  s_nop 0
  buffer_load_dwordx4 v5, s[16:19], s21 offen lds
  buffer_load_dwordx4 v5, s[16:19], s21 offen offset:1024 lds
  buffer_load_dwordx4 v5, s[16:19], s21 offen offset:2048 lds
  s_add_u32 s21, s21, 98304
  s_add_u32 m0, s22, 8192
  s_nop 0
  buffer_load_dwordx4 v1, s[12:15], s20 offen lds
  buffer_load_dwordx4 v2, s[12:15], s20 offen offset:1024 lds
  s_add_u32 s20, s20, 128
  v_mfma_f32_32x32x16_bf16 v[112:127], v[24:27], v[64:67], v[112:127]
  ds_read_b64_tr_b16 v[36:37], v141 offset:17408
  ds_read_b64_tr_b16 v[38:39], v141 offset:17920
  ds_read_b64_tr_b16 v[40:41], v141 offset:18432
  v_mfma_f32_32x32x16_bf16 v[80:95], v[68:71], v[28:31], v[80:95]
  ds_read_b64_tr_b16 v[42:43], v141 offset:18944
  ds_read_b128 v[20:23], v9 offset:16384
  ds_read_b64_tr_b16 v[44:45], v141 offset:22528
  v_mfma_f32_32x32x16_bf16 v[96:111], v[72:75], v[28:31], v[96:111]
  ds_read_b64_tr_b16 v[46:47], v141 offset:23040
  ds_read_b64_tr_b16 v[48:49], v141 offset:23552
  ds_read_b64_tr_b16 v[50:51], v141 offset:24064
  v_mfma_f32_32x32x16_bf16 v[112:127], v[28:31], v[76:79], v[112:127]
  ds_read_b64_tr_b16 v[52:53], v141 offset:24576
  ds_read_b64_tr_b16 v[54:55], v141 offset:25088
  s_waitcnt vmcnt(10) lgkmcnt(0)
  s_barrier
  v_mfma_f32_32x32x16_bf16 v[80:95], v[32:35], v[16:19], v[80:95]
  ds_read_b128 v[24:27], v10 offset:16384
  ds_read_b64_tr_b16 v[56:57], v141 offset:28672
  ds_read_b64_tr_b16 v[58:59], v141 offset:29184
  v_mfma_f32_32x32x16_bf16 v[96:111], v[36:39], v[16:19], v[96:111]
  s_add_u32 m0, s23, 49152
  s_nop 0
  buffer_load_dwordx4 v5, s[16:19], s21 offen lds
  buffer_load_dwordx4 v5, s[16:19], s21 offen offset:1024 lds
  buffer_load_dwordx4 v5, s[16:19], s21 offen offset:2048 lds
  s_add_u32 s21, s21, 98304
  v_mfma_f32_32x32x16_bf16 v[112:127], v[16:19], v[40:43], v[112:127]
  ds_read_b64_tr_b16 v[60:61], v141 offset:29696
  ds_read_b64_tr_b16 v[62:63], v141 offset:30208
  ds_read_b64_tr_b16 v[64:65], v141 offset:30720
  v_mfma_f32_32x32x16_bf16 v[80:95], v[44:47], v[20:23], v[80:95]
  ds_read_b64_tr_b16 v[66:67], v141 offset:31232
  ds_read_b128 v[28:31], v11 offset:16384
  ds_read_b64_tr_b16 v[68:69], v141 offset:34816
  v_mfma_f32_32x32x16_bf16 v[96:111], v[48:51], v[20:23], v[96:111]
  ds_read_b64_tr_b16 v[70:71], v141 offset:35328
  ds_read_b64_tr_b16 v[72:73], v141 offset:35840
  ds_read_b64_tr_b16 v[74:75], v141 offset:36352
  v_mfma_f32_32x32x16_bf16 v[112:127], v[20:23], v[52:55], v[112:127]
  ds_read_b64_tr_b16 v[76:77], v141 offset:36864
  ds_read_b64_tr_b16 v[78:79], v141 offset:37376
  s_waitcnt vmcnt(8) lgkmcnt(0)
  s_barrier
  v_mfma_f32_32x32x16_bf16 v[80:95], v[56:59], v[24:27], v[80:95]
  ds_read_b128 v[16:19], v8 offset:0
  ds_read_b64_tr_b16 v[32:33], v140 offset:24576
  ds_read_b64_tr_b16 v[34:35], v140 offset:25088
  v_mfma_f32_32x32x16_bf16 v[96:111], v[60:63], v[24:27], v[96:111]
  s_add_u32 m0, s23, 61440
  s_nop 0
  buffer_load_dwordx4 v5, s[16:19], s21 offen lds
  buffer_load_dwordx4 v5, s[16:19], s21 offen offset:1024 lds
  buffer_load_dwordx4 v5, s[16:19], s21 offen offset:2048 lds
  s_add_u32 s21, s21, 98304
  v_mfma_f32_32x32x16_bf16 v[112:127], v[24:27], v[64:67], v[112:127]
  ds_read_b64_tr_b16 v[36:37], v140 offset:25600
  ds_read_b64_tr_b16 v[38:39], v140 offset:26112
  ds_read_b64_tr_b16 v[40:41], v140 offset:26624
  v_mfma_f32_32x32x16_bf16 v[80:95], v[68:71], v[28:31], v[80:95]
  ds_read_b64_tr_b16 v[42:43], v140 offset:27136
  ds_read_b128 v[20:23], v9 offset:0
  ds_read_b64_tr_b16 v[44:45], v140 offset:30720
  v_mfma_f32_32x32x16_bf16 v[96:111], v[72:75], v[28:31], v[96:111]
  ds_read_b64_tr_b16 v[46:47], v140 offset:31232
  ds_read_b64_tr_b16 v[48:49], v140 offset:31744
  ds_read_b64_tr_b16 v[50:51], v140 offset:32256
  v_mfma_f32_32x32x16_bf16 v[112:127], v[28:31], v[76:79], v[112:127]
  ds_read_b64_tr_b16 v[52:53], v140 offset:32768
  ds_read_b64_tr_b16 v[54:55], v140 offset:33280
  s_waitcnt vmcnt(8) lgkmcnt(0)
  s_barrier
  v_mfma_f32_32x32x16_bf16 v[80:95], v[32:35], v[16:19], v[80:95]
  ds_read_b128 v[24:27], v10 offset:0
  ds_read_b64_tr_b16 v[56:57], v140 offset:36864
  ds_read_b64_tr_b16 v[58:59], v140 offset:37376
  v_mfma_f32_32x32x16_bf16 v[96:111], v[36:39], v[16:19], v[96:111]
  v_mfma_f32_32x32x16_bf16 v[112:127], v[16:19], v[40:43], v[112:127]
  ds_read_b64_tr_b16 v[60:61], v140 offset:37888
  ds_read_b64_tr_b16 v[62:63], v140 offset:38400
  ds_read_b64_tr_b16 v[64:65], v140 offset:38912
  v_mfma_f32_32x32x16_bf16 v[80:95], v[44:47], v[20:23], v[80:95]
  ds_read_b64_tr_b16 v[66:67], v140 offset:39424
  ds_read_b128 v[28:31], v11 offset:0
  ds_read_b64_tr_b16 v[68:69], v140 offset:43008
  v_mfma_f32_32x32x16_bf16 v[96:111], v[48:51], v[20:23], v[96:111]
  ds_read_b64_tr_b16 v[70:71], v140 offset:43520
  ds_read_b64_tr_b16 v[72:73], v140 offset:44032
  ds_read_b64_tr_b16 v[74:75], v140 offset:44544
  v_mfma_f32_32x32x16_bf16 v[112:127], v[20:23], v[52:55], v[112:127]
  ds_read_b64_tr_b16 v[76:77], v140 offset:45056
  ds_read_b64_tr_b16 v[78:79], v140 offset:45568
  s_waitcnt vmcnt(3) lgkmcnt(0)
  s_barrier
  v_mfma_f32_32x32x16_bf16 v[80:95], v[56:59], v[24:27], v[80:95]
  ds_read_b128 v[16:19], v8 offset:8192
  ds_read_b64_tr_b16 v[32:33], v141 offset:16384
  ds_read_b64_tr_b16 v[34:35], v141 offset:16896
  v_mfma_f32_32x32x16_bf16 v[96:111], v[60:63], v[24:27], v[96:111]
  v_mfma_f32_32x32x16_bf16 v[112:127], v[24:27], v[64:67], v[112:127]
  ds_read_b64_tr_b16 v[36:37], v141 offset:17408
  ds_read_b64_tr_b16 v[38:39], v141 offset:17920
  ds_read_b64_tr_b16 v[40:41], v141 offset:18432
  v_mfma_f32_32x32x16_bf16 v[80:95], v[68:71], v[28:31], v[80:95]
  ds_read_b64_tr_b16 v[42:43], v141 offset:18944
  ds_read_b128 v[20:23], v9 offset:8192
  ds_read_b64_tr_b16 v[44:45], v141 offset:22528
  v_mfma_f32_32x32x16_bf16 v[96:111], v[72:75], v[28:31], v[96:111]
  ds_read_b64_tr_b16 v[46:47], v141 offset:23040
  ds_read_b64_tr_b16 v[48:49], v141 offset:23552
  ds_read_b64_tr_b16 v[50:51], v141 offset:24064
  v_mfma_f32_32x32x16_bf16 v[112:127], v[28:31], v[76:79], v[112:127]
  ds_read_b64_tr_b16 v[52:53], v141 offset:24576
  ds_read_b64_tr_b16 v[54:55], v141 offset:25088
  s_waitcnt vmcnt(0) lgkmcnt(0)
  s_barrier
  v_mfma_f32_32x32x16_bf16 v[80:95], v[32:35], v[16:19], v[80:95]
  ds_read_b128 v[24:27], v10 offset:8192
  ds_read_b64_tr_b16 v[56:57], v141 offset:28672
  ds_read_b64_tr_b16 v[58:59], v141 offset:29184
  v_mfma_f32_32x32x16_bf16 v[96:111], v[36:39], v[16:19], v[96:111]
  v_mfma_f32_32x32x16_bf16 v[112:127], v[16:19], v[40:43], v[112:127]
  ds_read_b64_tr_b16 v[60:61], v141 offset:29696
  ds_read_b64_tr_b16 v[62:63], v141 offset:30208
  ds_read_b64_tr_b16 v[64:65], v141 offset:30720
  v_mfma_f32_32x32x16_bf16 v[80:95], v[44:47], v[20:23], v[80:95]
  ds_read_b64_tr_b16 v[66:67], v141 offset:31232
  ds_read_b128 v[28:31], v11 offset:8192
  ds_read_b64_tr_b16 v[68:69], v141 offset:34816
  v_mfma_f32_32x32x16_bf16 v[96:111], v[48:51], v[20:23], v[96:111]
  ds_read_b64_tr_b16 v[70:71], v141 offset:35328
  ds_read_b64_tr_b16 v[72:73], v141 offset:35840
  ds_read_b64_tr_b16 v[74:75], v141 offset:36352
  v_mfma_f32_32x32x16_bf16 v[112:127], v[20:23], v[52:55], v[112:127]
  ds_read_b64_tr_b16 v[76:77], v141 offset:36864
  ds_read_b64_tr_b16 v[78:79], v141 offset:37376
  s_waitcnt lgkmcnt(0)
  v_mfma_f32_32x32x16_bf16 v[80:95], v[56:59], v[24:27], v[80:95]
  v_mfma_f32_32x32x16_bf16 v[96:111], v[60:63], v[24:27], v[96:111]
  v_mfma_f32_32x32x16_bf16 v[112:127], v[24:27], v[64:67], v[112:127]
  v_mfma_f32_32x32x16_bf16 v[80:95], v[68:71], v[28:31], v[80:95]
  v_mfma_f32_32x32x16_bf16 v[96:111], v[72:75], v[28:31], v[96:111]
  v_mfma_f32_32x32x16_bf16 v[112:127], v[28:31], v[76:79], v[112:127]
  s_cmp_lg_u32 s8, 0
  s_cbranch_scc1 wi_1_done
  s_waitcnt vmcnt(0)
  v_readfirstlane_b32 s24, v179
  s_cmp_lg_u32 s24, 0
  s_cbranch_scc1 wi_1_done
  v_mov_b32 v12, 0
  s_mov_b32 s25, 100000
  s_mov_b64 exec, 1
wi_1_poll:
  global_load_dword v13, v12, s[48:49] sc1
  s_waitcnt vmcnt(0)
  v_readfirstlane_b32 s24, v13
  s_sub_u32 s25, s25, 1
  s_cmp_eq_u32 s25, 0
  s_cbranch_scc1 wi_1_out
  s_cmp_lg_u32 s24, 0
  s_cbranch_scc1 wi_1_out
  s_sleep 8
  s_branch wi_1_poll
wi_1_out:
  s_mov_b64 exec, -1
wi_1_done:
  s_nop 7
  s_lshl_b32 s24, s9, 1
  s_and_b32 s25, s8, 1
  s_add_u32 s24, s24, s25
  s_lshl_b32 s26, s10, 1
  s_lshr_b32 s25, s8, 1
  s_add_u32 s26, s26, s25
  s_lshl_b32 s26, s26, 17
  s_lshl_b32 s25, s24, 10
  s_add_u32 s25, s25, s26
  v_lshlrev_b32 v12, 4, v0
  v_add_u32 v12, s25, v12
  v_add_u32 v13, 0x10000, v12
  s_mov_b32 s27, 1052289595
  s_add_u32 s38, s4, 2097152
  s_addc_u32 s39, s5, 0
  v_mul_f32 v80, s27, v80
  v_mul_f32 v81, s27, v81
  v_mul_f32 v82, s27, v82
  v_mul_f32 v83, s27, v83
  v_mul_f32 v84, s27, v84
  v_mul_f32 v85, s27, v85
  v_mul_f32 v86, s27, v86
  v_mul_f32 v87, s27, v87
  v_cvt_pk_bf16_f32 v148, v80, v81
  v_cvt_pk_bf16_f32 v149, v82, v83
  v_cvt_pk_bf16_f32 v150, v84, v85
  v_cvt_pk_bf16_f32 v151, v86, v87
  global_store_dwordx4 v12, v[148:151], s[4:5] sc1
  v_mul_f32 v88, s27, v88
  v_mul_f32 v89, s27, v89
  v_mul_f32 v90, s27, v90
  v_mul_f32 v91, s27, v91
  v_mul_f32 v92, s27, v92
  v_mul_f32 v93, s27, v93
  v_mul_f32 v94, s27, v94
  v_mul_f32 v95, s27, v95
  v_cvt_pk_bf16_f32 v152, v88, v89
  v_cvt_pk_bf16_f32 v153, v90, v91
  v_cvt_pk_bf16_f32 v154, v92, v93
  v_cvt_pk_bf16_f32 v155, v94, v95
  global_store_dwordx4 v13, v[152:155], s[4:5] sc1
  v_cvt_pk_bf16_f32 v156, v96, v97
  v_cvt_pk_bf16_f32 v157, v98, v99
  v_cvt_pk_bf16_f32 v158, v100, v101
  v_cvt_pk_bf16_f32 v159, v102, v103
  global_store_dwordx4 v12, v[156:159], s[38:39] sc1
  v_cvt_pk_bf16_f32 v160, v104, v105
  v_cvt_pk_bf16_f32 v161, v106, v107
  v_cvt_pk_bf16_f32 v162, v108, v109
  v_cvt_pk_bf16_f32 v163, v110, v111
  global_store_dwordx4 v13, v[160:163], s[38:39] sc1
  s_lshl_b32 s25, s24, 10
  s_add_u32 s25, s25, s26
  s_add_u32 s25, s25, 4194304
  v_bfe_u32 v14, v0, 4, 1
  v_lshlrev_b32 v14, 16, v14
  v_lshrrev_b32 v15, 5, v0
  v_lshlrev_b32 v15, 8, v15
  v_add3_u32 v14, v14, v15, s25
  v_and_b32 v15, 15, v0
  v_lshlrev_b32 v15, 4, v15
  v_add_u32 v14, v14, v15
  v_cvt_pk_bf16_f32 v164, v112, v113
  v_cvt_pk_bf16_f32 v165, v114, v115
  v_cvt_pk_bf16_f32 v166, v116, v117
  v_cvt_pk_bf16_f32 v167, v118, v119
  s_nop 1
  v_permlane32_swap_b32 v164, v166
  v_permlane32_swap_b32 v165, v167
  global_store_dwordx4 v14, v[164:167], s[4:5] sc1
  v_cvt_pk_bf16_f32 v168, v120, v121
  v_cvt_pk_bf16_f32 v169, v122, v123
  v_cvt_pk_bf16_f32 v170, v124, v125
  v_cvt_pk_bf16_f32 v171, v126, v127
  s_nop 1
  v_permlane32_swap_b32 v168, v170
  v_permlane32_swap_b32 v169, v171
  global_store_dwordx4 v14, v[168:171], s[4:5] offset:512 sc1
  s_lshl_b32 s50, s10, 3
  s_lshr_b32 s51, s9, 2
  s_add_u32 s50, s50, s51
  s_lshl_b32 s50, s50, 1
  s_waitcnt vmcnt(0)
  s_barrier
  s_cmp_lg_u32 s8, 0
  s_cbranch_scc1 sig_2
  v_add_u32 v12, s50, v0
  v_lshlrev_b32 v12, 8, v12
  v_add_u32 v12, 18939904, v12
  v_mov_b32 v13, 1
  s_mov_b64 exec, 3
  global_atomic_add v12, v13, s[4:5] sc1
  s_mov_b64 exec, -1
sig_2:
  s_setprio 1
  s_and_b32 s6, s2, 7
  s_lshl_b32 s6, s6, 2
  s_lshr_b32 s22, s2, 6
  s_add_u32 s6, s6, s22
  s_lshr_b32 s7, s2, 3
  s_and_b32 s7, s7, 7
  v_lshlrev_b32 v1, 4, v0
  v_lshrrev_b32 v13, 5, v0
  v_lshlrev_b32 v13, 8, v13
  v_and_b32 v14, 15, v0
  v_lshlrev_b32 v14, 4, v14
  v_add_u32 v2, v13, v14
  v_and_b32 v13, 16, v0
  v_cmp_eq_u32 vcc, 0, v13
  v_mov_b32 v13, 49152
  v_mov_b32 v14, 8192
  v_cndmask_b32 v13, v13, v14, vcc
  v_add_u32 v153, v13, v2
  v_mov_b32 v13, 49152
  v_mov_b32 v14, 24576
  v_cndmask_b32 v13, v13, v14, vcc
  v_add_u32 v154, v13, v2
  v_mov_b32 v13, 49152
  v_mov_b32 v14, 40960
  v_cndmask_b32 v13, v13, v14, vcc
  v_add_u32 v155, v13, v2
  v_mov_b32 v12, 0xdddddddd
  s_mov_b32 s20, 0x0000ffff
  s_mov_b32 s21, 0x0000ffff
  s_lshl_b32 s26, s6, 16
  s_waitcnt lgkmcnt(0)
  s_add_u32 s38, s4, s26
  s_addc_u32 s39, s5, 0
  s_add_u32 s34, s38, 0
  s_addc_u32 s35, s39, 0
  s_add_u32 s27, s38, 4194304
  s_addc_u32 s28, s39, 0
  s_mov_b32 s16, s27
  s_and_b32 s17, s28, 0xffff
  s_mov_b32 s18, 65536
  s_mov_b32 s19, 0x20000
  s_add_u32 s38, s38, 2097152
  s_addc_u32 s39, s39, 0
  s_mov_b32 s12, s38
  s_and_b32 s13, s39, 0xffff
  s_mov_b32 s14, 65536
  s_mov_b32 s15, 0x20000
  s_lshl_b32 s22, s8, 11
  s_lshr_b32 s26, s6, 1
  s_lshl_b32 s26, s26, 13
  s_and_b32 s27, s6, 1
  s_lshl_b32 s27, s27, 10
  s_add_u32 s26, s26, s27
  s_add_u32 s26, s26, 12582912
  s_add_u32 s36, s4, s26
  s_addc_u32 s37, s5, 0
  s_lshl_b32 s26, s7, 1
  s_lshr_b32 s27, s8, 1
  s_add_u32 s26, s26, s27
  s_lshl_b32 s26, s26, 17
  s_and_b32 s27, s8, 1
  s_lshl_b32 s27, s27, 12
  s_add_u32 s26, s26, s27
  v_add_u32 v156, s26, v1
  v_add_u32 v159, 2048, v156
  s_lshl_b32 s26, s7, 13
  s_lshl_b32 s27, s8, 11
  s_add_u32 s26, s26, s27
  v_add_u32 v13, s26, v1
  v_mov_b32 v104, 0
  v_mov_b32 v105, 0
  v_mov_b32 v106, 0
  v_mov_b32 v107, 0
  v_mov_b32 v108, 0
  v_mov_b32 v109, 0
  v_mov_b32 v110, 0
  v_mov_b32 v111, 0
  v_mov_b32 v112, 0
  v_mov_b32 v113, 0
  v_mov_b32 v114, 0
  v_mov_b32 v115, 0
  v_mov_b32 v116, 0
  v_mov_b32 v117, 0
  v_mov_b32 v118, 0
  v_mov_b32 v119, 0
  v_mov_b32 v120, 0
  v_mov_b32 v121, 0
  v_mov_b32 v122, 0
  v_mov_b32 v123, 0
  v_mov_b32 v124, 0
  v_mov_b32 v125, 0
  v_mov_b32 v126, 0
  v_mov_b32 v127, 0
  v_mov_b32 v128, 0
  v_mov_b32 v129, 0
  v_mov_b32 v130, 0
  v_mov_b32 v131, 0
  v_mov_b32 v132, 0
  v_mov_b32 v133, 0
  v_mov_b32 v134, 0
  v_mov_b32 v135, 0
  s_mov_b32 s32, 0
  v_and_b32 v13, 11, v0
  v_cmp_eq_u32 vcc, 0, v13
  v_mov_b32 v14, 0x3f803f80
  s_nop 1
  v_cndmask_b32 v136, 0, v14, vcc
  v_mov_b32 v137, v136
  v_mov_b32 v138, v136
  v_mov_b32 v139, v136
  v_add_u32 v13, s22, v1
  ds_write_b128 v13, v[136:139] offset:49152
  ds_write_b128 v13, v[136:139] offset:50176
  v_add_u32 v13, s26, v1
  s_lshr_b32 s62, s6, 2
  s_lshl_b32 s62, s62, 4
  s_and_b32 s61, s6, 1
  s_add_u32 s62, s62, s61
  v_lshlrev_b32 v158, 1, v0
  v_add_u32 v158, s62, v158
  v_lshlrev_b32 v158, 8, v158
  v_add_u32 v158, 18939904, v158
  s_mov_b32 s61, 200000
  s_cmp_lg_u32 s8, 0
  s_cbranch_scc1 cw_3_o
  s_lshl_b32 s59, 1, s7
  s_add_u32 s60, s7, 1
  s_and_b32 s60, s60, 7
  s_lshl_b32 s60, 1, s60
  s_or_b32 s59, s59, s60
cw_3:
  s_mov_b32 exec_lo, s59
  s_mov_b32 exec_hi, 0
  global_load_dword v157, v158, s[4:5] sc1
  s_waitcnt vmcnt(0)
  v_cmp_le_u32 vcc, 4, v157
  s_mov_b64 exec, -1
  s_sub_u32 s61, s61, 1
  s_and_b32 s63, vcc_lo, s59
  s_cmp_eq_u32 s61, 0
  s_cbranch_scc1 cw_3_o
  s_cmp_eq_u32 s63, s59
  s_cbranch_scc1 cw_3_o
  s_sleep 2
  s_branch cw_3
cw_3_o:
  s_barrier
  global_load_dwordx4 v[4:7], v13, s[34:35] sc1
  global_load_dwordx4 v[8:11], v13, s[34:35] offset:1024 sc1
  s_add_u32 m0, s22, 0
  s_add_u32 s25, s7, 0
  s_and_b32 s25, s25, 7
  s_lshl_b32 s25, s25, 13
  s_add_u32 s25, s25, s22
  buffer_load_dwordx4 v1, s[12:15], s25 offen sc1 lds
  buffer_load_dwordx4 v1, s[12:15], s25 offen offset:1024 sc1 lds
  s_add_u32 m0, s22, 8192
  s_nop 0
  buffer_load_dwordx4 v1, s[16:19], s25 offen sc1 lds
  buffer_load_dwordx4 v1, s[16:19], s25 offen offset:1024 sc1 lds
  s_add_u32 m0, s22, 16384
  s_add_u32 s25, s7, 1
  s_and_b32 s25, s25, 7
  s_lshl_b32 s25, s25, 13
  s_add_u32 s25, s25, s22
  buffer_load_dwordx4 v1, s[12:15], s25 offen sc1 lds
  buffer_load_dwordx4 v1, s[12:15], s25 offen offset:1024 sc1 lds
  s_add_u32 m0, s22, 24576
  s_nop 0
  buffer_load_dwordx4 v1, s[16:19], s25 offen sc1 lds
  buffer_load_dwordx4 v1, s[16:19], s25 offen offset:1024 sc1 lds
  s_cmp_eq_u32 s8, 0
  s_cselect_b32 s60, 0xff, 1
  s_mov_b32 exec_lo, s60
  s_mov_b32 exec_hi, 0
  global_load_dword v157, v158, s[4:5] sc1
  s_mov_b64 exec, -1
attn_pass:
  v_mov_b32 v72, 0
  v_mov_b32 v73, 0
  v_mov_b32 v74, 0
  v_mov_b32 v75, 0
  v_mov_b32 v76, 0
  v_mov_b32 v77, 0
  v_mov_b32 v78, 0
  v_mov_b32 v79, 0
  v_mov_b32 v80, 0
  v_mov_b32 v81, 0
  v_mov_b32 v82, 0
  v_mov_b32 v83, 0
  v_mov_b32 v84, 0
  v_mov_b32 v85, 0
  v_mov_b32 v86, 0
  v_mov_b32 v87, 0
  v_mov_b32 v88, 0
  v_mov_b32 v89, 0
  v_mov_b32 v90, 0
  v_mov_b32 v91, 0
  v_mov_b32 v92, 0
  v_mov_b32 v93, 0
  v_mov_b32 v94, 0
  v_mov_b32 v95, 0
  v_mov_b32 v96, 0
  v_mov_b32 v97, 0
  v_mov_b32 v98, 0
  v_mov_b32 v99, 0
  v_mov_b32 v100, 0
  v_mov_b32 v101, 0
  v_mov_b32 v102, 0
  v_mov_b32 v103, 0
  s_waitcnt vmcnt(5) lgkmcnt(0)
  s_barrier
  ds_read_b128 v[20:23], v1 offset:0
  ds_read_b128 v[32:35], v153 offset:512
  ds_read_b128 v[16:19], v1 offset:1024
  ds_read_b128 v[24:27], v153 offset:0
  s_waitcnt lgkmcnt(3)
  v_mfma_f32_32x32x16_bf16 v[40:55], v[20:23], v[4:7], v[104:119]
  s_nop 7
  s_nop 3
  v_exp_f32 v40, v40
  v_exp_f32 v41, v41
  v_exp_f32 v42, v42
  v_exp_f32 v43, v43
  ds_read_b128 v[36:39], v153 offset:1536
  v_exp_f32 v44, v44
  v_exp_f32 v45, v45
  v_exp_f32 v46, v46
  v_mfma_f32_32x32x16_bf16 v[56:71], v[20:23], v[8:11], v[120:135]
  ds_read_b128 v[20:23], v1 offset:2048
  v_exp_f32 v47, v47
  v_exp_f32 v48, v48
  v_exp_f32 v49, v49
  s_waitcnt lgkmcnt(2)
  v_smfmac_f32_32x32x32_bf16 v[72:87], v[24:27], v[40:47], v12
  ds_read_b128 v[28:31], v153 offset:1024
  v_exp_f32 v50, v50
  v_exp_f32 v51, v51
  v_exp_f32 v52, v52
  v_exp_f32 v53, v53
  v_exp_f32 v54, v54
  v_exp_f32 v55, v55
  v_exp_f32 v56, v56
  v_exp_f32 v57, v57
  v_exp_f32 v58, v58
  v_exp_f32 v59, v59
  v_smfmac_f32_32x32x32_bf16 v[72:87], v[32:35], v[48:55], v12
  v_exp_f32 v60, v60
  v_exp_f32 v61, v61
  v_exp_f32 v62, v62
  v_mfma_f32_32x32x16_bf16 v[40:55], v[16:19], v[4:7], v[104:119]
  v_exp_f32 v63, v63
  v_exp_f32 v64, v64
  v_exp_f32 v65, v65
  v_smfmac_f32_32x32x32_bf16 v[88:103], v[24:27], v[56:63], v12
  v_exp_f32 v66, v66
  v_exp_f32 v67, v67
  v_exp_f32 v68, v68
  v_exp_f32 v69, v69
  v_exp_f32 v70, v70
  v_exp_f32 v71, v71
  v_exp_f32 v40, v40
  v_exp_f32 v41, v41
  v_exp_f32 v42, v42
  v_exp_f32 v43, v43
  v_smfmac_f32_32x32x32_bf16 v[88:103], v[32:35], v[64:71], v12
  ds_read_b128 v[32:35], v153 offset:2560
  v_exp_f32 v44, v44
  v_exp_f32 v45, v45
  v_exp_f32 v46, v46
  v_mfma_f32_32x32x16_bf16 v[56:71], v[16:19], v[8:11], v[120:135]
  ds_read_b128 v[16:19], v1 offset:3072
  v_exp_f32 v47, v47
  v_exp_f32 v48, v48
  v_exp_f32 v49, v49
  s_waitcnt lgkmcnt(2)
  v_smfmac_f32_32x32x32_bf16 v[72:87], v[28:31], v[40:47], v12
  ds_read_b128 v[24:27], v153 offset:2048
  v_exp_f32 v50, v50
  v_exp_f32 v51, v51
  v_exp_f32 v52, v52
  v_exp_f32 v53, v53
  v_exp_f32 v54, v54
  v_exp_f32 v55, v55
  v_exp_f32 v56, v56
  v_exp_f32 v57, v57
  v_exp_f32 v58, v58
  v_exp_f32 v59, v59
  v_smfmac_f32_32x32x32_bf16 v[72:87], v[36:39], v[48:55], v12
  v_exp_f32 v60, v60
  v_exp_f32 v61, v61
  v_exp_f32 v62, v62
  v_mfma_f32_32x32x16_bf16 v[40:55], v[20:23], v[4:7], v[104:119]
  v_exp_f32 v63, v63
  v_exp_f32 v64, v64
  v_exp_f32 v65, v65
  v_smfmac_f32_32x32x32_bf16 v[88:103], v[28:31], v[56:63], v12
  v_exp_f32 v66, v66
  v_exp_f32 v67, v67
  v_exp_f32 v68, v68
  v_exp_f32 v69, v69
  v_exp_f32 v70, v70
  v_exp_f32 v71, v71
  v_exp_f32 v40, v40
  v_exp_f32 v41, v41
  v_exp_f32 v42, v42
  v_exp_f32 v43, v43
  v_smfmac_f32_32x32x32_bf16 v[88:103], v[36:39], v[64:71], v12
  ds_read_b128 v[36:39], v153 offset:3584
  v_exp_f32 v44, v44
  v_exp_f32 v45, v45
  v_exp_f32 v46, v46
  v_mfma_f32_32x32x16_bf16 v[56:71], v[20:23], v[8:11], v[120:135]
  ds_read_b128 v[20:23], v1 offset:4096
  v_exp_f32 v47, v47
  v_exp_f32 v48, v48
  v_exp_f32 v49, v49
  s_waitcnt lgkmcnt(2)
  v_smfmac_f32_32x32x32_bf16 v[72:87], v[24:27], v[40:47], v12
  ds_read_b128 v[28:31], v153 offset:3072
  v_exp_f32 v50, v50
  v_exp_f32 v51, v51
  v_exp_f32 v52, v52
  v_exp_f32 v53, v53
  v_exp_f32 v54, v54
  v_exp_f32 v55, v55
  v_exp_f32 v56, v56
  v_exp_f32 v57, v57
  v_exp_f32 v58, v58
  v_exp_f32 v59, v59
  v_smfmac_f32_32x32x32_bf16 v[72:87], v[32:35], v[48:55], v12
  v_exp_f32 v60, v60
  v_exp_f32 v61, v61
  v_exp_f32 v62, v62
  v_mfma_f32_32x32x16_bf16 v[40:55], v[16:19], v[4:7], v[104:119]
  v_exp_f32 v63, v63
  v_exp_f32 v64, v64
  v_exp_f32 v65, v65
  v_smfmac_f32_32x32x32_bf16 v[88:103], v[24:27], v[56:63], v12
  v_exp_f32 v66, v66
  v_exp_f32 v67, v67
  v_exp_f32 v68, v68
  v_exp_f32 v69, v69
  v_exp_f32 v70, v70
  v_exp_f32 v71, v71
  v_exp_f32 v40, v40
  v_exp_f32 v41, v41
  v_exp_f32 v42, v42
  v_exp_f32 v43, v43
  v_smfmac_f32_32x32x32_bf16 v[88:103], v[32:35], v[64:71], v12
  ds_read_b128 v[32:35], v153 offset:4608
  v_exp_f32 v44, v44
  v_exp_f32 v45, v45
  v_exp_f32 v46, v46
  v_mfma_f32_32x32x16_bf16 v[56:71], v[16:19], v[8:11], v[120:135]
  ds_read_b128 v[16:19], v1 offset:5120
  v_exp_f32 v47, v47
  v_exp_f32 v48, v48
  v_exp_f32 v49, v49
  s_waitcnt lgkmcnt(2)
  v_smfmac_f32_32x32x32_bf16 v[72:87], v[28:31], v[40:47], v12
  ds_read_b128 v[24:27], v153 offset:4096
  v_exp_f32 v50, v50
  v_exp_f32 v51, v51
  v_exp_f32 v52, v52
  v_exp_f32 v53, v53
  v_exp_f32 v54, v54
  v_exp_f32 v55, v55
  v_exp_f32 v56, v56
  v_exp_f32 v57, v57
  v_exp_f32 v58, v58
  v_exp_f32 v59, v59
  v_smfmac_f32_32x32x32_bf16 v[72:87], v[36:39], v[48:55], v12
  v_exp_f32 v60, v60
  v_exp_f32 v61, v61
  v_exp_f32 v62, v62
  v_mfma_f32_32x32x16_bf16 v[40:55], v[20:23], v[4:7], v[104:119]
  v_exp_f32 v63, v63
  v_exp_f32 v64, v64
  v_exp_f32 v65, v65
  v_smfmac_f32_32x32x32_bf16 v[88:103], v[28:31], v[56:63], v12
  v_exp_f32 v66, v66
  v_exp_f32 v67, v67
  v_exp_f32 v68, v68
  v_exp_f32 v69, v69
  v_exp_f32 v70, v70
  v_exp_f32 v71, v71
  v_exp_f32 v40, v40
  v_exp_f32 v41, v41
  v_exp_f32 v42, v42
  v_exp_f32 v43, v43
  v_smfmac_f32_32x32x32_bf16 v[88:103], v[36:39], v[64:71], v12
  ds_read_b128 v[36:39], v153 offset:5632
  v_exp_f32 v44, v44
  v_exp_f32 v45, v45
  v_exp_f32 v46, v46
  v_mfma_f32_32x32x16_bf16 v[56:71], v[20:23], v[8:11], v[120:135]
  ds_read_b128 v[20:23], v1 offset:6144
  v_exp_f32 v47, v47
  v_exp_f32 v48, v48
  v_exp_f32 v49, v49
  s_waitcnt lgkmcnt(2)
  v_smfmac_f32_32x32x32_bf16 v[72:87], v[24:27], v[40:47], v12
  ds_read_b128 v[28:31], v153 offset:5120
  v_exp_f32 v50, v50
  v_exp_f32 v51, v51
  v_exp_f32 v52, v52
  v_exp_f32 v53, v53
  v_exp_f32 v54, v54
  v_exp_f32 v55, v55
  v_exp_f32 v56, v56
  v_exp_f32 v57, v57
  v_exp_f32 v58, v58
  v_exp_f32 v59, v59
  v_smfmac_f32_32x32x32_bf16 v[72:87], v[32:35], v[48:55], v12
  v_exp_f32 v60, v60
  v_exp_f32 v61, v61
  v_exp_f32 v62, v62
  v_mfma_f32_32x32x16_bf16 v[40:55], v[16:19], v[4:7], v[104:119]
  s_waitcnt vmcnt(0)
  s_cmp_lg_u32 s8, 0
  s_cbranch_scc1 ca_4_o
ca_4:
  v_cmp_le_u32 vcc, 4, v157
  s_nop 0
  s_and_b32 s60, vcc_lo, 0xff
  s_cmp_eq_u32 s60, 0xff
  s_cbranch_scc1 ca_4_o
  s_mov_b64 exec, 0xff
  global_load_dword v157, v158, s[4:5] sc1
  s_mov_b64 exec, -1
  s_sub_u32 s61, s61, 1
  s_waitcnt vmcnt(0)
  s_cmp_lg_u32 s61, 0
  s_cbranch_scc1 ca_4
ca_4_o:
  s_barrier
  v_exp_f32 v63, v63
  v_exp_f32 v64, v64
  v_exp_f32 v65, v65
  v_smfmac_f32_32x32x32_bf16 v[88:103], v[24:27], v[56:63], v12
  s_add_u32 m0, s22, 32768
  s_add_u32 s25, s7, 2
  s_and_b32 s25, s25, 7
  s_lshl_b32 s25, s25, 13
  s_add_u32 s25, s25, s22
  buffer_load_dwordx4 v1, s[12:15], s25 offen sc1 lds
  buffer_load_dwordx4 v1, s[12:15], s25 offen offset:1024 sc1 lds
  s_add_u32 m0, s22, 40960
  s_nop 0
  buffer_load_dwordx4 v1, s[16:19], s25 offen sc1 lds
  buffer_load_dwordx4 v1, s[16:19], s25 offen offset:1024 sc1 lds
  v_exp_f32 v66, v66
  v_exp_f32 v67, v67
  v_exp_f32 v68, v68
  v_exp_f32 v69, v69
  v_exp_f32 v70, v70
  v_exp_f32 v71, v71
  v_exp_f32 v40, v40
  v_exp_f32 v41, v41
  v_exp_f32 v42, v42
  v_exp_f32 v43, v43
  v_smfmac_f32_32x32x32_bf16 v[88:103], v[32:35], v[64:71], v12
  ds_read_b128 v[32:35], v153 offset:6656
  v_exp_f32 v44, v44
  v_exp_f32 v45, v45
  v_exp_f32 v46, v46
  v_mfma_f32_32x32x16_bf16 v[56:71], v[16:19], v[8:11], v[120:135]
  ds_read_b128 v[16:19], v1 offset:7168
  v_exp_f32 v47, v47
  v_exp_f32 v48, v48
  v_exp_f32 v49, v49
  s_waitcnt lgkmcnt(2)
  v_smfmac_f32_32x32x32_bf16 v[72:87], v[28:31], v[40:47], v12
  ds_read_b128 v[24:27], v153 offset:6144
  v_exp_f32 v50, v50
  v_exp_f32 v51, v51
  v_exp_f32 v52, v52
  v_exp_f32 v53, v53
  v_exp_f32 v54, v54
  v_exp_f32 v55, v55
  v_exp_f32 v56, v56
  v_exp_f32 v57, v57
  v_exp_f32 v58, v58
  v_exp_f32 v59, v59
  v_smfmac_f32_32x32x32_bf16 v[72:87], v[36:39], v[48:55], v12
  v_exp_f32 v60, v60
  v_exp_f32 v61, v61
  v_exp_f32 v62, v62
  v_mfma_f32_32x32x16_bf16 v[40:55], v[20:23], v[4:7], v[104:119]
  v_exp_f32 v63, v63
  v_exp_f32 v64, v64
  v_exp_f32 v65, v65
  v_smfmac_f32_32x32x32_bf16 v[88:103], v[28:31], v[56:63], v12
  v_exp_f32 v66, v66
  v_exp_f32 v67, v67
  v_exp_f32 v68, v68
  v_exp_f32 v69, v69
  v_exp_f32 v70, v70
  v_exp_f32 v71, v71
  v_exp_f32 v40, v40
  v_exp_f32 v41, v41
  v_exp_f32 v42, v42
  v_exp_f32 v43, v43
  v_smfmac_f32_32x32x32_bf16 v[88:103], v[36:39], v[64:71], v12
  ds_read_b128 v[36:39], v153 offset:7680
  v_exp_f32 v44, v44
  v_exp_f32 v45, v45
  v_exp_f32 v46, v46
  v_mfma_f32_32x32x16_bf16 v[56:71], v[20:23], v[8:11], v[120:135]
  ds_read_b128 v[20:23], v1 offset:16384
  v_exp_f32 v47, v47
  v_exp_f32 v48, v48
  v_exp_f32 v49, v49
  s_waitcnt lgkmcnt(2)
  v_smfmac_f32_32x32x32_bf16 v[72:87], v[24:27], v[40:47], v12
  ds_read_b128 v[28:31], v153 offset:7168
  v_exp_f32 v50, v50
  v_exp_f32 v51, v51
  v_exp_f32 v52, v52
  v_exp_f32 v53, v53
  v_exp_f32 v54, v54
  v_exp_f32 v55, v55
  v_exp_f32 v56, v56
  v_exp_f32 v57, v57
  v_exp_f32 v58, v58
  v_exp_f32 v59, v59
  v_smfmac_f32_32x32x32_bf16 v[72:87], v[32:35], v[48:55], v12
  v_exp_f32 v60, v60
  v_exp_f32 v61, v61
  v_exp_f32 v62, v62
  v_mfma_f32_32x32x16_bf16 v[40:55], v[16:19], v[4:7], v[104:119]
  v_exp_f32 v63, v63
  v_exp_f32 v64, v64
  v_exp_f32 v65, v65
  v_smfmac_f32_32x32x32_bf16 v[88:103], v[24:27], v[56:63], v12
  v_exp_f32 v66, v66
  v_exp_f32 v67, v67
  v_exp_f32 v68, v68
  v_exp_f32 v69, v69
  v_exp_f32 v70, v70
  v_exp_f32 v71, v71
  v_exp_f32 v40, v40
  v_exp_f32 v41, v41
  v_exp_f32 v42, v42
  v_exp_f32 v43, v43
  v_smfmac_f32_32x32x32_bf16 v[88:103], v[32:35], v[64:71], v12
  ds_read_b128 v[32:35], v154 offset:512
  v_exp_f32 v44, v44
  v_exp_f32 v45, v45
  v_exp_f32 v46, v46
  v_mfma_f32_32x32x16_bf16 v[56:71], v[16:19], v[8:11], v[120:135]
  ds_read_b128 v[16:19], v1 offset:17408
  v_exp_f32 v47, v47
  v_exp_f32 v48, v48
  v_exp_f32 v49, v49
  s_waitcnt lgkmcnt(2)
  v_smfmac_f32_32x32x32_bf16 v[72:87], v[28:31], v[40:47], v12
  ds_read_b128 v[24:27], v154 offset:0
  v_exp_f32 v50, v50
  v_exp_f32 v51, v51
  v_exp_f32 v52, v52
  v_exp_f32 v53, v53
  v_exp_f32 v54, v54
  v_exp_f32 v55, v55
  v_exp_f32 v56, v56
  v_exp_f32 v57, v57
  v_exp_f32 v58, v58
  v_exp_f32 v59, v59
  v_smfmac_f32_32x32x32_bf16 v[72:87], v[36:39], v[48:55], v12
  v_exp_f32 v60, v60
  v_exp_f32 v61, v61
  v_exp_f32 v62, v62
  v_mfma_f32_32x32x16_bf16 v[40:55], v[20:23], v[4:7], v[104:119]
  v_exp_f32 v63, v63
  v_exp_f32 v64, v64
  v_exp_f32 v65, v65
  v_smfmac_f32_32x32x32_bf16 v[88:103], v[28:31], v[56:63], v12
  v_exp_f32 v66, v66
  v_exp_f32 v67, v67
  v_exp_f32 v68, v68
  v_exp_f32 v69, v69
  v_exp_f32 v70, v70
  v_exp_f32 v71, v71
  v_exp_f32 v40, v40
  v_exp_f32 v41, v41
  v_exp_f32 v42, v42
  v_exp_f32 v43, v43
  v_smfmac_f32_32x32x32_bf16 v[88:103], v[36:39], v[64:71], v12
  ds_read_b128 v[36:39], v154 offset:1536
  v_exp_f32 v44, v44
  v_exp_f32 v45, v45
  v_exp_f32 v46, v46
  v_mfma_f32_32x32x16_bf16 v[56:71], v[20:23], v[8:11], v[120:135]
  ds_read_b128 v[20:23], v1 offset:18432
  v_exp_f32 v47, v47
  v_exp_f32 v48, v48
  v_exp_f32 v49, v49
  s_waitcnt lgkmcnt(2)
  v_smfmac_f32_32x32x32_bf16 v[72:87], v[24:27], v[40:47], v12
  ds_read_b128 v[28:31], v154 offset:1024
  v_exp_f32 v50, v50
  v_exp_f32 v51, v51
  v_exp_f32 v52, v52
  v_exp_f32 v53, v53
  v_exp_f32 v54, v54
  v_exp_f32 v55, v55
  v_exp_f32 v56, v56
  v_exp_f32 v57, v57
  v_exp_f32 v58, v58
  v_exp_f32 v59, v59
  v_smfmac_f32_32x32x32_bf16 v[72:87], v[32:35], v[48:55], v12
  v_exp_f32 v60, v60
  v_exp_f32 v61, v61
  v_exp_f32 v62, v62
  v_mfma_f32_32x32x16_bf16 v[40:55], v[16:19], v[4:7], v[104:119]
  v_exp_f32 v63, v63
  v_exp_f32 v64, v64
  v_exp_f32 v65, v65
  v_smfmac_f32_32x32x32_bf16 v[88:103], v[24:27], v[56:63], v12
  v_exp_f32 v66, v66
  v_exp_f32 v67, v67
  v_exp_f32 v68, v68
  v_exp_f32 v69, v69
  v_exp_f32 v70, v70
  v_exp_f32 v71, v71
  v_exp_f32 v40, v40
  v_exp_f32 v41, v41
  v_exp_f32 v42, v42
  v_exp_f32 v43, v43
  v_smfmac_f32_32x32x32_bf16 v[88:103], v[32:35], v[64:71], v12
  ds_read_b128 v[32:35], v154 offset:2560
  v_exp_f32 v44, v44
  v_exp_f32 v45, v45
  v_exp_f32 v46, v46
  v_mfma_f32_32x32x16_bf16 v[56:71], v[16:19], v[8:11], v[120:135]
  ds_read_b128 v[16:19], v1 offset:19456
  v_exp_f32 v47, v47
  v_exp_f32 v48, v48
  v_exp_f32 v49, v49
  s_waitcnt lgkmcnt(2)
  v_smfmac_f32_32x32x32_bf16 v[72:87], v[28:31], v[40:47], v12
  ds_read_b128 v[24:27], v154 offset:2048
  v_exp_f32 v50, v50
  v_exp_f32 v51, v51
  v_exp_f32 v52, v52
  v_exp_f32 v53, v53
  v_exp_f32 v54, v54
  v_exp_f32 v55, v55
  v_exp_f32 v56, v56
  v_exp_f32 v57, v57
  v_exp_f32 v58, v58
  v_exp_f32 v59, v59
  v_smfmac_f32_32x32x32_bf16 v[72:87], v[36:39], v[48:55], v12
  v_exp_f32 v60, v60
  v_exp_f32 v61, v61
  v_exp_f32 v62, v62
  v_mfma_f32_32x32x16_bf16 v[40:55], v[20:23], v[4:7], v[104:119]
  v_exp_f32 v63, v63
  v_exp_f32 v64, v64
  v_exp_f32 v65, v65
  v_smfmac_f32_32x32x32_bf16 v[88:103], v[28:31], v[56:63], v12
  v_exp_f32 v66, v66
  v_exp_f32 v67, v67
  v_exp_f32 v68, v68
  v_exp_f32 v69, v69
  v_exp_f32 v70, v70
  v_exp_f32 v71, v71
  v_exp_f32 v40, v40
  v_exp_f32 v41, v41
  v_exp_f32 v42, v42
  v_exp_f32 v43, v43
  v_smfmac_f32_32x32x32_bf16 v[88:103], v[36:39], v[64:71], v12
  ds_read_b128 v[36:39], v154 offset:3584
  v_exp_f32 v44, v44
  v_exp_f32 v45, v45
  v_exp_f32 v46, v46
  v_mfma_f32_32x32x16_bf16 v[56:71], v[20:23], v[8:11], v[120:135]
  ds_read_b128 v[20:23], v1 offset:20480
  v_exp_f32 v47, v47
  v_exp_f32 v48, v48
  v_exp_f32 v49, v49
  s_waitcnt lgkmcnt(2)
  v_smfmac_f32_32x32x32_bf16 v[72:87], v[24:27], v[40:47], v12
  ds_read_b128 v[28:31], v154 offset:3072
  v_exp_f32 v50, v50
  v_exp_f32 v51, v51
  v_exp_f32 v52, v52
  v_exp_f32 v53, v53
  v_exp_f32 v54, v54
  v_exp_f32 v55, v55
  v_exp_f32 v56, v56
  v_exp_f32 v57, v57
  v_exp_f32 v58, v58
  v_exp_f32 v59, v59
  v_smfmac_f32_32x32x32_bf16 v[72:87], v[32:35], v[48:55], v12
  v_exp_f32 v60, v60
  v_exp_f32 v61, v61
  v_exp_f32 v62, v62
  v_mfma_f32_32x32x16_bf16 v[40:55], v[16:19], v[4:7], v[104:119]
  v_exp_f32 v63, v63
  v_exp_f32 v64, v64
  v_exp_f32 v65, v65
  v_smfmac_f32_32x32x32_bf16 v[88:103], v[24:27], v[56:63], v12
  v_exp_f32 v66, v66
  v_exp_f32 v67, v67
  v_exp_f32 v68, v68
  v_exp_f32 v69, v69
  v_exp_f32 v70, v70
  v_exp_f32 v71, v71
  v_exp_f32 v40, v40
  v_exp_f32 v41, v41
  v_exp_f32 v42, v42
  v_exp_f32 v43, v43
  v_smfmac_f32_32x32x32_bf16 v[88:103], v[32:35], v[64:71], v12
  ds_read_b128 v[32:35], v154 offset:4608
  v_exp_f32 v44, v44
  v_exp_f32 v45, v45
  v_exp_f32 v46, v46
  v_mfma_f32_32x32x16_bf16 v[56:71], v[16:19], v[8:11], v[120:135]
  ds_read_b128 v[16:19], v1 offset:21504
  v_exp_f32 v47, v47
  v_exp_f32 v48, v48
  v_exp_f32 v49, v49
  s_waitcnt lgkmcnt(2)
  v_smfmac_f32_32x32x32_bf16 v[72:87], v[28:31], v[40:47], v12
  ds_read_b128 v[24:27], v154 offset:4096
  v_exp_f32 v50, v50
  v_exp_f32 v51, v51
  v_exp_f32 v52, v52
  v_exp_f32 v53, v53
  v_exp_f32 v54, v54
  v_exp_f32 v55, v55
  v_exp_f32 v56, v56
  v_exp_f32 v57, v57
  v_exp_f32 v58, v58
  v_exp_f32 v59, v59
  v_smfmac_f32_32x32x32_bf16 v[72:87], v[36:39], v[48:55], v12
  v_exp_f32 v60, v60
  v_exp_f32 v61, v61
  v_exp_f32 v62, v62
  v_mfma_f32_32x32x16_bf16 v[40:55], v[20:23], v[4:7], v[104:119]
  v_exp_f32 v63, v63
  v_exp_f32 v64, v64
  v_exp_f32 v65, v65
  v_smfmac_f32_32x32x32_bf16 v[88:103], v[28:31], v[56:63], v12
  v_exp_f32 v66, v66
  v_exp_f32 v67, v67
  v_exp_f32 v68, v68
  v_exp_f32 v69, v69
  v_exp_f32 v70, v70
  v_exp_f32 v71, v71
  v_exp_f32 v40, v40
  v_exp_f32 v41, v41
  v_exp_f32 v42, v42
  v_exp_f32 v43, v43
  v_smfmac_f32_32x32x32_bf16 v[88:103], v[36:39], v[64:71], v12
  ds_read_b128 v[36:39], v154 offset:5632
  v_exp_f32 v44, v44
  v_exp_f32 v45, v45
  v_exp_f32 v46, v46
  v_mfma_f32_32x32x16_bf16 v[56:71], v[20:23], v[8:11], v[120:135]
  ds_read_b128 v[20:23], v1 offset:22528
  v_exp_f32 v47, v47
  v_exp_f32 v48, v48
  v_exp_f32 v49, v49
  s_waitcnt lgkmcnt(2)
  v_smfmac_f32_32x32x32_bf16 v[72:87], v[24:27], v[40:47], v12
  ds_read_b128 v[28:31], v154 offset:5120
  v_exp_f32 v50, v50
  v_exp_f32 v51, v51
  v_exp_f32 v52, v52
  v_exp_f32 v53, v53
  v_exp_f32 v54, v54
  v_exp_f32 v55, v55
  v_exp_f32 v56, v56
  v_exp_f32 v57, v57
  v_exp_f32 v58, v58
  v_exp_f32 v59, v59
  v_smfmac_f32_32x32x32_bf16 v[72:87], v[32:35], v[48:55], v12
  v_exp_f32 v60, v60
  v_exp_f32 v61, v61
  v_exp_f32 v62, v62
  v_mfma_f32_32x32x16_bf16 v[40:55], v[16:19], v[4:7], v[104:119]
  s_waitcnt vmcnt(0)
  s_barrier
  v_exp_f32 v63, v63
  v_exp_f32 v64, v64
  v_exp_f32 v65, v65
  v_smfmac_f32_32x32x32_bf16 v[88:103], v[24:27], v[56:63], v12
  s_add_u32 m0, s22, 0
  s_add_u32 s25, s7, 3
  s_and_b32 s25, s25, 7
  s_lshl_b32 s25, s25, 13
  s_add_u32 s25, s25, s22
  buffer_load_dwordx4 v1, s[12:15], s25 offen sc1 lds
  buffer_load_dwordx4 v1, s[12:15], s25 offen offset:1024 sc1 lds
  s_add_u32 m0, s22, 8192
  s_nop 0
  buffer_load_dwordx4 v1, s[16:19], s25 offen sc1 lds
  buffer_load_dwordx4 v1, s[16:19], s25 offen offset:1024 sc1 lds
  v_exp_f32 v66, v66
  v_exp_f32 v67, v67
  v_exp_f32 v68, v68
  v_exp_f32 v69, v69
  v_exp_f32 v70, v70
  v_exp_f32 v71, v71
  v_exp_f32 v40, v40
  v_exp_f32 v41, v41
  v_exp_f32 v42, v42
  v_exp_f32 v43, v43
  v_smfmac_f32_32x32x32_bf16 v[88:103], v[32:35], v[64:71], v12
  ds_read_b128 v[32:35], v154 offset:6656
  v_exp_f32 v44, v44
  v_exp_f32 v45, v45
  v_exp_f32 v46, v46
  v_mfma_f32_32x32x16_bf16 v[56:71], v[16:19], v[8:11], v[120:135]
  ds_read_b128 v[16:19], v1 offset:23552
  v_exp_f32 v47, v47
  v_exp_f32 v48, v48
  v_exp_f32 v49, v49
  s_waitcnt lgkmcnt(2)
  v_smfmac_f32_32x32x32_bf16 v[72:87], v[28:31], v[40:47], v12
  ds_read_b128 v[24:27], v154 offset:6144
  v_exp_f32 v50, v50
  v_exp_f32 v51, v51
  v_exp_f32 v52, v52
  v_exp_f32 v53, v53
  v_exp_f32 v54, v54
  v_exp_f32 v55, v55
  v_exp_f32 v56, v56
  v_exp_f32 v57, v57
  v_exp_f32 v58, v58
  v_exp_f32 v59, v59
  v_smfmac_f32_32x32x32_bf16 v[72:87], v[36:39], v[48:55], v12
  v_exp_f32 v60, v60
  v_exp_f32 v61, v61
  v_exp_f32 v62, v62
  v_mfma_f32_32x32x16_bf16 v[40:55], v[20:23], v[4:7], v[104:119]
  v_exp_f32 v63, v63
  v_exp_f32 v64, v64
  v_exp_f32 v65, v65
  v_smfmac_f32_32x32x32_bf16 v[88:103], v[28:31], v[56:63], v12
  v_exp_f32 v66, v66
  v_exp_f32 v67, v67
  v_exp_f32 v68, v68
  v_exp_f32 v69, v69
  v_exp_f32 v70, v70
  v_exp_f32 v71, v71
  v_exp_f32 v40, v40
  v_exp_f32 v41, v41
  v_exp_f32 v42, v42
  v_exp_f32 v43, v43
  v_smfmac_f32_32x32x32_bf16 v[88:103], v[36:39], v[64:71], v12
  ds_read_b128 v[36:39], v154 offset:7680
  v_exp_f32 v44, v44
  v_exp_f32 v45, v45
  v_exp_f32 v46, v46
  v_mfma_f32_32x32x16_bf16 v[56:71], v[20:23], v[8:11], v[120:135]
  ds_read_b128 v[20:23], v1 offset:32768
  v_exp_f32 v47, v47
  v_exp_f32 v48, v48
  v_exp_f32 v49, v49
  s_waitcnt lgkmcnt(2)
  v_smfmac_f32_32x32x32_bf16 v[72:87], v[24:27], v[40:47], v12
  ds_read_b128 v[28:31], v154 offset:7168
  v_exp_f32 v50, v50
  v_exp_f32 v51, v51
  v_exp_f32 v52, v52
  v_exp_f32 v53, v53
  v_exp_f32 v54, v54
  v_exp_f32 v55, v55
  v_exp_f32 v56, v56
  v_exp_f32 v57, v57
  v_exp_f32 v58, v58
  v_exp_f32 v59, v59
  v_smfmac_f32_32x32x32_bf16 v[72:87], v[32:35], v[48:55], v12
  v_exp_f32 v60, v60
  v_exp_f32 v61, v61
  v_exp_f32 v62, v62
  v_mfma_f32_32x32x16_bf16 v[40:55], v[16:19], v[4:7], v[104:119]
  v_exp_f32 v63, v63
  v_exp_f32 v64, v64
  v_exp_f32 v65, v65
  v_smfmac_f32_32x32x32_bf16 v[88:103], v[24:27], v[56:63], v12
  v_exp_f32 v66, v66
  v_exp_f32 v67, v67
  v_exp_f32 v68, v68
  v_exp_f32 v69, v69
  v_exp_f32 v70, v70
  v_exp_f32 v71, v71
  v_exp_f32 v40, v40
  v_exp_f32 v41, v41
  v_exp_f32 v42, v42
  v_exp_f32 v43, v43
  v_smfmac_f32_32x32x32_bf16 v[88:103], v[32:35], v[64:71], v12
  ds_read_b128 v[32:35], v155 offset:512
  v_exp_f32 v44, v44
  v_exp_f32 v45, v45
  v_exp_f32 v46, v46
  v_mfma_f32_32x32x16_bf16 v[56:71], v[16:19], v[8:11], v[120:135]
  ds_read_b128 v[16:19], v1 offset:33792
  v_exp_f32 v47, v47
  v_exp_f32 v48, v48
  v_exp_f32 v49, v49
  s_waitcnt lgkmcnt(2)
  v_smfmac_f32_32x32x32_bf16 v[72:87], v[28:31], v[40:47], v12
  ds_read_b128 v[24:27], v155 offset:0
  v_exp_f32 v50, v50
  v_exp_f32 v51, v51
  v_exp_f32 v52, v52
  v_exp_f32 v53, v53
  v_exp_f32 v54, v54
  v_exp_f32 v55, v55
  v_exp_f32 v56, v56
  v_exp_f32 v57, v57
  v_exp_f32 v58, v58
  v_exp_f32 v59, v59
  v_smfmac_f32_32x32x32_bf16 v[72:87], v[36:39], v[48:55], v12
  v_exp_f32 v60, v60
  v_exp_f32 v61, v61
  v_exp_f32 v62, v62
  v_mfma_f32_32x32x16_bf16 v[40:55], v[20:23], v[4:7], v[104:119]
  v_exp_f32 v63, v63
  v_exp_f32 v64, v64
  v_exp_f32 v65, v65
  v_smfmac_f32_32x32x32_bf16 v[88:103], v[28:31], v[56:63], v12
  v_exp_f32 v66, v66
  v_exp_f32 v67, v67
  v_exp_f32 v68, v68
  v_exp_f32 v69, v69
  v_exp_f32 v70, v70
  v_exp_f32 v71, v71
  v_exp_f32 v40, v40
  v_exp_f32 v41, v41
  v_exp_f32 v42, v42
  v_exp_f32 v43, v43
  v_smfmac_f32_32x32x32_bf16 v[88:103], v[36:39], v[64:71], v12
  ds_read_b128 v[36:39], v155 offset:1536
  v_exp_f32 v44, v44
  v_exp_f32 v45, v45
  v_exp_f32 v46, v46
  v_mfma_f32_32x32x16_bf16 v[56:71], v[20:23], v[8:11], v[120:135]
  ds_read_b128 v[20:23], v1 offset:34816
  v_exp_f32 v47, v47
  v_exp_f32 v48, v48
  v_exp_f32 v49, v49
  s_waitcnt lgkmcnt(2)
  v_smfmac_f32_32x32x32_bf16 v[72:87], v[24:27], v[40:47], v12
  ds_read_b128 v[28:31], v155 offset:1024
  v_exp_f32 v50, v50
  v_exp_f32 v51, v51
  v_exp_f32 v52, v52
  v_exp_f32 v53, v53
  v_exp_f32 v54, v54
  v_exp_f32 v55, v55
  v_exp_f32 v56, v56
  v_exp_f32 v57, v57
  v_exp_f32 v58, v58
  v_exp_f32 v59, v59
  v_smfmac_f32_32x32x32_bf16 v[72:87], v[32:35], v[48:55], v12
  v_exp_f32 v60, v60
  v_exp_f32 v61, v61
  v_exp_f32 v62, v62
  v_mfma_f32_32x32x16_bf16 v[40:55], v[16:19], v[4:7], v[104:119]
  v_exp_f32 v63, v63
  v_exp_f32 v64, v64
  v_exp_f32 v65, v65
  v_smfmac_f32_32x32x32_bf16 v[88:103], v[24:27], v[56:63], v12
  v_exp_f32 v66, v66
  v_exp_f32 v67, v67
  v_exp_f32 v68, v68
  v_exp_f32 v69, v69
  v_exp_f32 v70, v70
  v_exp_f32 v71, v71
  v_exp_f32 v40, v40
  v_exp_f32 v41, v41
  v_exp_f32 v42, v42
  v_exp_f32 v43, v43
  v_smfmac_f32_32x32x32_bf16 v[88:103], v[32:35], v[64:71], v12
  ds_read_b128 v[32:35], v155 offset:2560
  v_exp_f32 v44, v44
  v_exp_f32 v45, v45
  v_exp_f32 v46, v46
  v_mfma_f32_32x32x16_bf16 v[56:71], v[16:19], v[8:11], v[120:135]
  ds_read_b128 v[16:19], v1 offset:35840
  v_exp_f32 v47, v47
  v_exp_f32 v48, v48
  v_exp_f32 v49, v49
  s_waitcnt lgkmcnt(2)
  v_smfmac_f32_32x32x32_bf16 v[72:87], v[28:31], v[40:47], v12
  ds_read_b128 v[24:27], v155 offset:2048
  v_exp_f32 v50, v50
  v_exp_f32 v51, v51
  v_exp_f32 v52, v52
  v_exp_f32 v53, v53
  v_exp_f32 v54, v54
  v_exp_f32 v55, v55
  v_exp_f32 v56, v56
  v_exp_f32 v57, v57
  v_exp_f32 v58, v58
  v_exp_f32 v59, v59
  v_smfmac_f32_32x32x32_bf16 v[72:87], v[36:39], v[48:55], v12
  v_exp_f32 v60, v60
  v_exp_f32 v61, v61
  v_exp_f32 v62, v62
  v_mfma_f32_32x32x16_bf16 v[40:55], v[20:23], v[4:7], v[104:119]
  v_exp_f32 v63, v63
  v_exp_f32 v64, v64
  v_exp_f32 v65, v65
  v_smfmac_f32_32x32x32_bf16 v[88:103], v[28:31], v[56:63], v12
  v_exp_f32 v66, v66
  v_exp_f32 v67, v67
  v_exp_f32 v68, v68
  v_exp_f32 v69, v69
  v_exp_f32 v70, v70
  v_exp_f32 v71, v71
  v_exp_f32 v40, v40
  v_exp_f32 v41, v41
  v_exp_f32 v42, v42
  v_exp_f32 v43, v43
  v_smfmac_f32_32x32x32_bf16 v[88:103], v[36:39], v[64:71], v12
  ds_read_b128 v[36:39], v155 offset:3584
  v_exp_f32 v44, v44
  v_exp_f32 v45, v45
  v_exp_f32 v46, v46
  v_mfma_f32_32x32x16_bf16 v[56:71], v[20:23], v[8:11], v[120:135]
  ds_read_b128 v[20:23], v1 offset:36864
  v_exp_f32 v47, v47
  v_exp_f32 v48, v48
  v_exp_f32 v49, v49
  s_waitcnt lgkmcnt(2)
  v_smfmac_f32_32x32x32_bf16 v[72:87], v[24:27], v[40:47], v12
  ds_read_b128 v[28:31], v155 offset:3072
  v_exp_f32 v50, v50
  v_exp_f32 v51, v51
  v_exp_f32 v52, v52
  v_exp_f32 v53, v53
  v_exp_f32 v54, v54
  v_exp_f32 v55, v55
  v_exp_f32 v56, v56
  v_exp_f32 v57, v57
  v_exp_f32 v58, v58
  v_exp_f32 v59, v59
  v_smfmac_f32_32x32x32_bf16 v[72:87], v[32:35], v[48:55], v12
  v_exp_f32 v60, v60
  v_exp_f32 v61, v61
  v_exp_f32 v62, v62
  v_mfma_f32_32x32x16_bf16 v[40:55], v[16:19], v[4:7], v[104:119]
  v_exp_f32 v63, v63
  v_exp_f32 v64, v64
  v_exp_f32 v65, v65
  v_smfmac_f32_32x32x32_bf16 v[88:103], v[24:27], v[56:63], v12
  v_exp_f32 v66, v66
  v_exp_f32 v67, v67
  v_exp_f32 v68, v68
  v_exp_f32 v69, v69
  v_exp_f32 v70, v70
  v_exp_f32 v71, v71
  v_exp_f32 v40, v40
  v_exp_f32 v41, v41
  v_exp_f32 v42, v42
  v_exp_f32 v43, v43
  v_smfmac_f32_32x32x32_bf16 v[88:103], v[32:35], v[64:71], v12
  ds_read_b128 v[32:35], v155 offset:4608
  v_exp_f32 v44, v44
  v_exp_f32 v45, v45
  v_exp_f32 v46, v46
  v_mfma_f32_32x32x16_bf16 v[56:71], v[16:19], v[8:11], v[120:135]
  ds_read_b128 v[16:19], v1 offset:37888
  v_exp_f32 v47, v47
  v_exp_f32 v48, v48
  v_exp_f32 v49, v49
  s_waitcnt lgkmcnt(2)
  v_smfmac_f32_32x32x32_bf16 v[72:87], v[28:31], v[40:47], v12
  ds_read_b128 v[24:27], v155 offset:4096
  v_exp_f32 v50, v50
  v_exp_f32 v51, v51
  v_exp_f32 v52, v52
  v_exp_f32 v53, v53
  v_exp_f32 v54, v54
  v_exp_f32 v55, v55
  v_exp_f32 v56, v56
  v_exp_f32 v57, v57
  v_exp_f32 v58, v58
  v_exp_f32 v59, v59
  v_smfmac_f32_32x32x32_bf16 v[72:87], v[36:39], v[48:55], v12
  v_exp_f32 v60, v60
  v_exp_f32 v61, v61
  v_exp_f32 v62, v62
  v_mfma_f32_32x32x16_bf16 v[40:55], v[20:23], v[4:7], v[104:119]
  v_exp_f32 v63, v63
  v_exp_f32 v64, v64
  v_exp_f32 v65, v65
  v_smfmac_f32_32x32x32_bf16 v[88:103], v[28:31], v[56:63], v12
  v_exp_f32 v66, v66
  v_exp_f32 v67, v67
  v_exp_f32 v68, v68
  v_exp_f32 v69, v69
  v_exp_f32 v70, v70
  v_exp_f32 v71, v71
  v_exp_f32 v40, v40
  v_exp_f32 v41, v41
  v_exp_f32 v42, v42
  v_exp_f32 v43, v43
  v_smfmac_f32_32x32x32_bf16 v[88:103], v[36:39], v[64:71], v12
  ds_read_b128 v[36:39], v155 offset:5632
  v_exp_f32 v44, v44
  v_exp_f32 v45, v45
  v_exp_f32 v46, v46
  v_mfma_f32_32x32x16_bf16 v[56:71], v[20:23], v[8:11], v[120:135]
  ds_read_b128 v[20:23], v1 offset:38912
  v_exp_f32 v47, v47
  v_exp_f32 v48, v48
  v_exp_f32 v49, v49
  s_waitcnt lgkmcnt(2)
  v_smfmac_f32_32x32x32_bf16 v[72:87], v[24:27], v[40:47], v12
  ds_read_b128 v[28:31], v155 offset:5120
  v_exp_f32 v50, v50
  v_exp_f32 v51, v51
  v_exp_f32 v52, v52
  v_exp_f32 v53, v53
  v_exp_f32 v54, v54
  v_exp_f32 v55, v55
  v_exp_f32 v56, v56
  v_exp_f32 v57, v57
  v_exp_f32 v58, v58
  v_exp_f32 v59, v59
  v_smfmac_f32_32x32x32_bf16 v[72:87], v[32:35], v[48:55], v12
  v_exp_f32 v60, v60
  v_exp_f32 v61, v61
  v_exp_f32 v62, v62
  v_mfma_f32_32x32x16_bf16 v[40:55], v[16:19], v[4:7], v[104:119]
  s_waitcnt vmcnt(0)
  s_barrier
  v_exp_f32 v63, v63
  v_exp_f32 v64, v64
  v_exp_f32 v65, v65
  v_smfmac_f32_32x32x32_bf16 v[88:103], v[24:27], v[56:63], v12
  s_add_u32 m0, s22, 16384
  s_add_u32 s25, s7, 4
  s_and_b32 s25, s25, 7
  s_lshl_b32 s25, s25, 13
  s_add_u32 s25, s25, s22
  buffer_load_dwordx4 v1, s[12:15], s25 offen sc1 lds
  buffer_load_dwordx4 v1, s[12:15], s25 offen offset:1024 sc1 lds
  s_add_u32 m0, s22, 24576
  s_nop 0
  buffer_load_dwordx4 v1, s[16:19], s25 offen sc1 lds
  buffer_load_dwordx4 v1, s[16:19], s25 offen offset:1024 sc1 lds
  v_exp_f32 v66, v66
  v_exp_f32 v67, v67
  v_exp_f32 v68, v68
  v_exp_f32 v69, v69
  v_exp_f32 v70, v70
  v_exp_f32 v71, v71
  v_exp_f32 v40, v40
  v_exp_f32 v41, v41
  v_exp_f32 v42, v42
  v_exp_f32 v43, v43
  v_smfmac_f32_32x32x32_bf16 v[88:103], v[32:35], v[64:71], v12
  ds_read_b128 v[32:35], v155 offset:6656
  v_exp_f32 v44, v44
  v_exp_f32 v45, v45
  v_exp_f32 v46, v46
  v_mfma_f32_32x32x16_bf16 v[56:71], v[16:19], v[8:11], v[120:135]
  ds_read_b128 v[16:19], v1 offset:39936
  v_exp_f32 v47, v47
  v_exp_f32 v48, v48
  v_exp_f32 v49, v49
  s_waitcnt lgkmcnt(2)
  v_smfmac_f32_32x32x32_bf16 v[72:87], v[28:31], v[40:47], v12
  ds_read_b128 v[24:27], v155 offset:6144
  v_exp_f32 v50, v50
  v_exp_f32 v51, v51
  v_exp_f32 v52, v52
  v_exp_f32 v53, v53
  v_exp_f32 v54, v54
  v_exp_f32 v55, v55
  v_exp_f32 v56, v56
  v_exp_f32 v57, v57
  v_exp_f32 v58, v58
  v_exp_f32 v59, v59
  v_smfmac_f32_32x32x32_bf16 v[72:87], v[36:39], v[48:55], v12
  v_exp_f32 v60, v60
  v_exp_f32 v61, v61
  v_exp_f32 v62, v62
  v_mfma_f32_32x32x16_bf16 v[40:55], v[20:23], v[4:7], v[104:119]
  v_exp_f32 v63, v63
  v_exp_f32 v64, v64
  v_exp_f32 v65, v65
  v_smfmac_f32_32x32x32_bf16 v[88:103], v[28:31], v[56:63], v12
  v_exp_f32 v66, v66
  v_exp_f32 v67, v67
  v_exp_f32 v68, v68
  v_exp_f32 v69, v69
  v_exp_f32 v70, v70
  v_exp_f32 v71, v71
  v_exp_f32 v40, v40
  v_exp_f32 v41, v41
  v_exp_f32 v42, v42
  v_exp_f32 v43, v43
  v_smfmac_f32_32x32x32_bf16 v[88:103], v[36:39], v[64:71], v12
  ds_read_b128 v[36:39], v155 offset:7680
  v_exp_f32 v44, v44
  v_exp_f32 v45, v45
  v_exp_f32 v46, v46
  v_mfma_f32_32x32x16_bf16 v[56:71], v[20:23], v[8:11], v[120:135]
  ds_read_b128 v[20:23], v1 offset:0
  v_exp_f32 v47, v47
  v_exp_f32 v48, v48
  v_exp_f32 v49, v49
  s_waitcnt lgkmcnt(2)
  v_smfmac_f32_32x32x32_bf16 v[72:87], v[24:27], v[40:47], v12
  ds_read_b128 v[28:31], v155 offset:7168
  v_exp_f32 v50, v50
  v_exp_f32 v51, v51
  v_exp_f32 v52, v52
  v_exp_f32 v53, v53
  v_exp_f32 v54, v54
  v_exp_f32 v55, v55
  v_exp_f32 v56, v56
  v_exp_f32 v57, v57
  v_exp_f32 v58, v58
  v_exp_f32 v59, v59
  v_smfmac_f32_32x32x32_bf16 v[72:87], v[32:35], v[48:55], v12
  v_exp_f32 v60, v60
  v_exp_f32 v61, v61
  v_exp_f32 v62, v62
  v_mfma_f32_32x32x16_bf16 v[40:55], v[16:19], v[4:7], v[104:119]
  v_exp_f32 v63, v63
  v_exp_f32 v64, v64
  v_exp_f32 v65, v65
  v_smfmac_f32_32x32x32_bf16 v[88:103], v[24:27], v[56:63], v12
  v_exp_f32 v66, v66
  v_exp_f32 v67, v67
  v_exp_f32 v68, v68
  v_exp_f32 v69, v69
  v_exp_f32 v70, v70
  v_exp_f32 v71, v71
  v_exp_f32 v40, v40
  v_exp_f32 v41, v41
  v_exp_f32 v42, v42
  v_exp_f32 v43, v43
  v_smfmac_f32_32x32x32_bf16 v[88:103], v[32:35], v[64:71], v12
  ds_read_b128 v[32:35], v153 offset:512
  v_exp_f32 v44, v44
  v_exp_f32 v45, v45
  v_exp_f32 v46, v46
  v_mfma_f32_32x32x16_bf16 v[56:71], v[16:19], v[8:11], v[120:135]
  ds_read_b128 v[16:19], v1 offset:1024
  v_exp_f32 v47, v47
  v_exp_f32 v48, v48
  v_exp_f32 v49, v49
  s_waitcnt lgkmcnt(2)
  v_smfmac_f32_32x32x32_bf16 v[72:87], v[28:31], v[40:47], v12
  ds_read_b128 v[24:27], v153 offset:0
  v_exp_f32 v50, v50
  v_exp_f32 v51, v51
  v_exp_f32 v52, v52
  v_exp_f32 v53, v53
  v_exp_f32 v54, v54
  v_exp_f32 v55, v55
  v_exp_f32 v56, v56
  v_exp_f32 v57, v57
  v_exp_f32 v58, v58
  v_exp_f32 v59, v59
  v_smfmac_f32_32x32x32_bf16 v[72:87], v[36:39], v[48:55], v12
  v_exp_f32 v60, v60
  v_exp_f32 v61, v61
  v_exp_f32 v62, v62
  v_mfma_f32_32x32x16_bf16 v[40:55], v[20:23], v[4:7], v[104:119]
  v_exp_f32 v63, v63
  v_exp_f32 v64, v64
  v_exp_f32 v65, v65
  v_smfmac_f32_32x32x32_bf16 v[88:103], v[28:31], v[56:63], v12
  v_exp_f32 v66, v66
  v_exp_f32 v67, v67
  v_exp_f32 v68, v68
  v_exp_f32 v69, v69
  v_exp_f32 v70, v70
  v_exp_f32 v71, v71
  v_exp_f32 v40, v40
  v_exp_f32 v41, v41
  v_exp_f32 v42, v42
  v_exp_f32 v43, v43
  v_smfmac_f32_32x32x32_bf16 v[88:103], v[36:39], v[64:71], v12
  ds_read_b128 v[36:39], v153 offset:1536
  v_exp_f32 v44, v44
  v_exp_f32 v45, v45
  v_exp_f32 v46, v46
  v_mfma_f32_32x32x16_bf16 v[56:71], v[20:23], v[8:11], v[120:135]
  ds_read_b128 v[20:23], v1 offset:2048
  v_exp_f32 v47, v47
  v_exp_f32 v48, v48
  v_exp_f32 v49, v49
  s_waitcnt lgkmcnt(2)
  v_smfmac_f32_32x32x32_bf16 v[72:87], v[24:27], v[40:47], v12
  ds_read_b128 v[28:31], v153 offset:1024
  v_exp_f32 v50, v50
  v_exp_f32 v51, v51
  v_exp_f32 v52, v52
  v_exp_f32 v53, v53
  v_exp_f32 v54, v54
  v_exp_f32 v55, v55
  v_exp_f32 v56, v56
  v_exp_f32 v57, v57
  v_exp_f32 v58, v58
  v_exp_f32 v59, v59
  v_smfmac_f32_32x32x32_bf16 v[72:87], v[32:35], v[48:55], v12
  v_exp_f32 v60, v60
  v_exp_f32 v61, v61
  v_exp_f32 v62, v62
  v_mfma_f32_32x32x16_bf16 v[40:55], v[16:19], v[4:7], v[104:119]
  v_exp_f32 v63, v63
  v_exp_f32 v64, v64
  v_exp_f32 v65, v65
  v_smfmac_f32_32x32x32_bf16 v[88:103], v[24:27], v[56:63], v12
  v_exp_f32 v66, v66
  v_exp_f32 v67, v67
  v_exp_f32 v68, v68
  v_exp_f32 v69, v69
  v_exp_f32 v70, v70
  v_exp_f32 v71, v71
  v_exp_f32 v40, v40
  v_exp_f32 v41, v41
  v_exp_f32 v42, v42
  v_exp_f32 v43, v43
  v_smfmac_f32_32x32x32_bf16 v[88:103], v[32:35], v[64:71], v12
  ds_read_b128 v[32:35], v153 offset:2560
  v_exp_f32 v44, v44
  v_exp_f32 v45, v45
  v_exp_f32 v46, v46
  v_mfma_f32_32x32x16_bf16 v[56:71], v[16:19], v[8:11], v[120:135]
  ds_read_b128 v[16:19], v1 offset:3072
  v_exp_f32 v47, v47
  v_exp_f32 v48, v48
  v_exp_f32 v49, v49
  s_waitcnt lgkmcnt(2)
  v_smfmac_f32_32x32x32_bf16 v[72:87], v[28:31], v[40:47], v12
  ds_read_b128 v[24:27], v153 offset:2048
  v_exp_f32 v50, v50
  v_exp_f32 v51, v51
  v_exp_f32 v52, v52
  v_exp_f32 v53, v53
  v_exp_f32 v54, v54
  v_exp_f32 v55, v55
  v_exp_f32 v56, v56
  v_exp_f32 v57, v57
  v_exp_f32 v58, v58
  v_exp_f32 v59, v59
  v_smfmac_f32_32x32x32_bf16 v[72:87], v[36:39], v[48:55], v12
  v_exp_f32 v60, v60
  v_exp_f32 v61, v61
  v_exp_f32 v62, v62
  v_mfma_f32_32x32x16_bf16 v[40:55], v[20:23], v[4:7], v[104:119]
  v_exp_f32 v63, v63
  v_exp_f32 v64, v64
  v_exp_f32 v65, v65
  v_smfmac_f32_32x32x32_bf16 v[88:103], v[28:31], v[56:63], v12
  v_exp_f32 v66, v66
  v_exp_f32 v67, v67
  v_exp_f32 v68, v68
  v_exp_f32 v69, v69
  v_exp_f32 v70, v70
  v_exp_f32 v71, v71
  v_exp_f32 v40, v40
  v_exp_f32 v41, v41
  v_exp_f32 v42, v42
  v_exp_f32 v43, v43
  v_smfmac_f32_32x32x32_bf16 v[88:103], v[36:39], v[64:71], v12
  ds_read_b128 v[36:39], v153 offset:3584
  v_exp_f32 v44, v44
  v_exp_f32 v45, v45
  v_exp_f32 v46, v46
  v_mfma_f32_32x32x16_bf16 v[56:71], v[20:23], v[8:11], v[120:135]
  ds_read_b128 v[20:23], v1 offset:4096
  v_exp_f32 v47, v47
  v_exp_f32 v48, v48
  v_exp_f32 v49, v49
  s_waitcnt lgkmcnt(2)
  v_smfmac_f32_32x32x32_bf16 v[72:87], v[24:27], v[40:47], v12
  ds_read_b128 v[28:31], v153 offset:3072
  v_exp_f32 v50, v50
  v_exp_f32 v51, v51
  v_exp_f32 v52, v52
  v_exp_f32 v53, v53
  v_exp_f32 v54, v54
  v_exp_f32 v55, v55
  v_exp_f32 v56, v56
  v_exp_f32 v57, v57
  v_exp_f32 v58, v58
  v_exp_f32 v59, v59
  v_smfmac_f32_32x32x32_bf16 v[72:87], v[32:35], v[48:55], v12
  v_exp_f32 v60, v60
  v_exp_f32 v61, v61
  v_exp_f32 v62, v62
  v_mfma_f32_32x32x16_bf16 v[40:55], v[16:19], v[4:7], v[104:119]
  v_exp_f32 v63, v63
  v_exp_f32 v64, v64
  v_exp_f32 v65, v65
  v_smfmac_f32_32x32x32_bf16 v[88:103], v[24:27], v[56:63], v12
  v_exp_f32 v66, v66
  v_exp_f32 v67, v67
  v_exp_f32 v68, v68
  v_exp_f32 v69, v69
  v_exp_f32 v70, v70
  v_exp_f32 v71, v71
  v_exp_f32 v40, v40
  v_exp_f32 v41, v41
  v_exp_f32 v42, v42
  v_exp_f32 v43, v43
  v_smfmac_f32_32x32x32_bf16 v[88:103], v[32:35], v[64:71], v12
  ds_read_b128 v[32:35], v153 offset:4608
  v_exp_f32 v44, v44
  v_exp_f32 v45, v45
  v_exp_f32 v46, v46
  v_mfma_f32_32x32x16_bf16 v[56:71], v[16:19], v[8:11], v[120:135]
  ds_read_b128 v[16:19], v1 offset:5120
  v_exp_f32 v47, v47
  v_exp_f32 v48, v48
  v_exp_f32 v49, v49
  s_waitcnt lgkmcnt(2)
  v_smfmac_f32_32x32x32_bf16 v[72:87], v[28:31], v[40:47], v12
  ds_read_b128 v[24:27], v153 offset:4096
  v_exp_f32 v50, v50
  v_exp_f32 v51, v51
  v_exp_f32 v52, v52
  v_exp_f32 v53, v53
  v_exp_f32 v54, v54
  v_exp_f32 v55, v55
  v_exp_f32 v56, v56
  v_exp_f32 v57, v57
  v_exp_f32 v58, v58
  v_exp_f32 v59, v59
  v_smfmac_f32_32x32x32_bf16 v[72:87], v[36:39], v[48:55], v12
  v_exp_f32 v60, v60
  v_exp_f32 v61, v61
  v_exp_f32 v62, v62
  v_mfma_f32_32x32x16_bf16 v[40:55], v[20:23], v[4:7], v[104:119]
  v_exp_f32 v63, v63
  v_exp_f32 v64, v64
  v_exp_f32 v65, v65
  v_smfmac_f32_32x32x32_bf16 v[88:103], v[28:31], v[56:63], v12
  v_exp_f32 v66, v66
  v_exp_f32 v67, v67
  v_exp_f32 v68, v68
  v_exp_f32 v69, v69
  v_exp_f32 v70, v70
  v_exp_f32 v71, v71
  v_exp_f32 v40, v40
  v_exp_f32 v41, v41
  v_exp_f32 v42, v42
  v_exp_f32 v43, v43
  v_smfmac_f32_32x32x32_bf16 v[88:103], v[36:39], v[64:71], v12
  ds_read_b128 v[36:39], v153 offset:5632
  v_exp_f32 v44, v44
  v_exp_f32 v45, v45
  v_exp_f32 v46, v46
  v_mfma_f32_32x32x16_bf16 v[56:71], v[20:23], v[8:11], v[120:135]
  ds_read_b128 v[20:23], v1 offset:6144
  v_exp_f32 v47, v47
  v_exp_f32 v48, v48
  v_exp_f32 v49, v49
  s_waitcnt lgkmcnt(2)
  v_smfmac_f32_32x32x32_bf16 v[72:87], v[24:27], v[40:47], v12
  ds_read_b128 v[28:31], v153 offset:5120
  v_exp_f32 v50, v50
  v_exp_f32 v51, v51
  v_exp_f32 v52, v52
  v_exp_f32 v53, v53
  v_exp_f32 v54, v54
  v_exp_f32 v55, v55
  v_exp_f32 v56, v56
  v_exp_f32 v57, v57
  v_exp_f32 v58, v58
  v_exp_f32 v59, v59
  v_smfmac_f32_32x32x32_bf16 v[72:87], v[32:35], v[48:55], v12
  v_exp_f32 v60, v60
  v_exp_f32 v61, v61
  v_exp_f32 v62, v62
  v_mfma_f32_32x32x16_bf16 v[40:55], v[16:19], v[4:7], v[104:119]
  s_waitcnt vmcnt(0)
  s_barrier
  v_exp_f32 v63, v63
  v_exp_f32 v64, v64
  v_exp_f32 v65, v65
  v_smfmac_f32_32x32x32_bf16 v[88:103], v[24:27], v[56:63], v12
  s_add_u32 m0, s22, 32768
  s_add_u32 s25, s7, 5
  s_and_b32 s25, s25, 7
  s_lshl_b32 s25, s25, 13
  s_add_u32 s25, s25, s22
  buffer_load_dwordx4 v1, s[12:15], s25 offen sc1 lds
  buffer_load_dwordx4 v1, s[12:15], s25 offen offset:1024 sc1 lds
  s_add_u32 m0, s22, 40960
  s_nop 0
  buffer_load_dwordx4 v1, s[16:19], s25 offen sc1 lds
  buffer_load_dwordx4 v1, s[16:19], s25 offen offset:1024 sc1 lds
  v_exp_f32 v66, v66
  v_exp_f32 v67, v67
  v_exp_f32 v68, v68
  v_exp_f32 v69, v69
  v_exp_f32 v70, v70
  v_exp_f32 v71, v71
  v_exp_f32 v40, v40
  v_exp_f32 v41, v41
  v_exp_f32 v42, v42
  v_exp_f32 v43, v43
  v_smfmac_f32_32x32x32_bf16 v[88:103], v[32:35], v[64:71], v12
  ds_read_b128 v[32:35], v153 offset:6656
  v_exp_f32 v44, v44
  v_exp_f32 v45, v45
  v_exp_f32 v46, v46
  v_mfma_f32_32x32x16_bf16 v[56:71], v[16:19], v[8:11], v[120:135]
  ds_read_b128 v[16:19], v1 offset:7168
  v_exp_f32 v47, v47
  v_exp_f32 v48, v48
  v_exp_f32 v49, v49
  s_waitcnt lgkmcnt(2)
  v_smfmac_f32_32x32x32_bf16 v[72:87], v[28:31], v[40:47], v12
  ds_read_b128 v[24:27], v153 offset:6144
  v_exp_f32 v50, v50
  v_exp_f32 v51, v51
  v_exp_f32 v52, v52
  v_exp_f32 v53, v53
  v_exp_f32 v54, v54
  v_exp_f32 v55, v55
  v_exp_f32 v56, v56
  v_exp_f32 v57, v57
  v_exp_f32 v58, v58
  v_exp_f32 v59, v59
  v_smfmac_f32_32x32x32_bf16 v[72:87], v[36:39], v[48:55], v12
  v_exp_f32 v60, v60
  v_exp_f32 v61, v61
  v_exp_f32 v62, v62
  v_mfma_f32_32x32x16_bf16 v[40:55], v[20:23], v[4:7], v[104:119]
  v_exp_f32 v63, v63
  v_exp_f32 v64, v64
  v_exp_f32 v65, v65
  v_smfmac_f32_32x32x32_bf16 v[88:103], v[28:31], v[56:63], v12
  v_exp_f32 v66, v66
  v_exp_f32 v67, v67
  v_exp_f32 v68, v68
  v_exp_f32 v69, v69
  v_exp_f32 v70, v70
  v_exp_f32 v71, v71
  v_exp_f32 v40, v40
  v_exp_f32 v41, v41
  v_exp_f32 v42, v42
  v_exp_f32 v43, v43
  v_smfmac_f32_32x32x32_bf16 v[88:103], v[36:39], v[64:71], v12
  ds_read_b128 v[36:39], v153 offset:7680
  v_exp_f32 v44, v44
  v_exp_f32 v45, v45
  v_exp_f32 v46, v46
  v_mfma_f32_32x32x16_bf16 v[56:71], v[20:23], v[8:11], v[120:135]
  ds_read_b128 v[20:23], v1 offset:16384
  v_exp_f32 v47, v47
  v_exp_f32 v48, v48
  v_exp_f32 v49, v49
  s_waitcnt lgkmcnt(2)
  v_smfmac_f32_32x32x32_bf16 v[72:87], v[24:27], v[40:47], v12
  ds_read_b128 v[28:31], v153 offset:7168
  v_exp_f32 v50, v50
  v_exp_f32 v51, v51
  v_exp_f32 v52, v52
  v_exp_f32 v53, v53
  v_exp_f32 v54, v54
  v_exp_f32 v55, v55
  v_exp_f32 v56, v56
  v_exp_f32 v57, v57
  v_exp_f32 v58, v58
  v_exp_f32 v59, v59
  v_smfmac_f32_32x32x32_bf16 v[72:87], v[32:35], v[48:55], v12
  v_exp_f32 v60, v60
  v_exp_f32 v61, v61
  v_exp_f32 v62, v62
  v_mfma_f32_32x32x16_bf16 v[40:55], v[16:19], v[4:7], v[104:119]
  v_exp_f32 v63, v63
  v_exp_f32 v64, v64
  v_exp_f32 v65, v65
  v_smfmac_f32_32x32x32_bf16 v[88:103], v[24:27], v[56:63], v12
  v_exp_f32 v66, v66
  v_exp_f32 v67, v67
  v_exp_f32 v68, v68
  v_exp_f32 v69, v69
  v_exp_f32 v70, v70
  v_exp_f32 v71, v71
  v_exp_f32 v40, v40
  v_exp_f32 v41, v41
  v_exp_f32 v42, v42
  v_exp_f32 v43, v43
  v_smfmac_f32_32x32x32_bf16 v[88:103], v[32:35], v[64:71], v12
  ds_read_b128 v[32:35], v154 offset:512
  v_exp_f32 v44, v44
  v_exp_f32 v45, v45
  v_exp_f32 v46, v46
  v_mfma_f32_32x32x16_bf16 v[56:71], v[16:19], v[8:11], v[120:135]
  ds_read_b128 v[16:19], v1 offset:17408
  v_exp_f32 v47, v47
  v_exp_f32 v48, v48
  v_exp_f32 v49, v49
  s_waitcnt lgkmcnt(2)
  v_smfmac_f32_32x32x32_bf16 v[72:87], v[28:31], v[40:47], v12
  ds_read_b128 v[24:27], v154 offset:0
  v_exp_f32 v50, v50
  v_exp_f32 v51, v51
  v_exp_f32 v52, v52
  v_exp_f32 v53, v53
  v_exp_f32 v54, v54
  v_exp_f32 v55, v55
  v_exp_f32 v56, v56
  v_exp_f32 v57, v57
  v_exp_f32 v58, v58
  v_exp_f32 v59, v59
  v_smfmac_f32_32x32x32_bf16 v[72:87], v[36:39], v[48:55], v12
  v_exp_f32 v60, v60
  v_exp_f32 v61, v61
  v_exp_f32 v62, v62
  v_mfma_f32_32x32x16_bf16 v[40:55], v[20:23], v[4:7], v[104:119]
  v_exp_f32 v63, v63
  v_exp_f32 v64, v64
  v_exp_f32 v65, v65
  v_smfmac_f32_32x32x32_bf16 v[88:103], v[28:31], v[56:63], v12
  v_exp_f32 v66, v66
  v_exp_f32 v67, v67
  v_exp_f32 v68, v68
  v_exp_f32 v69, v69
  v_exp_f32 v70, v70
  v_exp_f32 v71, v71
  v_exp_f32 v40, v40
  v_exp_f32 v41, v41
  v_exp_f32 v42, v42
  v_exp_f32 v43, v43
  v_smfmac_f32_32x32x32_bf16 v[88:103], v[36:39], v[64:71], v12
  ds_read_b128 v[36:39], v154 offset:1536
  v_exp_f32 v44, v44
  v_exp_f32 v45, v45
  v_exp_f32 v46, v46
  v_mfma_f32_32x32x16_bf16 v[56:71], v[20:23], v[8:11], v[120:135]
  ds_read_b128 v[20:23], v1 offset:18432
  v_exp_f32 v47, v47
  v_exp_f32 v48, v48
  v_exp_f32 v49, v49
  s_waitcnt lgkmcnt(2)
  v_smfmac_f32_32x32x32_bf16 v[72:87], v[24:27], v[40:47], v12
  ds_read_b128 v[28:31], v154 offset:1024
  v_exp_f32 v50, v50
  v_exp_f32 v51, v51
  v_exp_f32 v52, v52
  v_exp_f32 v53, v53
  v_exp_f32 v54, v54
  v_exp_f32 v55, v55
  v_exp_f32 v56, v56
  v_exp_f32 v57, v57
  v_exp_f32 v58, v58
  v_exp_f32 v59, v59
  v_smfmac_f32_32x32x32_bf16 v[72:87], v[32:35], v[48:55], v12
  v_exp_f32 v60, v60
  v_exp_f32 v61, v61
  v_exp_f32 v62, v62
  v_mfma_f32_32x32x16_bf16 v[40:55], v[16:19], v[4:7], v[104:119]
  v_exp_f32 v63, v63
  v_exp_f32 v64, v64
  v_exp_f32 v65, v65
  v_smfmac_f32_32x32x32_bf16 v[88:103], v[24:27], v[56:63], v12
  v_exp_f32 v66, v66
  v_exp_f32 v67, v67
  v_exp_f32 v68, v68
  v_exp_f32 v69, v69
  v_exp_f32 v70, v70
  v_exp_f32 v71, v71
  v_exp_f32 v40, v40
  v_exp_f32 v41, v41
  v_exp_f32 v42, v42
  v_exp_f32 v43, v43
  v_smfmac_f32_32x32x32_bf16 v[88:103], v[32:35], v[64:71], v12
  ds_read_b128 v[32:35], v154 offset:2560
  v_exp_f32 v44, v44
  v_exp_f32 v45, v45
  v_exp_f32 v46, v46
  v_mfma_f32_32x32x16_bf16 v[56:71], v[16:19], v[8:11], v[120:135]
  ds_read_b128 v[16:19], v1 offset:19456
  v_exp_f32 v47, v47
  v_exp_f32 v48, v48
  v_exp_f32 v49, v49
  s_waitcnt lgkmcnt(2)
  v_smfmac_f32_32x32x32_bf16 v[72:87], v[28:31], v[40:47], v12
  ds_read_b128 v[24:27], v154 offset:2048
  v_exp_f32 v50, v50
  v_exp_f32 v51, v51
  v_exp_f32 v52, v52
  v_exp_f32 v53, v53
  v_exp_f32 v54, v54
  v_exp_f32 v55, v55
  v_exp_f32 v56, v56
  v_exp_f32 v57, v57
  v_exp_f32 v58, v58
  v_exp_f32 v59, v59
  v_smfmac_f32_32x32x32_bf16 v[72:87], v[36:39], v[48:55], v12
  v_exp_f32 v60, v60
  v_exp_f32 v61, v61
  v_exp_f32 v62, v62
  v_mfma_f32_32x32x16_bf16 v[40:55], v[20:23], v[4:7], v[104:119]
  v_exp_f32 v63, v63
  v_exp_f32 v64, v64
  v_exp_f32 v65, v65
  v_smfmac_f32_32x32x32_bf16 v[88:103], v[28:31], v[56:63], v12
  v_exp_f32 v66, v66
  v_exp_f32 v67, v67
  v_exp_f32 v68, v68
  v_exp_f32 v69, v69
  v_exp_f32 v70, v70
  v_exp_f32 v71, v71
  v_exp_f32 v40, v40
  v_exp_f32 v41, v41
  v_exp_f32 v42, v42
  v_exp_f32 v43, v43
  v_smfmac_f32_32x32x32_bf16 v[88:103], v[36:39], v[64:71], v12
  ds_read_b128 v[36:39], v154 offset:3584
  v_exp_f32 v44, v44
  v_exp_f32 v45, v45
  v_exp_f32 v46, v46
  v_mfma_f32_32x32x16_bf16 v[56:71], v[20:23], v[8:11], v[120:135]
  ds_read_b128 v[20:23], v1 offset:20480
  v_exp_f32 v47, v47
  v_exp_f32 v48, v48
  v_exp_f32 v49, v49
  s_waitcnt lgkmcnt(2)
  v_smfmac_f32_32x32x32_bf16 v[72:87], v[24:27], v[40:47], v12
  ds_read_b128 v[28:31], v154 offset:3072
  v_exp_f32 v50, v50
  v_exp_f32 v51, v51
  v_exp_f32 v52, v52
  v_exp_f32 v53, v53
  v_exp_f32 v54, v54
  v_exp_f32 v55, v55
  v_exp_f32 v56, v56
  v_exp_f32 v57, v57
  v_exp_f32 v58, v58
  v_exp_f32 v59, v59
  v_smfmac_f32_32x32x32_bf16 v[72:87], v[32:35], v[48:55], v12
  v_exp_f32 v60, v60
  v_exp_f32 v61, v61
  v_exp_f32 v62, v62
  v_mfma_f32_32x32x16_bf16 v[40:55], v[16:19], v[4:7], v[104:119]
  v_exp_f32 v63, v63
  v_exp_f32 v64, v64
  v_exp_f32 v65, v65
  v_smfmac_f32_32x32x32_bf16 v[88:103], v[24:27], v[56:63], v12
  v_exp_f32 v66, v66
  v_exp_f32 v67, v67
  v_exp_f32 v68, v68
  v_exp_f32 v69, v69
  v_exp_f32 v70, v70
  v_exp_f32 v71, v71
  v_exp_f32 v40, v40
  v_exp_f32 v41, v41
  v_exp_f32 v42, v42
  v_exp_f32 v43, v43
  v_smfmac_f32_32x32x32_bf16 v[88:103], v[32:35], v[64:71], v12
  ds_read_b128 v[32:35], v154 offset:4608
  v_exp_f32 v44, v44
  v_exp_f32 v45, v45
  v_exp_f32 v46, v46
  v_mfma_f32_32x32x16_bf16 v[56:71], v[16:19], v[8:11], v[120:135]
  ds_read_b128 v[16:19], v1 offset:21504
  v_exp_f32 v47, v47
  v_exp_f32 v48, v48
  v_exp_f32 v49, v49
  s_waitcnt lgkmcnt(2)
  v_smfmac_f32_32x32x32_bf16 v[72:87], v[28:31], v[40:47], v12
  ds_read_b128 v[24:27], v154 offset:4096
  v_exp_f32 v50, v50
  v_exp_f32 v51, v51
  v_exp_f32 v52, v52
  v_exp_f32 v53, v53
  v_exp_f32 v54, v54
  v_exp_f32 v55, v55
  v_exp_f32 v56, v56
  v_exp_f32 v57, v57
  v_exp_f32 v58, v58
  v_exp_f32 v59, v59
  v_smfmac_f32_32x32x32_bf16 v[72:87], v[36:39], v[48:55], v12
  v_exp_f32 v60, v60
  v_exp_f32 v61, v61
  v_exp_f32 v62, v62
  v_mfma_f32_32x32x16_bf16 v[40:55], v[20:23], v[4:7], v[104:119]
  v_exp_f32 v63, v63
  v_exp_f32 v64, v64
  v_exp_f32 v65, v65
  v_smfmac_f32_32x32x32_bf16 v[88:103], v[28:31], v[56:63], v12
  v_exp_f32 v66, v66
  v_exp_f32 v67, v67
  v_exp_f32 v68, v68
  v_exp_f32 v69, v69
  v_exp_f32 v70, v70
  v_exp_f32 v71, v71
  v_exp_f32 v40, v40
  v_exp_f32 v41, v41
  v_exp_f32 v42, v42
  v_exp_f32 v43, v43
  v_smfmac_f32_32x32x32_bf16 v[88:103], v[36:39], v[64:71], v12
  ds_read_b128 v[36:39], v154 offset:5632
  v_exp_f32 v44, v44
  v_exp_f32 v45, v45
  v_exp_f32 v46, v46
  v_mfma_f32_32x32x16_bf16 v[56:71], v[20:23], v[8:11], v[120:135]
  ds_read_b128 v[20:23], v1 offset:22528
  v_exp_f32 v47, v47
  v_exp_f32 v48, v48
  v_exp_f32 v49, v49
  s_waitcnt lgkmcnt(2)
  v_smfmac_f32_32x32x32_bf16 v[72:87], v[24:27], v[40:47], v12
  ds_read_b128 v[28:31], v154 offset:5120
  v_exp_f32 v50, v50
  v_exp_f32 v51, v51
  v_exp_f32 v52, v52
  v_exp_f32 v53, v53
  v_exp_f32 v54, v54
  v_exp_f32 v55, v55
  v_exp_f32 v56, v56
  v_exp_f32 v57, v57
  v_exp_f32 v58, v58
  v_exp_f32 v59, v59
  v_smfmac_f32_32x32x32_bf16 v[72:87], v[32:35], v[48:55], v12
  v_exp_f32 v60, v60
  v_exp_f32 v61, v61
  v_exp_f32 v62, v62
  v_mfma_f32_32x32x16_bf16 v[40:55], v[16:19], v[4:7], v[104:119]
  s_waitcnt vmcnt(0)
  s_barrier
  v_exp_f32 v63, v63
  v_exp_f32 v64, v64
  v_exp_f32 v65, v65
  v_smfmac_f32_32x32x32_bf16 v[88:103], v[24:27], v[56:63], v12
  s_add_u32 m0, s22, 0
  s_add_u32 s25, s7, 6
  s_and_b32 s25, s25, 7
  s_lshl_b32 s25, s25, 13
  s_add_u32 s25, s25, s22
  buffer_load_dwordx4 v1, s[12:15], s25 offen sc1 lds
  buffer_load_dwordx4 v1, s[12:15], s25 offen offset:1024 sc1 lds
  s_add_u32 m0, s22, 8192
  s_nop 0
  buffer_load_dwordx4 v1, s[16:19], s25 offen sc1 lds
  buffer_load_dwordx4 v1, s[16:19], s25 offen offset:1024 sc1 lds
  v_exp_f32 v66, v66
  v_exp_f32 v67, v67
  v_exp_f32 v68, v68
  v_exp_f32 v69, v69
  v_exp_f32 v70, v70
  v_exp_f32 v71, v71
  v_exp_f32 v40, v40
  v_exp_f32 v41, v41
  v_exp_f32 v42, v42
  v_exp_f32 v43, v43
  v_smfmac_f32_32x32x32_bf16 v[88:103], v[32:35], v[64:71], v12
  ds_read_b128 v[32:35], v154 offset:6656
  v_exp_f32 v44, v44
  v_exp_f32 v45, v45
  v_exp_f32 v46, v46
  v_mfma_f32_32x32x16_bf16 v[56:71], v[16:19], v[8:11], v[120:135]
  ds_read_b128 v[16:19], v1 offset:23552
  v_exp_f32 v47, v47
  v_exp_f32 v48, v48
  v_exp_f32 v49, v49
  s_waitcnt lgkmcnt(2)
  v_smfmac_f32_32x32x32_bf16 v[72:87], v[28:31], v[40:47], v12
  ds_read_b128 v[24:27], v154 offset:6144
  v_exp_f32 v50, v50
  v_exp_f32 v51, v51
  v_exp_f32 v52, v52
  v_exp_f32 v53, v53
  v_exp_f32 v54, v54
  v_exp_f32 v55, v55
  v_exp_f32 v56, v56
  v_exp_f32 v57, v57
  v_exp_f32 v58, v58
  v_exp_f32 v59, v59
  v_smfmac_f32_32x32x32_bf16 v[72:87], v[36:39], v[48:55], v12
  v_exp_f32 v60, v60
  v_exp_f32 v61, v61
  v_exp_f32 v62, v62
  v_mfma_f32_32x32x16_bf16 v[40:55], v[20:23], v[4:7], v[104:119]
  v_exp_f32 v63, v63
  v_exp_f32 v64, v64
  v_exp_f32 v65, v65
  v_smfmac_f32_32x32x32_bf16 v[88:103], v[28:31], v[56:63], v12
  v_exp_f32 v66, v66
  v_exp_f32 v67, v67
  v_exp_f32 v68, v68
  v_exp_f32 v69, v69
  v_exp_f32 v70, v70
  v_exp_f32 v71, v71
  v_exp_f32 v40, v40
  v_exp_f32 v41, v41
  v_exp_f32 v42, v42
  v_exp_f32 v43, v43
  v_smfmac_f32_32x32x32_bf16 v[88:103], v[36:39], v[64:71], v12
  ds_read_b128 v[36:39], v154 offset:7680
  v_exp_f32 v44, v44
  v_exp_f32 v45, v45
  v_exp_f32 v46, v46
  v_mfma_f32_32x32x16_bf16 v[56:71], v[20:23], v[8:11], v[120:135]
  ds_read_b128 v[20:23], v1 offset:32768
  v_exp_f32 v47, v47
  v_exp_f32 v48, v48
  v_exp_f32 v49, v49
  s_waitcnt lgkmcnt(2)
  v_smfmac_f32_32x32x32_bf16 v[72:87], v[24:27], v[40:47], v12
  ds_read_b128 v[28:31], v154 offset:7168
  v_exp_f32 v50, v50
  v_exp_f32 v51, v51
  v_exp_f32 v52, v52
  v_exp_f32 v53, v53
  v_exp_f32 v54, v54
  v_exp_f32 v55, v55
  v_exp_f32 v56, v56
  v_exp_f32 v57, v57
  v_exp_f32 v58, v58
  v_exp_f32 v59, v59
  v_smfmac_f32_32x32x32_bf16 v[72:87], v[32:35], v[48:55], v12
  v_exp_f32 v60, v60
  v_exp_f32 v61, v61
  v_exp_f32 v62, v62
  v_mfma_f32_32x32x16_bf16 v[40:55], v[16:19], v[4:7], v[104:119]
  v_exp_f32 v63, v63
  v_exp_f32 v64, v64
  v_exp_f32 v65, v65
  v_smfmac_f32_32x32x32_bf16 v[88:103], v[24:27], v[56:63], v12
  v_exp_f32 v66, v66
  v_exp_f32 v67, v67
  v_exp_f32 v68, v68
  v_exp_f32 v69, v69
  v_exp_f32 v70, v70
  v_exp_f32 v71, v71
  v_exp_f32 v40, v40
  v_exp_f32 v41, v41
  v_exp_f32 v42, v42
  v_exp_f32 v43, v43
  v_smfmac_f32_32x32x32_bf16 v[88:103], v[32:35], v[64:71], v12
  ds_read_b128 v[32:35], v155 offset:512
  v_exp_f32 v44, v44
  v_exp_f32 v45, v45
  v_exp_f32 v46, v46
  v_mfma_f32_32x32x16_bf16 v[56:71], v[16:19], v[8:11], v[120:135]
  ds_read_b128 v[16:19], v1 offset:33792
  v_exp_f32 v47, v47
  v_exp_f32 v48, v48
  v_exp_f32 v49, v49
  s_waitcnt lgkmcnt(2)
  v_smfmac_f32_32x32x32_bf16 v[72:87], v[28:31], v[40:47], v12
  ds_read_b128 v[24:27], v155 offset:0
  v_exp_f32 v50, v50
  v_exp_f32 v51, v51
  v_exp_f32 v52, v52
  v_exp_f32 v53, v53
  v_exp_f32 v54, v54
  v_exp_f32 v55, v55
  v_exp_f32 v56, v56
  v_exp_f32 v57, v57
  v_exp_f32 v58, v58
  v_exp_f32 v59, v59
  v_smfmac_f32_32x32x32_bf16 v[72:87], v[36:39], v[48:55], v12
  v_exp_f32 v60, v60
  v_exp_f32 v61, v61
  v_exp_f32 v62, v62
  v_mfma_f32_32x32x16_bf16 v[40:55], v[20:23], v[4:7], v[104:119]
  v_exp_f32 v63, v63
  v_exp_f32 v64, v64
  v_exp_f32 v65, v65
  v_smfmac_f32_32x32x32_bf16 v[88:103], v[28:31], v[56:63], v12
  v_exp_f32 v66, v66
  v_exp_f32 v67, v67
  v_exp_f32 v68, v68
  v_exp_f32 v69, v69
  v_exp_f32 v70, v70
  v_exp_f32 v71, v71
  v_exp_f32 v40, v40
  v_exp_f32 v41, v41
  v_exp_f32 v42, v42
  v_exp_f32 v43, v43
  v_smfmac_f32_32x32x32_bf16 v[88:103], v[36:39], v[64:71], v12
  ds_read_b128 v[36:39], v155 offset:1536
  v_exp_f32 v44, v44
  v_exp_f32 v45, v45
  v_exp_f32 v46, v46
  v_mfma_f32_32x32x16_bf16 v[56:71], v[20:23], v[8:11], v[120:135]
  ds_read_b128 v[20:23], v1 offset:34816
  v_exp_f32 v47, v47
  v_exp_f32 v48, v48
  v_exp_f32 v49, v49
  s_waitcnt lgkmcnt(2)
  v_smfmac_f32_32x32x32_bf16 v[72:87], v[24:27], v[40:47], v12
  ds_read_b128 v[28:31], v155 offset:1024
  v_exp_f32 v50, v50
  v_exp_f32 v51, v51
  v_exp_f32 v52, v52
  v_exp_f32 v53, v53
  v_exp_f32 v54, v54
  v_exp_f32 v55, v55
  v_exp_f32 v56, v56
  v_exp_f32 v57, v57
  v_exp_f32 v58, v58
  v_exp_f32 v59, v59
  v_smfmac_f32_32x32x32_bf16 v[72:87], v[32:35], v[48:55], v12
  v_exp_f32 v60, v60
  v_exp_f32 v61, v61
  v_exp_f32 v62, v62
  v_mfma_f32_32x32x16_bf16 v[40:55], v[16:19], v[4:7], v[104:119]
  v_exp_f32 v63, v63
  v_exp_f32 v64, v64
  v_exp_f32 v65, v65
  v_smfmac_f32_32x32x32_bf16 v[88:103], v[24:27], v[56:63], v12
  v_exp_f32 v66, v66
  v_exp_f32 v67, v67
  v_exp_f32 v68, v68
  v_exp_f32 v69, v69
  v_exp_f32 v70, v70
  v_exp_f32 v71, v71
  v_exp_f32 v40, v40
  v_exp_f32 v41, v41
  v_exp_f32 v42, v42
  v_exp_f32 v43, v43
  v_smfmac_f32_32x32x32_bf16 v[88:103], v[32:35], v[64:71], v12
  ds_read_b128 v[32:35], v155 offset:2560
  v_exp_f32 v44, v44
  v_exp_f32 v45, v45
  v_exp_f32 v46, v46
  v_mfma_f32_32x32x16_bf16 v[56:71], v[16:19], v[8:11], v[120:135]
  ds_read_b128 v[16:19], v1 offset:35840
  v_exp_f32 v47, v47
  v_exp_f32 v48, v48
  v_exp_f32 v49, v49
  s_waitcnt lgkmcnt(2)
  v_smfmac_f32_32x32x32_bf16 v[72:87], v[28:31], v[40:47], v12
  ds_read_b128 v[24:27], v155 offset:2048
  v_exp_f32 v50, v50
  v_exp_f32 v51, v51
  v_exp_f32 v52, v52
  v_exp_f32 v53, v53
  v_exp_f32 v54, v54
  v_exp_f32 v55, v55
  v_exp_f32 v56, v56
  v_exp_f32 v57, v57
  v_exp_f32 v58, v58
  v_exp_f32 v59, v59
  v_smfmac_f32_32x32x32_bf16 v[72:87], v[36:39], v[48:55], v12
  v_exp_f32 v60, v60
  v_exp_f32 v61, v61
  v_exp_f32 v62, v62
  v_mfma_f32_32x32x16_bf16 v[40:55], v[20:23], v[4:7], v[104:119]
  v_exp_f32 v63, v63
  v_exp_f32 v64, v64
  v_exp_f32 v65, v65
  v_smfmac_f32_32x32x32_bf16 v[88:103], v[28:31], v[56:63], v12
  v_exp_f32 v66, v66
  v_exp_f32 v67, v67
  v_exp_f32 v68, v68
  v_exp_f32 v69, v69
  v_exp_f32 v70, v70
  v_exp_f32 v71, v71
  v_exp_f32 v40, v40
  v_exp_f32 v41, v41
  v_exp_f32 v42, v42
  v_exp_f32 v43, v43
  v_smfmac_f32_32x32x32_bf16 v[88:103], v[36:39], v[64:71], v12
  ds_read_b128 v[36:39], v155 offset:3584
  v_exp_f32 v44, v44
  v_exp_f32 v45, v45
  v_exp_f32 v46, v46
  v_mfma_f32_32x32x16_bf16 v[56:71], v[20:23], v[8:11], v[120:135]
  ds_read_b128 v[20:23], v1 offset:36864
  v_exp_f32 v47, v47
  v_exp_f32 v48, v48
  v_exp_f32 v49, v49
  s_waitcnt lgkmcnt(2)
  v_smfmac_f32_32x32x32_bf16 v[72:87], v[24:27], v[40:47], v12
  ds_read_b128 v[28:31], v155 offset:3072
  v_exp_f32 v50, v50
  v_exp_f32 v51, v51
  v_exp_f32 v52, v52
  v_exp_f32 v53, v53
  v_exp_f32 v54, v54
  v_exp_f32 v55, v55
  v_exp_f32 v56, v56
  v_exp_f32 v57, v57
  v_exp_f32 v58, v58
  v_exp_f32 v59, v59
  v_smfmac_f32_32x32x32_bf16 v[72:87], v[32:35], v[48:55], v12
  v_exp_f32 v60, v60
  v_exp_f32 v61, v61
  v_exp_f32 v62, v62
  v_mfma_f32_32x32x16_bf16 v[40:55], v[16:19], v[4:7], v[104:119]
  v_exp_f32 v63, v63
  v_exp_f32 v64, v64
  v_exp_f32 v65, v65
  v_smfmac_f32_32x32x32_bf16 v[88:103], v[24:27], v[56:63], v12
  v_exp_f32 v66, v66
  v_exp_f32 v67, v67
  v_exp_f32 v68, v68
  v_exp_f32 v69, v69
  v_exp_f32 v70, v70
  v_exp_f32 v71, v71
  v_exp_f32 v40, v40
  v_exp_f32 v41, v41
  v_exp_f32 v42, v42
  v_exp_f32 v43, v43
  v_smfmac_f32_32x32x32_bf16 v[88:103], v[32:35], v[64:71], v12
  ds_read_b128 v[32:35], v155 offset:4608
  v_exp_f32 v44, v44
  v_exp_f32 v45, v45
  v_exp_f32 v46, v46
  v_mfma_f32_32x32x16_bf16 v[56:71], v[16:19], v[8:11], v[120:135]
  ds_read_b128 v[16:19], v1 offset:37888
  v_exp_f32 v47, v47
  v_exp_f32 v48, v48
  v_exp_f32 v49, v49
  s_waitcnt lgkmcnt(2)
  v_smfmac_f32_32x32x32_bf16 v[72:87], v[28:31], v[40:47], v12
  ds_read_b128 v[24:27], v155 offset:4096
  v_exp_f32 v50, v50
  v_exp_f32 v51, v51
  v_exp_f32 v52, v52
  v_exp_f32 v53, v53
  v_exp_f32 v54, v54
  v_exp_f32 v55, v55
  v_exp_f32 v56, v56
  v_exp_f32 v57, v57
  v_exp_f32 v58, v58
  v_exp_f32 v59, v59
  v_smfmac_f32_32x32x32_bf16 v[72:87], v[36:39], v[48:55], v12
  v_exp_f32 v60, v60
  v_exp_f32 v61, v61
  v_exp_f32 v62, v62
  v_mfma_f32_32x32x16_bf16 v[40:55], v[20:23], v[4:7], v[104:119]
  v_exp_f32 v63, v63
  v_exp_f32 v64, v64
  v_exp_f32 v65, v65
  v_smfmac_f32_32x32x32_bf16 v[88:103], v[28:31], v[56:63], v12
  v_exp_f32 v66, v66
  v_exp_f32 v67, v67
  v_exp_f32 v68, v68
  v_exp_f32 v69, v69
  v_exp_f32 v70, v70
  v_exp_f32 v71, v71
  v_exp_f32 v40, v40
  v_exp_f32 v41, v41
  v_exp_f32 v42, v42
  v_exp_f32 v43, v43
  v_smfmac_f32_32x32x32_bf16 v[88:103], v[36:39], v[64:71], v12
  ds_read_b128 v[36:39], v155 offset:5632
  v_exp_f32 v44, v44
  v_exp_f32 v45, v45
  v_exp_f32 v46, v46
  v_mfma_f32_32x32x16_bf16 v[56:71], v[20:23], v[8:11], v[120:135]
  ds_read_b128 v[20:23], v1 offset:38912
  v_exp_f32 v47, v47
  v_exp_f32 v48, v48
  v_exp_f32 v49, v49
  s_waitcnt lgkmcnt(2)
  v_smfmac_f32_32x32x32_bf16 v[72:87], v[24:27], v[40:47], v12
  ds_read_b128 v[28:31], v155 offset:5120
  v_exp_f32 v50, v50
  v_exp_f32 v51, v51
  v_exp_f32 v52, v52
  v_exp_f32 v53, v53
  v_exp_f32 v54, v54
  v_exp_f32 v55, v55
  v_exp_f32 v56, v56
  v_exp_f32 v57, v57
  v_exp_f32 v58, v58
  v_exp_f32 v59, v59
  v_smfmac_f32_32x32x32_bf16 v[72:87], v[32:35], v[48:55], v12
  v_exp_f32 v60, v60
  v_exp_f32 v61, v61
  v_exp_f32 v62, v62
  v_mfma_f32_32x32x16_bf16 v[40:55], v[16:19], v[4:7], v[104:119]
  s_waitcnt vmcnt(0)
  s_barrier
  v_exp_f32 v63, v63
  v_exp_f32 v64, v64
  v_exp_f32 v65, v65
  v_smfmac_f32_32x32x32_bf16 v[88:103], v[24:27], v[56:63], v12
  s_add_u32 m0, s22, 16384
  s_add_u32 s25, s7, 7
  s_and_b32 s25, s25, 7
  s_lshl_b32 s25, s25, 13
  s_add_u32 s25, s25, s22
  buffer_load_dwordx4 v1, s[12:15], s25 offen sc1 lds
  buffer_load_dwordx4 v1, s[12:15], s25 offen offset:1024 sc1 lds
  s_add_u32 m0, s22, 24576
  s_nop 0
  buffer_load_dwordx4 v1, s[16:19], s25 offen sc1 lds
  buffer_load_dwordx4 v1, s[16:19], s25 offen offset:1024 sc1 lds
  v_exp_f32 v66, v66
  v_exp_f32 v67, v67
  v_exp_f32 v68, v68
  v_exp_f32 v69, v69
  v_exp_f32 v70, v70
  v_exp_f32 v71, v71
  v_exp_f32 v40, v40
  v_exp_f32 v41, v41
  v_exp_f32 v42, v42
  v_exp_f32 v43, v43
  v_smfmac_f32_32x32x32_bf16 v[88:103], v[32:35], v[64:71], v12
  ds_read_b128 v[32:35], v155 offset:6656
  v_exp_f32 v44, v44
  v_exp_f32 v45, v45
  v_exp_f32 v46, v46
  v_mfma_f32_32x32x16_bf16 v[56:71], v[16:19], v[8:11], v[120:135]
  ds_read_b128 v[16:19], v1 offset:39936
  v_exp_f32 v47, v47
  v_exp_f32 v48, v48
  v_exp_f32 v49, v49
  s_waitcnt lgkmcnt(2)
  v_smfmac_f32_32x32x32_bf16 v[72:87], v[28:31], v[40:47], v12
  ds_read_b128 v[24:27], v155 offset:6144
  v_exp_f32 v50, v50
  v_exp_f32 v51, v51
  v_exp_f32 v52, v52
  v_exp_f32 v53, v53
  v_exp_f32 v54, v54
  v_exp_f32 v55, v55
  v_exp_f32 v56, v56
  v_exp_f32 v57, v57
  v_exp_f32 v58, v58
  v_exp_f32 v59, v59
  v_smfmac_f32_32x32x32_bf16 v[72:87], v[36:39], v[48:55], v12
  v_exp_f32 v60, v60
  v_exp_f32 v61, v61
  v_exp_f32 v62, v62
  v_mfma_f32_32x32x16_bf16 v[40:55], v[20:23], v[4:7], v[104:119]
  v_exp_f32 v63, v63
  v_exp_f32 v64, v64
  v_exp_f32 v65, v65
  v_smfmac_f32_32x32x32_bf16 v[88:103], v[28:31], v[56:63], v12
  v_exp_f32 v66, v66
  v_exp_f32 v67, v67
  v_exp_f32 v68, v68
  v_exp_f32 v69, v69
  v_exp_f32 v70, v70
  v_exp_f32 v71, v71
  v_exp_f32 v40, v40
  v_exp_f32 v41, v41
  v_exp_f32 v42, v42
  v_exp_f32 v43, v43
  v_smfmac_f32_32x32x32_bf16 v[88:103], v[36:39], v[64:71], v12
  ds_read_b128 v[36:39], v155 offset:7680
  v_exp_f32 v44, v44
  v_exp_f32 v45, v45
  v_exp_f32 v46, v46
  v_mfma_f32_32x32x16_bf16 v[56:71], v[20:23], v[8:11], v[120:135]
  ds_read_b128 v[20:23], v1 offset:0
  v_exp_f32 v47, v47
  v_exp_f32 v48, v48
  v_exp_f32 v49, v49
  s_waitcnt lgkmcnt(2)
  v_smfmac_f32_32x32x32_bf16 v[72:87], v[24:27], v[40:47], v12
  ds_read_b128 v[28:31], v155 offset:7168
  v_exp_f32 v50, v50
  v_exp_f32 v51, v51
  v_exp_f32 v52, v52
  v_exp_f32 v53, v53
  v_exp_f32 v54, v54
  v_exp_f32 v55, v55
  v_exp_f32 v56, v56
  v_exp_f32 v57, v57
  v_exp_f32 v58, v58
  v_exp_f32 v59, v59
  v_smfmac_f32_32x32x32_bf16 v[72:87], v[32:35], v[48:55], v12
  v_exp_f32 v60, v60
  v_exp_f32 v61, v61
  v_exp_f32 v62, v62
  v_mfma_f32_32x32x16_bf16 v[40:55], v[16:19], v[4:7], v[104:119]
  v_exp_f32 v63, v63
  v_exp_f32 v64, v64
  v_exp_f32 v65, v65
  v_smfmac_f32_32x32x32_bf16 v[88:103], v[24:27], v[56:63], v12
  v_exp_f32 v66, v66
  v_exp_f32 v67, v67
  v_exp_f32 v68, v68
  v_exp_f32 v69, v69
  v_exp_f32 v70, v70
  v_exp_f32 v71, v71
  v_exp_f32 v40, v40
  v_exp_f32 v41, v41
  v_exp_f32 v42, v42
  v_exp_f32 v43, v43
  v_smfmac_f32_32x32x32_bf16 v[88:103], v[32:35], v[64:71], v12
  ds_read_b128 v[32:35], v153 offset:512
  v_exp_f32 v44, v44
  v_exp_f32 v45, v45
  v_exp_f32 v46, v46
  v_mfma_f32_32x32x16_bf16 v[56:71], v[16:19], v[8:11], v[120:135]
  ds_read_b128 v[16:19], v1 offset:1024
  v_exp_f32 v47, v47
  v_exp_f32 v48, v48
  v_exp_f32 v49, v49
  s_waitcnt lgkmcnt(2)
  v_smfmac_f32_32x32x32_bf16 v[72:87], v[28:31], v[40:47], v12
  ds_read_b128 v[24:27], v153 offset:0
  v_exp_f32 v50, v50
  v_exp_f32 v51, v51
  v_exp_f32 v52, v52
  v_exp_f32 v53, v53
  v_exp_f32 v54, v54
  v_exp_f32 v55, v55
  v_exp_f32 v56, v56
  v_exp_f32 v57, v57
  v_exp_f32 v58, v58
  v_exp_f32 v59, v59
  v_smfmac_f32_32x32x32_bf16 v[72:87], v[36:39], v[48:55], v12
  v_exp_f32 v60, v60
  v_exp_f32 v61, v61
  v_exp_f32 v62, v62
  v_mfma_f32_32x32x16_bf16 v[40:55], v[20:23], v[4:7], v[104:119]
  v_exp_f32 v63, v63
  v_exp_f32 v64, v64
  v_exp_f32 v65, v65
  v_smfmac_f32_32x32x32_bf16 v[88:103], v[28:31], v[56:63], v12
  v_exp_f32 v66, v66
  v_exp_f32 v67, v67
  v_exp_f32 v68, v68
  v_exp_f32 v69, v69
  v_exp_f32 v70, v70
  v_exp_f32 v71, v71
  v_exp_f32 v40, v40
  v_exp_f32 v41, v41
  v_exp_f32 v42, v42
  v_exp_f32 v43, v43
  v_smfmac_f32_32x32x32_bf16 v[88:103], v[36:39], v[64:71], v12
  ds_read_b128 v[36:39], v153 offset:1536
  v_exp_f32 v44, v44
  v_exp_f32 v45, v45
  v_exp_f32 v46, v46
  v_mfma_f32_32x32x16_bf16 v[56:71], v[20:23], v[8:11], v[120:135]
  ds_read_b128 v[20:23], v1 offset:2048
  v_exp_f32 v47, v47
  v_exp_f32 v48, v48
  v_exp_f32 v49, v49
  s_waitcnt lgkmcnt(2)
  v_smfmac_f32_32x32x32_bf16 v[72:87], v[24:27], v[40:47], v12
  ds_read_b128 v[28:31], v153 offset:1024
  v_exp_f32 v50, v50
  v_exp_f32 v51, v51
  v_exp_f32 v52, v52
  v_exp_f32 v53, v53
  v_exp_f32 v54, v54
  v_exp_f32 v55, v55
  v_exp_f32 v56, v56
  v_exp_f32 v57, v57
  v_exp_f32 v58, v58
  v_exp_f32 v59, v59
  v_smfmac_f32_32x32x32_bf16 v[72:87], v[32:35], v[48:55], v12
  v_exp_f32 v60, v60
  v_exp_f32 v61, v61
  v_exp_f32 v62, v62
  v_mfma_f32_32x32x16_bf16 v[40:55], v[16:19], v[4:7], v[104:119]
  v_exp_f32 v63, v63
  v_exp_f32 v64, v64
  v_exp_f32 v65, v65
  v_smfmac_f32_32x32x32_bf16 v[88:103], v[24:27], v[56:63], v12
  v_exp_f32 v66, v66
  v_exp_f32 v67, v67
  v_exp_f32 v68, v68
  v_exp_f32 v69, v69
  v_exp_f32 v70, v70
  v_exp_f32 v71, v71
  v_exp_f32 v40, v40
  v_exp_f32 v41, v41
  v_exp_f32 v42, v42
  v_exp_f32 v43, v43
  v_smfmac_f32_32x32x32_bf16 v[88:103], v[32:35], v[64:71], v12
  ds_read_b128 v[32:35], v153 offset:2560
  v_exp_f32 v44, v44
  v_exp_f32 v45, v45
  v_exp_f32 v46, v46
  v_mfma_f32_32x32x16_bf16 v[56:71], v[16:19], v[8:11], v[120:135]
  ds_read_b128 v[16:19], v1 offset:3072
  v_exp_f32 v47, v47
  v_exp_f32 v48, v48
  v_exp_f32 v49, v49
  s_waitcnt lgkmcnt(2)
  v_smfmac_f32_32x32x32_bf16 v[72:87], v[28:31], v[40:47], v12
  ds_read_b128 v[24:27], v153 offset:2048
  v_exp_f32 v50, v50
  v_exp_f32 v51, v51
  v_exp_f32 v52, v52
  v_exp_f32 v53, v53
  v_exp_f32 v54, v54
  v_exp_f32 v55, v55
  v_exp_f32 v56, v56
  v_exp_f32 v57, v57
  v_exp_f32 v58, v58
  v_exp_f32 v59, v59
  v_smfmac_f32_32x32x32_bf16 v[72:87], v[36:39], v[48:55], v12
  v_exp_f32 v60, v60
  v_exp_f32 v61, v61
  v_exp_f32 v62, v62
  v_mfma_f32_32x32x16_bf16 v[40:55], v[20:23], v[4:7], v[104:119]
  v_exp_f32 v63, v63
  v_exp_f32 v64, v64
  v_exp_f32 v65, v65
  v_smfmac_f32_32x32x32_bf16 v[88:103], v[28:31], v[56:63], v12
  v_exp_f32 v66, v66
  v_exp_f32 v67, v67
  v_exp_f32 v68, v68
  v_exp_f32 v69, v69
  v_exp_f32 v70, v70
  v_exp_f32 v71, v71
  v_exp_f32 v40, v40
  v_exp_f32 v41, v41
  v_exp_f32 v42, v42
  v_exp_f32 v43, v43
  v_smfmac_f32_32x32x32_bf16 v[88:103], v[36:39], v[64:71], v12
  ds_read_b128 v[36:39], v153 offset:3584
  v_exp_f32 v44, v44
  v_exp_f32 v45, v45
  v_exp_f32 v46, v46
  v_mfma_f32_32x32x16_bf16 v[56:71], v[20:23], v[8:11], v[120:135]
  ds_read_b128 v[20:23], v1 offset:4096
  v_exp_f32 v47, v47
  v_exp_f32 v48, v48
  v_exp_f32 v49, v49
  s_waitcnt lgkmcnt(2)
  v_smfmac_f32_32x32x32_bf16 v[72:87], v[24:27], v[40:47], v12
  ds_read_b128 v[28:31], v153 offset:3072
  v_exp_f32 v50, v50
  v_exp_f32 v51, v51
  v_exp_f32 v52, v52
  v_exp_f32 v53, v53
  v_exp_f32 v54, v54
  v_exp_f32 v55, v55
  v_exp_f32 v56, v56
  v_exp_f32 v57, v57
  v_exp_f32 v58, v58
  v_exp_f32 v59, v59
  v_smfmac_f32_32x32x32_bf16 v[72:87], v[32:35], v[48:55], v12
  v_exp_f32 v60, v60
  v_exp_f32 v61, v61
  v_exp_f32 v62, v62
  v_mfma_f32_32x32x16_bf16 v[40:55], v[16:19], v[4:7], v[104:119]
  v_exp_f32 v63, v63
  v_exp_f32 v64, v64
  v_exp_f32 v65, v65
  v_smfmac_f32_32x32x32_bf16 v[88:103], v[24:27], v[56:63], v12
  v_exp_f32 v66, v66
  v_exp_f32 v67, v67
  v_exp_f32 v68, v68
  v_exp_f32 v69, v69
  v_exp_f32 v70, v70
  v_exp_f32 v71, v71
  v_exp_f32 v40, v40
  v_exp_f32 v41, v41
  v_exp_f32 v42, v42
  v_exp_f32 v43, v43
  v_smfmac_f32_32x32x32_bf16 v[88:103], v[32:35], v[64:71], v12
  ds_read_b128 v[32:35], v153 offset:4608
  v_exp_f32 v44, v44
  v_exp_f32 v45, v45
  v_exp_f32 v46, v46
  v_mfma_f32_32x32x16_bf16 v[56:71], v[16:19], v[8:11], v[120:135]
  ds_read_b128 v[16:19], v1 offset:5120
  v_exp_f32 v47, v47
  v_exp_f32 v48, v48
  v_exp_f32 v49, v49
  s_waitcnt lgkmcnt(2)
  v_smfmac_f32_32x32x32_bf16 v[72:87], v[28:31], v[40:47], v12
  ds_read_b128 v[24:27], v153 offset:4096
  v_exp_f32 v50, v50
  v_exp_f32 v51, v51
  v_exp_f32 v52, v52
  v_exp_f32 v53, v53
  v_exp_f32 v54, v54
  v_exp_f32 v55, v55
  v_exp_f32 v56, v56
  v_exp_f32 v57, v57
  v_exp_f32 v58, v58
  v_exp_f32 v59, v59
  v_smfmac_f32_32x32x32_bf16 v[72:87], v[36:39], v[48:55], v12
  v_exp_f32 v60, v60
  v_exp_f32 v61, v61
  v_exp_f32 v62, v62
  v_mfma_f32_32x32x16_bf16 v[40:55], v[20:23], v[4:7], v[104:119]
  v_exp_f32 v63, v63
  v_exp_f32 v64, v64
  v_exp_f32 v65, v65
  v_smfmac_f32_32x32x32_bf16 v[88:103], v[28:31], v[56:63], v12
  v_exp_f32 v66, v66
  v_exp_f32 v67, v67
  v_exp_f32 v68, v68
  v_exp_f32 v69, v69
  v_exp_f32 v70, v70
  v_exp_f32 v71, v71
  v_exp_f32 v40, v40
  v_exp_f32 v41, v41
  v_exp_f32 v42, v42
  v_exp_f32 v43, v43
  v_smfmac_f32_32x32x32_bf16 v[88:103], v[36:39], v[64:71], v12
  ds_read_b128 v[36:39], v153 offset:5632
  v_exp_f32 v44, v44
  v_exp_f32 v45, v45
  v_exp_f32 v46, v46
  v_mfma_f32_32x32x16_bf16 v[56:71], v[20:23], v[8:11], v[120:135]
  ds_read_b128 v[20:23], v1 offset:6144
  v_exp_f32 v47, v47
  v_exp_f32 v48, v48
  v_exp_f32 v49, v49
  s_waitcnt lgkmcnt(2)
  v_smfmac_f32_32x32x32_bf16 v[72:87], v[24:27], v[40:47], v12
  ds_read_b128 v[28:31], v153 offset:5120
  v_exp_f32 v50, v50
  v_exp_f32 v51, v51
  v_exp_f32 v52, v52
  v_exp_f32 v53, v53
  v_exp_f32 v54, v54
  v_exp_f32 v55, v55
  v_exp_f32 v56, v56
  v_exp_f32 v57, v57
  v_exp_f32 v58, v58
  v_exp_f32 v59, v59
  v_smfmac_f32_32x32x32_bf16 v[72:87], v[32:35], v[48:55], v12
  v_exp_f32 v60, v60
  v_exp_f32 v61, v61
  v_exp_f32 v62, v62
  v_mfma_f32_32x32x16_bf16 v[40:55], v[16:19], v[4:7], v[104:119]
  s_waitcnt vmcnt(0)
  s_barrier
  v_exp_f32 v63, v63
  v_exp_f32 v64, v64
  v_exp_f32 v65, v65
  v_smfmac_f32_32x32x32_bf16 v[88:103], v[24:27], v[56:63], v12
  v_exp_f32 v66, v66
  v_exp_f32 v67, v67
  v_exp_f32 v68, v68
  v_exp_f32 v69, v69
  v_exp_f32 v70, v70
  v_exp_f32 v71, v71
  v_exp_f32 v40, v40
  v_exp_f32 v41, v41
  v_exp_f32 v42, v42
  v_exp_f32 v43, v43
  v_smfmac_f32_32x32x32_bf16 v[88:103], v[32:35], v[64:71], v12
  ds_read_b128 v[32:35], v153 offset:6656
  v_exp_f32 v44, v44
  v_exp_f32 v45, v45
  v_exp_f32 v46, v46
  v_mfma_f32_32x32x16_bf16 v[56:71], v[16:19], v[8:11], v[120:135]
  ds_read_b128 v[16:19], v1 offset:7168
  v_exp_f32 v47, v47
  v_exp_f32 v48, v48
  v_exp_f32 v49, v49
  s_waitcnt lgkmcnt(2)
  v_smfmac_f32_32x32x32_bf16 v[72:87], v[28:31], v[40:47], v12
  ds_read_b128 v[24:27], v153 offset:6144
  v_exp_f32 v50, v50
  v_exp_f32 v51, v51
  v_exp_f32 v52, v52
  v_exp_f32 v53, v53
  v_exp_f32 v54, v54
  v_exp_f32 v55, v55
  v_exp_f32 v56, v56
  v_exp_f32 v57, v57
  v_exp_f32 v58, v58
  v_exp_f32 v59, v59
  v_smfmac_f32_32x32x32_bf16 v[72:87], v[36:39], v[48:55], v12
  v_exp_f32 v60, v60
  v_exp_f32 v61, v61
  v_exp_f32 v62, v62
  v_mfma_f32_32x32x16_bf16 v[40:55], v[20:23], v[4:7], v[104:119]
  v_exp_f32 v63, v63
  v_exp_f32 v64, v64
  v_exp_f32 v65, v65
  v_smfmac_f32_32x32x32_bf16 v[88:103], v[28:31], v[56:63], v12
  v_exp_f32 v66, v66
  v_exp_f32 v67, v67
  v_exp_f32 v68, v68
  v_exp_f32 v69, v69
  v_exp_f32 v70, v70
  v_exp_f32 v71, v71
  v_exp_f32 v40, v40
  v_exp_f32 v41, v41
  v_exp_f32 v42, v42
  v_exp_f32 v43, v43
  v_smfmac_f32_32x32x32_bf16 v[88:103], v[36:39], v[64:71], v12
  ds_read_b128 v[36:39], v153 offset:7680
  v_exp_f32 v44, v44
  v_exp_f32 v45, v45
  v_exp_f32 v46, v46
  v_mfma_f32_32x32x16_bf16 v[56:71], v[20:23], v[8:11], v[120:135]
  ds_read_b128 v[20:23], v1 offset:16384
  v_exp_f32 v47, v47
  v_exp_f32 v48, v48
  v_exp_f32 v49, v49
  s_waitcnt lgkmcnt(2)
  v_smfmac_f32_32x32x32_bf16 v[72:87], v[24:27], v[40:47], v12
  ds_read_b128 v[28:31], v153 offset:7168
  v_exp_f32 v50, v50
  v_exp_f32 v51, v51
  v_exp_f32 v52, v52
  v_exp_f32 v53, v53
  v_exp_f32 v54, v54
  v_exp_f32 v55, v55
  v_exp_f32 v56, v56
  v_exp_f32 v57, v57
  v_exp_f32 v58, v58
  v_exp_f32 v59, v59
  v_smfmac_f32_32x32x32_bf16 v[72:87], v[32:35], v[48:55], v12
  v_exp_f32 v60, v60
  v_exp_f32 v61, v61
  v_exp_f32 v62, v62
  v_mfma_f32_32x32x16_bf16 v[40:55], v[16:19], v[4:7], v[104:119]
  v_exp_f32 v63, v63
  v_exp_f32 v64, v64
  v_exp_f32 v65, v65
  v_smfmac_f32_32x32x32_bf16 v[88:103], v[24:27], v[56:63], v12
  v_exp_f32 v66, v66
  v_exp_f32 v67, v67
  v_exp_f32 v68, v68
  v_exp_f32 v69, v69
  v_exp_f32 v70, v70
  v_exp_f32 v71, v71
  v_exp_f32 v40, v40
  v_exp_f32 v41, v41
  v_exp_f32 v42, v42
  v_exp_f32 v43, v43
  v_smfmac_f32_32x32x32_bf16 v[88:103], v[32:35], v[64:71], v12
  ds_read_b128 v[32:35], v154 offset:512
  v_exp_f32 v44, v44
  v_exp_f32 v45, v45
  v_exp_f32 v46, v46
  v_mfma_f32_32x32x16_bf16 v[56:71], v[16:19], v[8:11], v[120:135]
  ds_read_b128 v[16:19], v1 offset:17408
  v_exp_f32 v47, v47
  v_exp_f32 v48, v48
  v_exp_f32 v49, v49
  s_waitcnt lgkmcnt(2)
  v_smfmac_f32_32x32x32_bf16 v[72:87], v[28:31], v[40:47], v12
  ds_read_b128 v[24:27], v154 offset:0
  v_exp_f32 v50, v50
  v_exp_f32 v51, v51
  v_exp_f32 v52, v52
  v_exp_f32 v53, v53
  v_exp_f32 v54, v54
  v_exp_f32 v55, v55
  v_exp_f32 v56, v56
  v_exp_f32 v57, v57
  v_exp_f32 v58, v58
  v_exp_f32 v59, v59
  v_smfmac_f32_32x32x32_bf16 v[72:87], v[36:39], v[48:55], v12
  v_exp_f32 v60, v60
  v_exp_f32 v61, v61
  v_exp_f32 v62, v62
  v_mfma_f32_32x32x16_bf16 v[40:55], v[20:23], v[4:7], v[104:119]
  v_exp_f32 v63, v63
  v_exp_f32 v64, v64
  v_exp_f32 v65, v65
  v_smfmac_f32_32x32x32_bf16 v[88:103], v[28:31], v[56:63], v12
  v_exp_f32 v66, v66
  v_exp_f32 v67, v67
  v_exp_f32 v68, v68
  v_exp_f32 v69, v69
  v_exp_f32 v70, v70
  v_exp_f32 v71, v71
  v_exp_f32 v40, v40
  v_exp_f32 v41, v41
  v_exp_f32 v42, v42
  v_exp_f32 v43, v43
  v_smfmac_f32_32x32x32_bf16 v[88:103], v[36:39], v[64:71], v12
  ds_read_b128 v[36:39], v154 offset:1536
  v_exp_f32 v44, v44
  v_exp_f32 v45, v45
  v_exp_f32 v46, v46
  v_mfma_f32_32x32x16_bf16 v[56:71], v[20:23], v[8:11], v[120:135]
  ds_read_b128 v[20:23], v1 offset:18432
  v_exp_f32 v47, v47
  v_exp_f32 v48, v48
  v_exp_f32 v49, v49
  s_waitcnt lgkmcnt(2)
  v_smfmac_f32_32x32x32_bf16 v[72:87], v[24:27], v[40:47], v12
  ds_read_b128 v[28:31], v154 offset:1024
  v_exp_f32 v50, v50
  v_exp_f32 v51, v51
  v_exp_f32 v52, v52
  v_exp_f32 v53, v53
  v_exp_f32 v54, v54
  v_exp_f32 v55, v55
  v_exp_f32 v56, v56
  v_exp_f32 v57, v57
  v_exp_f32 v58, v58
  v_exp_f32 v59, v59
  v_smfmac_f32_32x32x32_bf16 v[72:87], v[32:35], v[48:55], v12
  v_exp_f32 v60, v60
  v_exp_f32 v61, v61
  v_exp_f32 v62, v62
  v_mfma_f32_32x32x16_bf16 v[40:55], v[16:19], v[4:7], v[104:119]
  v_exp_f32 v63, v63
  v_exp_f32 v64, v64
  v_exp_f32 v65, v65
  v_smfmac_f32_32x32x32_bf16 v[88:103], v[24:27], v[56:63], v12
  v_exp_f32 v66, v66
  v_exp_f32 v67, v67
  v_exp_f32 v68, v68
  v_exp_f32 v69, v69
  v_exp_f32 v70, v70
  v_exp_f32 v71, v71
  v_exp_f32 v40, v40
  v_exp_f32 v41, v41
  v_exp_f32 v42, v42
  v_exp_f32 v43, v43
  v_smfmac_f32_32x32x32_bf16 v[88:103], v[32:35], v[64:71], v12
  ds_read_b128 v[32:35], v154 offset:2560
  v_exp_f32 v44, v44
  v_exp_f32 v45, v45
  v_exp_f32 v46, v46
  v_mfma_f32_32x32x16_bf16 v[56:71], v[16:19], v[8:11], v[120:135]
  ds_read_b128 v[16:19], v1 offset:19456
  v_exp_f32 v47, v47
  v_exp_f32 v48, v48
  v_exp_f32 v49, v49
  s_waitcnt lgkmcnt(2)
  v_smfmac_f32_32x32x32_bf16 v[72:87], v[28:31], v[40:47], v12
  ds_read_b128 v[24:27], v154 offset:2048
  v_exp_f32 v50, v50
  v_exp_f32 v51, v51
  v_exp_f32 v52, v52
  v_exp_f32 v53, v53
  v_exp_f32 v54, v54
  v_exp_f32 v55, v55
  v_exp_f32 v56, v56
  v_exp_f32 v57, v57
  v_exp_f32 v58, v58
  v_exp_f32 v59, v59
  v_smfmac_f32_32x32x32_bf16 v[72:87], v[36:39], v[48:55], v12
  v_exp_f32 v60, v60
  v_exp_f32 v61, v61
  v_exp_f32 v62, v62
  v_mfma_f32_32x32x16_bf16 v[40:55], v[20:23], v[4:7], v[104:119]
  v_exp_f32 v63, v63
  v_exp_f32 v64, v64
  v_exp_f32 v65, v65
  v_smfmac_f32_32x32x32_bf16 v[88:103], v[28:31], v[56:63], v12
  v_exp_f32 v66, v66
  v_exp_f32 v67, v67
  v_exp_f32 v68, v68
  v_exp_f32 v69, v69
  v_exp_f32 v70, v70
  v_exp_f32 v71, v71
  v_exp_f32 v40, v40
  v_exp_f32 v41, v41
  v_exp_f32 v42, v42
  v_exp_f32 v43, v43
  v_smfmac_f32_32x32x32_bf16 v[88:103], v[36:39], v[64:71], v12
  ds_read_b128 v[36:39], v154 offset:3584
  v_exp_f32 v44, v44
  v_exp_f32 v45, v45
  v_exp_f32 v46, v46
  v_mfma_f32_32x32x16_bf16 v[56:71], v[20:23], v[8:11], v[120:135]
  ds_read_b128 v[20:23], v1 offset:20480
  v_exp_f32 v47, v47
  v_exp_f32 v48, v48
  v_exp_f32 v49, v49
  s_waitcnt lgkmcnt(2)
  v_smfmac_f32_32x32x32_bf16 v[72:87], v[24:27], v[40:47], v12
  ds_read_b128 v[28:31], v154 offset:3072
  v_exp_f32 v50, v50
  v_exp_f32 v51, v51
  v_exp_f32 v52, v52
  v_exp_f32 v53, v53
  v_exp_f32 v54, v54
  v_exp_f32 v55, v55
  v_exp_f32 v56, v56
  v_exp_f32 v57, v57
  v_exp_f32 v58, v58
  v_exp_f32 v59, v59
  v_smfmac_f32_32x32x32_bf16 v[72:87], v[32:35], v[48:55], v12
  v_exp_f32 v60, v60
  v_exp_f32 v61, v61
  v_exp_f32 v62, v62
  v_mfma_f32_32x32x16_bf16 v[40:55], v[16:19], v[4:7], v[104:119]
  v_exp_f32 v63, v63
  v_exp_f32 v64, v64
  v_exp_f32 v65, v65
  v_smfmac_f32_32x32x32_bf16 v[88:103], v[24:27], v[56:63], v12
  v_exp_f32 v66, v66
  v_exp_f32 v67, v67
  v_exp_f32 v68, v68
  v_exp_f32 v69, v69
  v_exp_f32 v70, v70
  v_exp_f32 v71, v71
  v_exp_f32 v40, v40
  v_exp_f32 v41, v41
  v_exp_f32 v42, v42
  v_exp_f32 v43, v43
  v_smfmac_f32_32x32x32_bf16 v[88:103], v[32:35], v[64:71], v12
  ds_read_b128 v[32:35], v154 offset:4608
  v_exp_f32 v44, v44
  v_exp_f32 v45, v45
  v_exp_f32 v46, v46
  v_mfma_f32_32x32x16_bf16 v[56:71], v[16:19], v[8:11], v[120:135]
  ds_read_b128 v[16:19], v1 offset:21504
  v_exp_f32 v47, v47
  v_exp_f32 v48, v48
  v_exp_f32 v49, v49
  s_waitcnt lgkmcnt(2)
  v_smfmac_f32_32x32x32_bf16 v[72:87], v[28:31], v[40:47], v12
  ds_read_b128 v[24:27], v154 offset:4096
  v_exp_f32 v50, v50
  v_exp_f32 v51, v51
  v_exp_f32 v52, v52
  v_exp_f32 v53, v53
  v_exp_f32 v54, v54
  v_exp_f32 v55, v55
  v_exp_f32 v56, v56
  v_exp_f32 v57, v57
  v_exp_f32 v58, v58
  v_exp_f32 v59, v59
  v_smfmac_f32_32x32x32_bf16 v[72:87], v[36:39], v[48:55], v12
  v_exp_f32 v60, v60
  v_exp_f32 v61, v61
  v_exp_f32 v62, v62
  v_mfma_f32_32x32x16_bf16 v[40:55], v[20:23], v[4:7], v[104:119]
  v_exp_f32 v63, v63
  v_exp_f32 v64, v64
  v_exp_f32 v65, v65
  v_smfmac_f32_32x32x32_bf16 v[88:103], v[28:31], v[56:63], v12
  v_exp_f32 v66, v66
  v_exp_f32 v67, v67
  v_exp_f32 v68, v68
  v_exp_f32 v69, v69
  v_exp_f32 v70, v70
  v_exp_f32 v71, v71
  v_exp_f32 v40, v40
  v_exp_f32 v41, v41
  v_exp_f32 v42, v42
  v_exp_f32 v43, v43
  v_smfmac_f32_32x32x32_bf16 v[88:103], v[36:39], v[64:71], v12
  ds_read_b128 v[36:39], v154 offset:5632
  v_exp_f32 v44, v44
  v_exp_f32 v45, v45
  v_exp_f32 v46, v46
  v_mfma_f32_32x32x16_bf16 v[56:71], v[20:23], v[8:11], v[120:135]
  ds_read_b128 v[20:23], v1 offset:22528
  v_exp_f32 v47, v47
  v_exp_f32 v48, v48
  v_exp_f32 v49, v49
  s_waitcnt lgkmcnt(2)
  v_smfmac_f32_32x32x32_bf16 v[72:87], v[24:27], v[40:47], v12
  ds_read_b128 v[28:31], v154 offset:5120
  v_exp_f32 v50, v50
  v_exp_f32 v51, v51
  v_exp_f32 v52, v52
  v_exp_f32 v53, v53
  v_exp_f32 v54, v54
  v_exp_f32 v55, v55
  v_exp_f32 v56, v56
  v_exp_f32 v57, v57
  v_exp_f32 v58, v58
  v_exp_f32 v59, v59
  v_smfmac_f32_32x32x32_bf16 v[72:87], v[32:35], v[48:55], v12
  v_exp_f32 v60, v60
  v_exp_f32 v61, v61
  v_exp_f32 v62, v62
  v_mfma_f32_32x32x16_bf16 v[40:55], v[16:19], v[4:7], v[104:119]
  v_exp_f32 v63, v63
  v_exp_f32 v64, v64
  v_exp_f32 v65, v65
  v_smfmac_f32_32x32x32_bf16 v[88:103], v[24:27], v[56:63], v12
  v_exp_f32 v66, v66
  v_exp_f32 v67, v67
  v_exp_f32 v68, v68
  v_exp_f32 v69, v69
  v_exp_f32 v70, v70
  v_exp_f32 v71, v71
  v_exp_f32 v40, v40
  v_exp_f32 v41, v41
  v_exp_f32 v42, v42
  v_exp_f32 v43, v43
  v_smfmac_f32_32x32x32_bf16 v[88:103], v[32:35], v[64:71], v12
  ds_read_b128 v[32:35], v154 offset:6656
  v_exp_f32 v44, v44
  v_exp_f32 v45, v45
  v_exp_f32 v46, v46
  v_mfma_f32_32x32x16_bf16 v[56:71], v[16:19], v[8:11], v[120:135]
  ds_read_b128 v[16:19], v1 offset:23552
  v_exp_f32 v47, v47
  v_exp_f32 v48, v48
  v_exp_f32 v49, v49
  s_waitcnt lgkmcnt(2)
  v_smfmac_f32_32x32x32_bf16 v[72:87], v[28:31], v[40:47], v12
  ds_read_b128 v[24:27], v154 offset:6144
  v_exp_f32 v50, v50
  v_exp_f32 v51, v51
  v_exp_f32 v52, v52
  v_exp_f32 v53, v53
  v_exp_f32 v54, v54
  v_exp_f32 v55, v55
  v_exp_f32 v56, v56
  v_exp_f32 v57, v57
  v_exp_f32 v58, v58
  v_exp_f32 v59, v59
  v_smfmac_f32_32x32x32_bf16 v[72:87], v[36:39], v[48:55], v12
  v_exp_f32 v60, v60
  v_exp_f32 v61, v61
  v_exp_f32 v62, v62
  v_mfma_f32_32x32x16_bf16 v[40:55], v[20:23], v[4:7], v[104:119]
  v_exp_f32 v63, v63
  v_exp_f32 v64, v64
  v_exp_f32 v65, v65
  v_smfmac_f32_32x32x32_bf16 v[88:103], v[28:31], v[56:63], v12
  v_exp_f32 v66, v66
  v_exp_f32 v67, v67
  v_exp_f32 v68, v68
  v_exp_f32 v69, v69
  v_exp_f32 v70, v70
  v_exp_f32 v71, v71
  v_exp_f32 v40, v40
  v_exp_f32 v41, v41
  v_exp_f32 v42, v42
  v_exp_f32 v43, v43
  v_smfmac_f32_32x32x32_bf16 v[88:103], v[36:39], v[64:71], v12
  ds_read_b128 v[36:39], v154 offset:7680
  v_exp_f32 v44, v44
  v_exp_f32 v45, v45
  v_exp_f32 v46, v46
  v_mfma_f32_32x32x16_bf16 v[56:71], v[20:23], v[8:11], v[120:135]
  v_exp_f32 v47, v47
  v_exp_f32 v48, v48
  v_exp_f32 v49, v49
  s_waitcnt lgkmcnt(1)
  v_smfmac_f32_32x32x32_bf16 v[72:87], v[24:27], v[40:47], v12
  ds_read_b128 v[28:31], v154 offset:7168
  v_exp_f32 v50, v50
  v_exp_f32 v51, v51
  v_exp_f32 v52, v52
  v_exp_f32 v53, v53
  v_exp_f32 v54, v54
  v_exp_f32 v55, v55
  v_exp_f32 v56, v56
  v_exp_f32 v57, v57
  v_exp_f32 v58, v58
  v_exp_f32 v59, v59
  v_smfmac_f32_32x32x32_bf16 v[72:87], v[32:35], v[48:55], v12
  v_exp_f32 v60, v60
  v_exp_f32 v61, v61
  v_exp_f32 v62, v62
  v_mfma_f32_32x32x16_bf16 v[40:55], v[16:19], v[4:7], v[104:119]
  v_exp_f32 v63, v63
  v_exp_f32 v64, v64
  v_exp_f32 v65, v65
  v_smfmac_f32_32x32x32_bf16 v[88:103], v[24:27], v[56:63], v12
  v_exp_f32 v66, v66
  v_exp_f32 v67, v67
  v_exp_f32 v68, v68
  v_exp_f32 v69, v69
  v_exp_f32 v70, v70
  v_exp_f32 v71, v71
  v_exp_f32 v40, v40
  v_exp_f32 v41, v41
  v_exp_f32 v42, v42
  v_exp_f32 v43, v43
  v_smfmac_f32_32x32x32_bf16 v[88:103], v[32:35], v[64:71], v12
  v_exp_f32 v44, v44
  v_exp_f32 v45, v45
  v_exp_f32 v46, v46
  v_mfma_f32_32x32x16_bf16 v[56:71], v[16:19], v[8:11], v[120:135]
  v_exp_f32 v47, v47
  v_exp_f32 v48, v48
  v_exp_f32 v49, v49
  s_waitcnt lgkmcnt(0)
  v_smfmac_f32_32x32x32_bf16 v[72:87], v[28:31], v[40:47], v12
  v_exp_f32 v50, v50
  v_exp_f32 v51, v51
  v_exp_f32 v52, v52
  v_exp_f32 v53, v53
  v_exp_f32 v54, v54
  v_exp_f32 v55, v55
  v_exp_f32 v56, v56
  v_exp_f32 v57, v57
  v_exp_f32 v58, v58
  v_exp_f32 v59, v59
  v_smfmac_f32_32x32x32_bf16 v[72:87], v[36:39], v[48:55], v12
  v_exp_f32 v60, v60
  v_exp_f32 v61, v61
  v_exp_f32 v62, v62
  v_exp_f32 v63, v63
  v_exp_f32 v64, v64
  v_exp_f32 v65, v65
  v_smfmac_f32_32x32x32_bf16 v[88:103], v[28:31], v[56:63], v12
  v_exp_f32 v66, v66
  v_exp_f32 v67, v67
  v_exp_f32 v68, v68
  v_exp_f32 v69, v69
  v_exp_f32 v70, v70
  v_exp_f32 v71, v71
  s_nop 1
  v_smfmac_f32_32x32x32_bf16 v[88:103], v[36:39], v[64:71], v12
  s_nop 7
  s_nop 7
  v_rcp_f32 v15, v80
  s_nop 0
  v_mul_f32 v72, v72, v15
  v_mul_f32 v73, v73, v15
  v_mul_f32 v74, v74, v15
  v_mul_f32 v75, v75, v15
  v_mul_f32 v76, v76, v15
  v_mul_f32 v77, v77, v15
  v_mul_f32 v78, v78, v15
  v_mul_f32 v79, v79, v15
  v_cvt_pk_bf16_f32 v136, v72, v73
  v_cvt_pk_bf16_f32 v137, v74, v75
  v_cvt_pk_bf16_f32 v138, v76, v77
  v_cvt_pk_bf16_f32 v139, v78, v79
  global_store_dwordx4 v156, v[136:139], s[36:37] sc1
  v_rcp_f32 v15, v96
  s_nop 0
  v_mul_f32 v88, v88, v15
  v_mul_f32 v89, v89, v15
  v_mul_f32 v90, v90, v15
  v_mul_f32 v91, v91, v15
  v_mul_f32 v92, v92, v15
  v_mul_f32 v93, v93, v15
  v_mul_f32 v94, v94, v15
  v_mul_f32 v95, v95, v15
  v_cvt_pk_bf16_f32 v140, v88, v89
  v_cvt_pk_bf16_f32 v141, v90, v91
  v_cvt_pk_bf16_f32 v142, v92, v93
  v_cvt_pk_bf16_f32 v143, v94, v95
  global_store_dwordx4 v159, v[140:143], s[36:37] sc1
  v_mov_b32 v148, 0
  v_fma_f32 v148, v72, 0, v148
  v_fma_f32 v148, v73, 0, v148
  v_fma_f32 v148, v74, 0, v148
  v_fma_f32 v148, v75, 0, v148
  v_fma_f32 v148, v76, 0, v148
  v_fma_f32 v148, v77, 0, v148
  v_fma_f32 v148, v78, 0, v148
  v_fma_f32 v148, v79, 0, v148
  v_fma_f32 v148, v88, 0, v148
  v_fma_f32 v148, v89, 0, v148
  v_fma_f32 v148, v90, 0, v148
  v_fma_f32 v148, v91, 0, v148
  v_fma_f32 v148, v92, 0, v148
  v_fma_f32 v148, v93, 0, v148
  v_fma_f32 v148, v94, 0, v148
  v_fma_f32 v148, v95, 0, v148
  s_mov_b32 s26, 0x21800000
  s_mov_b32 s27, 0x71800000
  v_cmp_eq_f32 vcc, 0, v148
  v_cmp_ge_f32 s[28:29], v80, s26
  s_and_b64 vcc, vcc, s[28:29]
  v_cmp_le_f32 s[28:29], v80, s27
  s_and_b64 vcc, vcc, s[28:29]
  v_cmp_ge_f32 s[28:29], v96, s26
  s_and_b64 vcc, vcc, s[28:29]
  v_cmp_le_f32 s[28:29], v96, s27
  s_and_b64 vcc, vcc, s[28:29]
  s_cmp_eq_u64 vcc, -1
  s_cselect_b32 s26, 0, 1
  s_lshl_b32 s27, s8, 2
  s_add_u32 s27, s27, 57344
  v_mov_b32 v148, s27
  v_mov_b32 v149, s26
  ds_write_b32 v148, v149
  s_waitcnt vmcnt(0) lgkmcnt(0)
  s_barrier
  s_cmp_lg_u32 s32, 0
  s_cbranch_scc1 attn_fin
  v_mov_b32 v136, 57344
  ds_read_b128 v[140:143], v136
  s_waitcnt lgkmcnt(0)
  v_or_b32 v140, v140, v141
  v_or3_b32 v140, v140, v142, v143
  s_nop 1
  v_readfirstlane_b32 s26, v140
  s_nop 3
  s_cmp_eq_u32 s26, 0
  s_cbranch_scc1 attn_fin
  s_mov_b32 s32, 1
  v_mov_b32 v144, 0xff800000
  v_mov_b32 v145, 0xff800000
  v_mov_b32 v13, v1
  s_mov_b32 s26, 64
attn_maxloop:
  global_load_dwordx4 v[16:19], v13, s[38:39] sc1
  v_add_u32 v13, 1024, v13
  s_waitcnt vmcnt(0)
  v_mfma_f32_32x32x16_bf16 v[40:55], v[16:19], v[4:7], 0
  v_mfma_f32_32x32x16_bf16 v[56:71], v[16:19], v[8:11], 0
  s_nop 15
  s_nop 7
  v_max3_f32 v144, v40, v41, v144
  v_max3_f32 v144, v42, v43, v144
  v_max3_f32 v144, v44, v45, v144
  v_max3_f32 v144, v46, v47, v144
  v_max3_f32 v144, v48, v49, v144
  v_max3_f32 v144, v50, v51, v144
  v_max3_f32 v144, v52, v53, v144
  v_max3_f32 v144, v54, v55, v144
  v_max3_f32 v145, v56, v57, v145
  v_max3_f32 v145, v58, v59, v145
  v_max3_f32 v145, v60, v61, v145
  v_max3_f32 v145, v62, v63, v145
  v_max3_f32 v145, v64, v65, v145
  v_max3_f32 v145, v66, v67, v145
  v_max3_f32 v145, v68, v69, v145
  v_max3_f32 v145, v70, v71, v145
  s_sub_u32 s26, s26, 1
  s_cmp_lg_u32 s26, 0
  s_cbranch_scc1 attn_maxloop
  v_mov_b32 v146, v144
  s_nop 1
  v_permlane32_swap_b32 v146, v144
  s_nop 1
  v_max_f32 v144, v146, v144
  v_mov_b32 v146, v145
  s_nop 1
  v_permlane32_swap_b32 v146, v145
  s_nop 1
  v_max_f32 v145, v146, v145
  v_sub_f32 v104, 0, v144
  v_sub_f32 v120, 0, v145
  v_sub_f32 v105, 0, v144
  v_sub_f32 v121, 0, v145
  v_sub_f32 v106, 0, v144
  v_sub_f32 v122, 0, v145
  v_sub_f32 v107, 0, v144
  v_sub_f32 v123, 0, v145
  v_sub_f32 v108, 0, v144
  v_sub_f32 v124, 0, v145
  v_sub_f32 v109, 0, v144
  v_sub_f32 v125, 0, v145
  v_sub_f32 v110, 0, v144
  v_sub_f32 v126, 0, v145
  v_sub_f32 v111, 0, v144
  v_sub_f32 v127, 0, v145
  v_sub_f32 v112, 0, v144
  v_sub_f32 v128, 0, v145
  v_sub_f32 v113, 0, v144
  v_sub_f32 v129, 0, v145
  v_sub_f32 v114, 0, v144
  v_sub_f32 v130, 0, v145
  v_sub_f32 v115, 0, v144
  v_sub_f32 v131, 0, v145
  v_sub_f32 v116, 0, v144
  v_sub_f32 v132, 0, v145
  v_sub_f32 v117, 0, v144
  v_sub_f32 v133, 0, v145
  v_sub_f32 v118, 0, v144
  v_sub_f32 v134, 0, v145
  v_sub_f32 v119, 0, v144
  v_sub_f32 v135, 0, v145
  s_barrier
  s_add_u32 m0, s22, 0
  s_add_u32 s25, s7, 0
  s_and_b32 s25, s25, 7
  s_lshl_b32 s25, s25, 13
  s_add_u32 s25, s25, s22
  buffer_load_dwordx4 v1, s[12:15], s25 offen sc1 lds
  buffer_load_dwordx4 v1, s[12:15], s25 offen offset:1024 sc1 lds
  s_add_u32 m0, s22, 8192
  s_nop 0
  buffer_load_dwordx4 v1, s[16:19], s25 offen sc1 lds
  buffer_load_dwordx4 v1, s[16:19], s25 offen offset:1024 sc1 lds
  s_add_u32 m0, s22, 16384
  s_add_u32 s25, s7, 1
  s_and_b32 s25, s25, 7
  s_lshl_b32 s25, s25, 13
  s_add_u32 s25, s25, s22
  buffer_load_dwordx4 v1, s[12:15], s25 offen sc1 lds
  buffer_load_dwordx4 v1, s[12:15], s25 offen offset:1024 sc1 lds
  s_add_u32 m0, s22, 24576
  s_nop 0
  buffer_load_dwordx4 v1, s[16:19], s25 offen sc1 lds
  buffer_load_dwordx4 v1, s[16:19], s25 offen offset:1024 sc1 lds
  s_waitcnt vmcnt(4)
  s_branch attn_pass
attn_fin:
  s_lshl_b32 s50, s7, 3
  s_cmp_lg_u32 s8, 0
  s_cbranch_scc1 sig_5
  v_add_u32 v136, s50, v0
  v_lshlrev_b32 v136, 8, v136
  v_add_u32 v136, 18989056, v136
  v_mov_b32 v137, 1
  s_mov_b64 exec, 255
  global_atomic_add v136, v137, s[4:5] sc1
  s_mov_b64 exec, -1
sig_5:
  s_branch k_done
k_ffn:
  s_sub_u32 s3, s2, 256
  s_or_b32 s50, s3, s8
  s_cmp_lg_u32 s50, 0
  s_cbranch_scc1 k_noinit
  s_waitcnt lgkmcnt(0)
  v_lshlrev_b32 v12, 8, v0
  v_add_u32 v12, 18939904, v12
  v_mov_b32 v13, 0
  global_store_dword v12, v13, s[4:5] sc1
  v_add_u32 v12, 16384, v12
  global_store_dword v12, v13, s[4:5] sc1
  v_add_u32 v12, 16384, v12
  global_store_dword v12, v13, s[4:5] sc1
  v_add_u32 v12, 16384, v12
  global_store_dword v12, v13, s[4:5] sc1
  v_add_u32 v12, 16384, v12
  global_store_dword v12, v13, s[4:5] sc1
  v_add_u32 v12, 16384, v12
  global_store_dword v12, v13, s[4:5] sc1
  v_add_u32 v12, 16384, v12
  global_store_dword v12, v13, s[4:5] sc1
  v_add_u32 v12, 16384, v12
  global_store_dword v12, v13, s[4:5] sc1
  s_waitcnt vmcnt(0)
  v_mov_b32 v12, 0
  v_mov_b32 v13, 1
  s_mov_b64 exec, 1
  global_store_dword v12, v13, s[48:49] sc1
  s_mov_b64 exec, -1
k_noinit:
  s_lshl_b32 s52, s3, 2
  s_add_u32 s52, s52, s8
  s_load_dwordx2 s[54:55], s[0:1], 8
  s_mul_i32 s58, s52, 1536
  v_lshlrev_b32 v241, 7, v0
  v_add_u32 v241, s58, v241
  v_cmp_gt_u32 vcc, 12, v0
  s_waitcnt lgkmcnt(0)
  s_mov_b32 s60, s54
  s_and_b32 s61, s55, 0xffff
  s_mov_b32 s62, 1572864
  s_mov_b32 s63, 0x20000
  s_and_saveexec_b64 s[56:57], vcc
  buffer_load_dword v245, v241, s[60:63], 0 offen
  s_mov_b64 exec, s[56:57]
  s_load_dwordx2 s[54:55], s[0:1], 0
  s_mul_i32 s58, s52, 2048
  v_lshlrev_b32 v241, 7, v0
  v_add_u32 v241, s58, v241
  v_cmp_gt_u32 vcc, 16, v0
  s_waitcnt lgkmcnt(0)
  s_mov_b32 s60, s54
  s_and_b32 s61, s55, 0xffff
  s_mov_b32 s62, 2097152
  s_mov_b32 s63, 0x20000
  s_and_saveexec_b64 s[56:57], vcc
  buffer_load_dword v244, v241, s[60:63], 0 offen
  s_mov_b64 exec, s[56:57]
  s_waitcnt vmcnt(0)
  s_load_dwordx2 s[54:55], s[0:1], 32
  s_mul_i32 s58, s52, 1408
  v_lshlrev_b32 v241, 7, v0
  v_add_u32 v241, s58, v241
  v_cmp_gt_u32 vcc, 11, v0
  s_waitcnt lgkmcnt(0)
  s_mov_b32 s60, s54
  s_and_b32 s61, s55, 0xffff
  s_mov_b32 s62, 1409024
  s_mov_b32 s63, 0x20000
  s_and_saveexec_b64 s[56:57], vcc
  buffer_load_dword v244, v241, s[60:63], 0 offen
  s_mov_b64 exec, s[56:57]
  s_load_dwordx2 s[54:55], s[0:1], 40
  s_mul_i32 s58, s52, 1408
  v_lshlrev_b32 v241, 7, v0
  v_add_u32 v241, s58, v241
  v_cmp_gt_u32 vcc, 11, v0
  s_waitcnt lgkmcnt(0)
  s_mov_b32 s60, s54
  s_and_b32 s61, s55, 0xffff
  s_mov_b32 s62, 1409024
  s_mov_b32 s63, 0x20000
  s_and_saveexec_b64 s[56:57], vcc
  buffer_load_dword v245, v241, s[60:63], 0 offen
  s_mov_b64 exec, s[56:57]
  s_cmp_lg_u32 s8, 0
  s_cbranch_scc1 wi_6_done
  v_mov_b32 v12, 0
  s_mov_b32 s25, 100000
  s_mov_b64 exec, 1
wi_6_poll:
  global_load_dword v13, v12, s[48:49] sc1
  s_waitcnt vmcnt(0)
  v_readfirstlane_b32 s24, v13
  s_sub_u32 s25, s25, 1
  s_cmp_eq_u32 s25, 0
  s_cbranch_scc1 wi_6_out
  s_cmp_lg_u32 s24, 0
  s_cbranch_scc1 wi_6_out
  s_sleep 8
  s_branch wi_6_poll
wi_6_out:
  s_mov_b64 exec, -1
wi_6_done:
  s_setprio 3
  s_and_b32 s9, s3, 1
  s_lshl_b32 s9, s9, 3
  s_bfe_u32 s24, s3, 0x30003
  s_add_u32 s9, s9, s24
  s_bfe_u32 s10, s3, 0x20001
  s_lshl_b32 s10, s10, 2
  s_lshr_b32 s24, s3, 6
  s_add_u32 s10, s10, s24
  s_lshl_b32 s24, s8, 15
  v_lshrrev_b32 v12, 4, v0
  v_and_b32 v13, 7, v0
  v_xor_b32 v12, v12, v13
  v_lshlrev_b32 v12, 4, v12
  v_lshrrev_b32 v13, 3, v0
  v_lshlrev_b32 v13, 10, v13
  v_add_u32 v1, v12, v13
  v_lshrrev_b32 v12, 4, v0
  v_add_u32 v12, 4, v12
  v_and_b32 v13, 7, v0
  v_xor_b32 v12, v12, v13
  v_lshlrev_b32 v12, 4, v12
  v_lshrrev_b32 v13, 3, v0
  v_lshlrev_b32 v13, 10, v13
  v_add_u32 v2, v12, v13
  v_add_u32 v1, s24, v1
  v_add_u32 v2, s24, v2
  v_add_u32 v3, 14336, v1
  v_add_u32 v4, 21504, v2
  v_add_u32 v2, 7168, v2
  s_lshl_b32 s22, s8, 12
  v_and_b32 v12, 31, v0
  v_lshrrev_b32 v13, 5, v0
  v_bfe_u32 v14, v0, 1, 3
  v_xor_b32 v13, v13, v14
  v_lshlrev_b32 v13, 4, v13
  v_lshlrev_b32 v12, 7, v12
  v_add3_u32 v8, v12, v13, s22
  v_xor_b32 v9, 32, v8
  v_xor_b32 v10, 64, v8
  v_xor_b32 v11, 96, v8
  v_add_u32 v226, 32768, v8
  v_add_u32 v227, 32768, v9
  v_add_u32 v228, 32768, v10
  v_add_u32 v229, 32768, v11
  s_mul_i32 s38, s10, 3
  s_lshl_b32 s24, s10, 1
  s_add_u32 s24, s24, 11
  s_cmp_lt_u32 s10, 11
  s_cselect_b32 s38, s38, s24
  s_cselect_b32 s11, 3, 2
  s_and_b32 s24, s8, 1
  s_lshr_b32 s25, s8, 1
  s_mul_i32 s23, s25, 6144
  s_mul_i32 s26, s24, 3072
  s_add_u32 s23, s23, s26
  s_mul_i32 s27, s24, 192
  v_add_u32 v12, s27, v0
  v_mul_u32_u24 v13, 43691, v12
  v_lshrrev_b32 v13, 19, v13
  v_mul_u32_u24 v14, 12, v13
  v_sub_u32 v12, v12, v14
  v_lshlrev_b32 v12, 4, v12
  v_mul_u32_u24 v13, 2752, v13
  v_add_u32 v12, v12, v13
  v_add_u32 v5, 2048, v12
  v_add_u32 v12, s27, v0
  v_add_u32 v12, 64, v12
  v_mul_u32_u24 v13, 43691, v12
  v_lshrrev_b32 v13, 19, v13
  v_mul_u32_u24 v14, 12, v13
  v_sub_u32 v12, v12, v14
  v_lshlrev_b32 v12, 4, v12
  v_mul_u32_u24 v13, 2752, v13
  v_add_u32 v12, v12, v13
  v_add_u32 v6, 1024, v12
  v_add_u32 v12, s27, v0
  v_add_u32 v12, 128, v12
  v_mul_u32_u24 v13, 43691, v12
  v_lshrrev_b32 v13, 19, v13
  v_mul_u32_u24 v14, 12, v13
  v_sub_u32 v12, v12, v14
  v_lshlrev_b32 v12, 4, v12
  v_mul_u32_u24 v13, 2752, v13
  v_add_u32 v12, v12, v13
  v_add_u32 v7, 0, v12
  v_lshrrev_b32 v12, 5, v0
  v_lshlrev_b32 v12, 3, v12
  v_bfe_u32 v13, v0, 2, 2
  v_add_u32 v12, v12, v13
  v_mul_u32_u24 v12, 192, v12
  v_bfe_u32 v13, v0, 4, 1
  v_lshlrev_b32 v13, 5, v13
  v_and_b32 v14, 3, v0
  v_lshlrev_b32 v14, 3, v14
  v_add3_u32 v224, v12, v13, v14
  v_add_u32 v225, 32768, v224
  s_lshl_b32 s20, s9, 17
  s_lshl_b32 s21, s38, 6
  s_waitcnt lgkmcnt(0)
  s_mov_b32 s12, s32
  s_mov_b32 s13, s33
  s_and_b32 s13, s13, 0xffff
  s_mov_b32 s14, 2097152
  s_mov_b32 s15, 0x20000
  s_cmp_eq_u32 s25, 0
  s_cselect_b32 s28, s40, s42
  s_cselect_b32 s29, s41, s43
  s_sub_u32 s16, s28, 2048
  s_subb_u32 s17, s29, 0
  s_and_b32 s17, s17, 0xffff
  s_mov_b32 s18, 1411072
  s_mov_b32 s19, 0x20000
  s_cmp_lt_u32 s11, 3
  s_cbranch_scc1 g_np2
  s_add_u32 m0, s22, 0
  s_nop 0
  buffer_load_dwordx4 v1, s[12:15], s20 offen lds
  buffer_load_dwordx4 v2, s[12:15], s20 offen offset:1024 lds
  buffer_load_dwordx4 v3, s[12:15], s20 offen offset:2048 lds
  buffer_load_dwordx4 v4, s[12:15], s20 offen offset:3072 lds
  s_add_u32 s20, s20, 128
  s_add_u32 m0, s23, 32768
  s_nop 0
  buffer_load_dwordx4 v5, s[16:19], s21 offen lds
  buffer_load_dwordx4 v6, s[16:19], s21 offen offset:1024 lds
  buffer_load_dwordx4 v7, s[16:19], s21 offen offset:2048 lds
  s_add_u32 s21, s21, 88064
  s_add_u32 m0, s23, 45056
  s_nop 0
  buffer_load_dwordx4 v5, s[16:19], s21 offen lds
  buffer_load_dwordx4 v6, s[16:19], s21 offen offset:1024 lds
  buffer_load_dwordx4 v7, s[16:19], s21 offen offset:2048 lds
  s_add_u32 s21, s21, 88064
  s_add_u32 m0, s22, 16384
  s_nop 0
  buffer_load_dwordx4 v1, s[12:15], s20 offen lds
  buffer_load_dwordx4 v2, s[12:15], s20 offen offset:1024 lds
  buffer_load_dwordx4 v3, s[12:15], s20 offen offset:2048 lds
  buffer_load_dwordx4 v4, s[12:15], s20 offen offset:3072 lds
  s_add_u32 s20, s20, 128
  s_add_u32 m0, s23, 57344
  s_nop 0
  buffer_load_dwordx4 v5, s[16:19], s21 offen lds
  buffer_load_dwordx4 v6, s[16:19], s21 offen offset:1024 lds
  buffer_load_dwordx4 v7, s[16:19], s21 offen offset:2048 lds
  s_add_u32 s21, s21, 88064
  s_add_u32 m0, s23, 69632
  s_nop 0
  buffer_load_dwordx4 v5, s[16:19], s21 offen lds
  buffer_load_dwordx4 v6, s[16:19], s21 offen offset:1024 lds
  buffer_load_dwordx4 v7, s[16:19], s21 offen offset:2048 lds
  s_add_u32 s21, s21, 88064
  v_mov_b32 v128, 0
  v_mov_b32 v129, 0
  v_mov_b32 v130, 0
  v_mov_b32 v131, 0
  v_mov_b32 v132, 0
  v_mov_b32 v133, 0
  v_mov_b32 v134, 0
  v_mov_b32 v135, 0
  v_mov_b32 v136, 0
  v_mov_b32 v137, 0
  v_mov_b32 v138, 0
  v_mov_b32 v139, 0
  v_mov_b32 v140, 0
  v_mov_b32 v141, 0
  v_mov_b32 v142, 0
  v_mov_b32 v143, 0
  v_mov_b32 v144, 0
  v_mov_b32 v145, 0
  v_mov_b32 v146, 0
  v_mov_b32 v147, 0
  v_mov_b32 v148, 0
  v_mov_b32 v149, 0
  v_mov_b32 v150, 0
  v_mov_b32 v151, 0
  v_mov_b32 v152, 0
  v_mov_b32 v153, 0
  v_mov_b32 v154, 0
  v_mov_b32 v155, 0
  v_mov_b32 v156, 0
  v_mov_b32 v157, 0
  v_mov_b32 v158, 0
  v_mov_b32 v159, 0
  v_mov_b32 v160, 0
  v_mov_b32 v161, 0
  v_mov_b32 v162, 0
  v_mov_b32 v163, 0
  v_mov_b32 v164, 0
  v_mov_b32 v165, 0
  v_mov_b32 v166, 0
  v_mov_b32 v167, 0
  v_mov_b32 v168, 0
  v_mov_b32 v169, 0
  v_mov_b32 v170, 0
  v_mov_b32 v171, 0
  v_mov_b32 v172, 0
  v_mov_b32 v173, 0
  v_mov_b32 v174, 0
  v_mov_b32 v175, 0
  v_mov_b32 v176, 0
  v_mov_b32 v177, 0
  v_mov_b32 v178, 0
  v_mov_b32 v179, 0
  v_mov_b32 v180, 0
  v_mov_b32 v181, 0
  v_mov_b32 v182, 0
  v_mov_b32 v183, 0
  v_mov_b32 v184, 0
  v_mov_b32 v185, 0
  v_mov_b32 v186, 0
  v_mov_b32 v187, 0
  v_mov_b32 v188, 0
  v_mov_b32 v189, 0
  v_mov_b32 v190, 0
  v_mov_b32 v191, 0
  v_mov_b32 v192, 0
  v_mov_b32 v193, 0
  v_mov_b32 v194, 0
  v_mov_b32 v195, 0
  v_mov_b32 v196, 0
  v_mov_b32 v197, 0
  v_mov_b32 v198, 0
  v_mov_b32 v199, 0
  v_mov_b32 v200, 0
  v_mov_b32 v201, 0
  v_mov_b32 v202, 0
  v_mov_b32 v203, 0
  v_mov_b32 v204, 0
  v_mov_b32 v205, 0
  v_mov_b32 v206, 0
  v_mov_b32 v207, 0
  v_mov_b32 v208, 0
  v_mov_b32 v209, 0
  v_mov_b32 v210, 0
  v_mov_b32 v211, 0
  v_mov_b32 v212, 0
  v_mov_b32 v213, 0
  v_mov_b32 v214, 0
  v_mov_b32 v215, 0
  v_mov_b32 v216, 0
  v_mov_b32 v217, 0
  v_mov_b32 v218, 0
  v_mov_b32 v219, 0
  v_mov_b32 v220, 0
  v_mov_b32 v221, 0
  v_mov_b32 v222, 0
  v_mov_b32 v223, 0
  s_setprio 0
  s_waitcnt vmcnt(13)
  s_barrier
  ds_read_b128 v[16:19], v8 offset:0
  ds_read_b64_tr_b16 v[32:33], v224 offset:32768
  ds_read_b64_tr_b16 v[34:35], v224 offset:33536
  ds_read_b64_tr_b16 v[36:37], v224 offset:32832
  ds_read_b64_tr_b16 v[38:39], v224 offset:33600
  ds_read_b64_tr_b16 v[40:41], v224 offset:32896
  ds_read_b64_tr_b16 v[42:43], v224 offset:33664
  ds_read_b64_tr_b16 v[44:45], v224 offset:38912
  ds_read_b64_tr_b16 v[46:47], v224 offset:39680
  ds_read_b64_tr_b16 v[48:49], v224 offset:38976
  ds_read_b64_tr_b16 v[50:51], v224 offset:39744
  ds_read_b64_tr_b16 v[52:53], v224 offset:39040
  ds_read_b64_tr_b16 v[54:55], v224 offset:39808
  ds_read_b128 v[20:23], v9 offset:0
  ds_read_b64_tr_b16 v[56:57], v224 offset:35840
  ds_read_b64_tr_b16 v[58:59], v224 offset:36608
  ds_read_b64_tr_b16 v[60:61], v224 offset:35904
  ds_read_b64_tr_b16 v[62:63], v224 offset:36672
  ds_read_b64_tr_b16 v[64:65], v224 offset:35968
  ds_read_b64_tr_b16 v[66:67], v224 offset:36736
  ds_read_b64_tr_b16 v[68:69], v224 offset:41984
  ds_read_b64_tr_b16 v[70:71], v224 offset:42752
  ds_read_b64_tr_b16 v[72:73], v224 offset:42048
  ds_read_b64_tr_b16 v[74:75], v224 offset:42816
  ds_read_b64_tr_b16 v[76:77], v224 offset:42112
  ds_read_b64_tr_b16 v[78:79], v224 offset:42880
  s_waitcnt vmcnt(10) lgkmcnt(0)
  s_barrier
  v_mfma_f32_32x32x16_bf16 v[128:143], v[32:35], v[16:19], v[128:143]
  ds_read_b128 v[24:27], v10 offset:0
  ds_read_b64_tr_b16 v[80:81], v224 offset:45056
  ds_read_b64_tr_b16 v[82:83], v224 offset:45824
  v_mfma_f32_32x32x16_bf16 v[144:159], v[36:39], v[16:19], v[144:159]
  s_add_u32 m0, s23, 32768
  s_nop 0
  buffer_load_dwordx4 v5, s[16:19], s21 offen lds
  buffer_load_dwordx4 v6, s[16:19], s21 offen offset:1024 lds
  buffer_load_dwordx4 v7, s[16:19], s21 offen offset:2048 lds
  s_add_u32 s21, s21, 88064
  v_mfma_f32_32x32x16_bf16 v[160:175], v[40:43], v[16:19], v[160:175]
  ds_read_b64_tr_b16 v[84:85], v224 offset:45120
  ds_read_b64_tr_b16 v[86:87], v224 offset:45888
  ds_read_b64_tr_b16 v[88:89], v224 offset:45184
  v_mfma_f32_32x32x16_bf16 v[176:191], v[44:47], v[16:19], v[176:191]
  ds_read_b64_tr_b16 v[90:91], v224 offset:45952
  ds_read_b64_tr_b16 v[92:93], v225 offset:18432
  v_mfma_f32_32x32x16_bf16 v[192:207], v[48:51], v[16:19], v[192:207]
  ds_read_b64_tr_b16 v[94:95], v225 offset:19200
  ds_read_b64_tr_b16 v[96:97], v225 offset:18496
  v_mfma_f32_32x32x16_bf16 v[208:223], v[52:55], v[16:19], v[208:223]
  ds_read_b64_tr_b16 v[98:99], v225 offset:19264
  ds_read_b64_tr_b16 v[100:101], v225 offset:18560
  ds_read_b64_tr_b16 v[102:103], v225 offset:19328
  v_mfma_f32_32x32x16_bf16 v[128:143], v[56:59], v[20:23], v[128:143]
  ds_read_b128 v[28:31], v11 offset:0
  ds_read_b64_tr_b16 v[104:105], v224 offset:48128
  v_mfma_f32_32x32x16_bf16 v[144:159], v[60:63], v[20:23], v[144:159]
  ds_read_b64_tr_b16 v[106:107], v224 offset:48896
  ds_read_b64_tr_b16 v[108:109], v224 offset:48192
  v_mfma_f32_32x32x16_bf16 v[160:175], v[64:67], v[20:23], v[160:175]
  ds_read_b64_tr_b16 v[110:111], v224 offset:48960
  ds_read_b64_tr_b16 v[112:113], v224 offset:48256
  ds_read_b64_tr_b16 v[114:115], v224 offset:49024
  v_mfma_f32_32x32x16_bf16 v[176:191], v[68:71], v[20:23], v[176:191]
  ds_read_b64_tr_b16 v[116:117], v225 offset:21504
  ds_read_b64_tr_b16 v[118:119], v225 offset:22272
  v_mfma_f32_32x32x16_bf16 v[192:207], v[72:75], v[20:23], v[192:207]
  ds_read_b64_tr_b16 v[120:121], v225 offset:21568
  ds_read_b64_tr_b16 v[122:123], v225 offset:22336
  v_mfma_f32_32x32x16_bf16 v[208:223], v[76:79], v[20:23], v[208:223]
  ds_read_b64_tr_b16 v[124:125], v225 offset:21632
  ds_read_b64_tr_b16 v[126:127], v225 offset:22400
  s_waitcnt vmcnt(6) lgkmcnt(0)
  s_barrier
  v_mfma_f32_32x32x16_bf16 v[128:143], v[80:83], v[24:27], v[128:143]
  ds_read_b128 v[16:19], v8 offset:16384
  ds_read_b64_tr_b16 v[32:33], v225 offset:24576
  ds_read_b64_tr_b16 v[34:35], v225 offset:25344
  v_mfma_f32_32x32x16_bf16 v[144:159], v[84:87], v[24:27], v[144:159]
  s_add_u32 m0, s23, 45056
  s_nop 0
  buffer_load_dwordx4 v5, s[16:19], s21 offen lds
  buffer_load_dwordx4 v6, s[16:19], s21 offen offset:1024 lds
  buffer_load_dwordx4 v7, s[16:19], s21 offen offset:2048 lds
  s_add_u32 s21, s21, 88064
  s_add_u32 m0, s22, 0
  s_nop 0
  buffer_load_dwordx4 v1, s[12:15], s20 offen lds
  buffer_load_dwordx4 v2, s[12:15], s20 offen offset:1024 lds
  buffer_load_dwordx4 v3, s[12:15], s20 offen offset:2048 lds
  buffer_load_dwordx4 v4, s[12:15], s20 offen offset:3072 lds
  s_add_u32 s20, s20, 128
  v_mfma_f32_32x32x16_bf16 v[160:175], v[88:91], v[24:27], v[160:175]
  ds_read_b64_tr_b16 v[36:37], v225 offset:24640
  ds_read_b64_tr_b16 v[38:39], v225 offset:25408
  ds_read_b64_tr_b16 v[40:41], v225 offset:24704
  v_mfma_f32_32x32x16_bf16 v[176:191], v[92:95], v[24:27], v[176:191]
  ds_read_b64_tr_b16 v[42:43], v225 offset:25472
  ds_read_b64_tr_b16 v[44:45], v225 offset:30720
  v_mfma_f32_32x32x16_bf16 v[192:207], v[96:99], v[24:27], v[192:207]
  ds_read_b64_tr_b16 v[46:47], v225 offset:31488
  ds_read_b64_tr_b16 v[48:49], v225 offset:30784
  v_mfma_f32_32x32x16_bf16 v[208:223], v[100:103], v[24:27], v[208:223]
  ds_read_b64_tr_b16 v[50:51], v225 offset:31552
  ds_read_b64_tr_b16 v[52:53], v225 offset:30848
  ds_read_b64_tr_b16 v[54:55], v225 offset:31616
  v_mfma_f32_32x32x16_bf16 v[128:143], v[104:107], v[28:31], v[128:143]
  ds_read_b128 v[20:23], v9 offset:16384
  ds_read_b64_tr_b16 v[56:57], v225 offset:27648
  v_mfma_f32_32x32x16_bf16 v[144:159], v[108:111], v[28:31], v[144:159]
  ds_read_b64_tr_b16 v[58:59], v225 offset:28416
  ds_read_b64_tr_b16 v[60:61], v225 offset:27712
  v_mfma_f32_32x32x16_bf16 v[160:175], v[112:115], v[28:31], v[160:175]
  ds_read_b64_tr_b16 v[62:63], v225 offset:28480
  ds_read_b64_tr_b16 v[64:65], v225 offset:27776
  ds_read_b64_tr_b16 v[66:67], v225 offset:28544
  v_mfma_f32_32x32x16_bf16 v[176:191], v[116:119], v[28:31], v[176:191]
  ds_read_b64_tr_b16 v[68:69], v225 offset:33792
  ds_read_b64_tr_b16 v[70:71], v225 offset:34560
  v_mfma_f32_32x32x16_bf16 v[192:207], v[120:123], v[28:31], v[192:207]
  ds_read_b64_tr_b16 v[72:73], v225 offset:33856
  ds_read_b64_tr_b16 v[74:75], v225 offset:34624
  v_mfma_f32_32x32x16_bf16 v[208:223], v[124:127], v[28:31], v[208:223]
  ds_read_b64_tr_b16 v[76:77], v225 offset:33920
  ds_read_b64_tr_b16 v[78:79], v225 offset:34688
  s_waitcnt vmcnt(10) lgkmcnt(0)
  s_barrier
  v_mfma_f32_32x32x16_bf16 v[128:143], v[32:35], v[16:19], v[128:143]
  ds_read_b128 v[24:27], v10 offset:16384
  ds_read_b64_tr_b16 v[80:81], v225 offset:36864
  ds_read_b64_tr_b16 v[82:83], v225 offset:37632
  v_mfma_f32_32x32x16_bf16 v[144:159], v[36:39], v[16:19], v[144:159]
  s_add_u32 m0, s23, 57344
  s_nop 0
  buffer_load_dwordx4 v5, s[16:19], s21 offen lds
  buffer_load_dwordx4 v6, s[16:19], s21 offen offset:1024 lds
  buffer_load_dwordx4 v7, s[16:19], s21 offen offset:2048 lds
  s_add_u32 s21, s21, 88064
  v_mfma_f32_32x32x16_bf16 v[160:175], v[40:43], v[16:19], v[160:175]
  ds_read_b64_tr_b16 v[84:85], v225 offset:36928
  ds_read_b64_tr_b16 v[86:87], v225 offset:37696
  ds_read_b64_tr_b16 v[88:89], v225 offset:36992
  v_mfma_f32_32x32x16_bf16 v[176:191], v[44:47], v[16:19], v[176:191]
  ds_read_b64_tr_b16 v[90:91], v225 offset:37760
  ds_read_b64_tr_b16 v[92:93], v225 offset:43008
  v_mfma_f32_32x32x16_bf16 v[192:207], v[48:51], v[16:19], v[192:207]
  ds_read_b64_tr_b16 v[94:95], v225 offset:43776
  ds_read_b64_tr_b16 v[96:97], v225 offset:43072
  v_mfma_f32_32x32x16_bf16 v[208:223], v[52:55], v[16:19], v[208:223]
  ds_read_b64_tr_b16 v[98:99], v225 offset:43840
  ds_read_b64_tr_b16 v[100:101], v225 offset:43136
  ds_read_b64_tr_b16 v[102:103], v225 offset:43904
  v_mfma_f32_32x32x16_bf16 v[128:143], v[56:59], v[20:23], v[128:143]
  ds_read_b128 v[28:31], v11 offset:16384
  ds_read_b64_tr_b16 v[104:105], v225 offset:39936
  v_mfma_f32_32x32x16_bf16 v[144:159], v[60:63], v[20:23], v[144:159]
  ds_read_b64_tr_b16 v[106:107], v225 offset:40704
  ds_read_b64_tr_b16 v[108:109], v225 offset:40000
  v_mfma_f32_32x32x16_bf16 v[160:175], v[64:67], v[20:23], v[160:175]
  ds_read_b64_tr_b16 v[110:111], v225 offset:40768
  ds_read_b64_tr_b16 v[112:113], v225 offset:40064
  ds_read_b64_tr_b16 v[114:115], v225 offset:40832
  v_mfma_f32_32x32x16_bf16 v[176:191], v[68:71], v[20:23], v[176:191]
  ds_read_b64_tr_b16 v[116:117], v225 offset:46080
  ds_read_b64_tr_b16 v[118:119], v225 offset:46848
  v_mfma_f32_32x32x16_bf16 v[192:207], v[72:75], v[20:23], v[192:207]
  ds_read_b64_tr_b16 v[120:121], v225 offset:46144
  ds_read_b64_tr_b16 v[122:123], v225 offset:46912
  v_mfma_f32_32x32x16_bf16 v[208:223], v[76:79], v[20:23], v[208:223]
  ds_read_b64_tr_b16 v[124:125], v225 offset:46208
  ds_read_b64_tr_b16 v[126:127], v225 offset:46976
  s_waitcnt vmcnt(3) lgkmcnt(0)
  s_barrier
  v_mfma_f32_32x32x16_bf16 v[128:143], v[80:83], v[24:27], v[128:143]
  ds_read_b128 v[16:19], v8 offset:0
  ds_read_b64_tr_b16 v[32:33], v224 offset:32768
  ds_read_b64_tr_b16 v[34:35], v224 offset:33536
  v_mfma_f32_32x32x16_bf16 v[144:159], v[84:87], v[24:27], v[144:159]
  s_add_u32 m0, s23, 69632
  s_nop 0
  buffer_load_dwordx4 v5, s[16:19], s21 offen lds
  buffer_load_dwordx4 v6, s[16:19], s21 offen offset:1024 lds
  buffer_load_dwordx4 v7, s[16:19], s21 offen offset:2048 lds
  s_add_u32 s21, s21, 88064
  s_add_u32 m0, s22, 16384
  s_nop 0
  buffer_load_dwordx4 v1, s[12:15], s20 offen lds
  buffer_load_dwordx4 v2, s[12:15], s20 offen offset:1024 lds
  buffer_load_dwordx4 v3, s[12:15], s20 offen offset:2048 lds
  buffer_load_dwordx4 v4, s[12:15], s20 offen offset:3072 lds
  s_add_u32 s20, s20, 128
  v_mfma_f32_32x32x16_bf16 v[160:175], v[88:91], v[24:27], v[160:175]
  ds_read_b64_tr_b16 v[36:37], v224 offset:32832
  ds_read_b64_tr_b16 v[38:39], v224 offset:33600
  ds_read_b64_tr_b16 v[40:41], v224 offset:32896
  v_mfma_f32_32x32x16_bf16 v[176:191], v[92:95], v[24:27], v[176:191]
  ds_read_b64_tr_b16 v[42:43], v224 offset:33664
  ds_read_b64_tr_b16 v[44:45], v224 offset:38912
  v_mfma_f32_32x32x16_bf16 v[192:207], v[96:99], v[24:27], v[192:207]
  ds_read_b64_tr_b16 v[46:47], v224 offset:39680
  ds_read_b64_tr_b16 v[48:49], v224 offset:38976
  v_mfma_f32_32x32x16_bf16 v[208:223], v[100:103], v[24:27], v[208:223]
  ds_read_b64_tr_b16 v[50:51], v224 offset:39744
  ds_read_b64_tr_b16 v[52:53], v224 offset:39040
  ds_read_b64_tr_b16 v[54:55], v224 offset:39808
  v_mfma_f32_32x32x16_bf16 v[128:143], v[104:107], v[28:31], v[128:143]
  ds_read_b128 v[20:23], v9 offset:0
  ds_read_b64_tr_b16 v[56:57], v224 offset:35840
  v_mfma_f32_32x32x16_bf16 v[144:159], v[108:111], v[28:31], v[144:159]
  ds_read_b64_tr_b16 v[58:59], v224 offset:36608
  ds_read_b64_tr_b16 v[60:61], v224 offset:35904
  v_mfma_f32_32x32x16_bf16 v[160:175], v[112:115], v[28:31], v[160:175]
  ds_read_b64_tr_b16 v[62:63], v224 offset:36672
  ds_read_b64_tr_b16 v[64:65], v224 offset:35968
  ds_read_b64_tr_b16 v[66:67], v224 offset:36736
  v_mfma_f32_32x32x16_bf16 v[176:191], v[116:119], v[28:31], v[176:191]
  ds_read_b64_tr_b16 v[68:69], v224 offset:41984
  ds_read_b64_tr_b16 v[70:71], v224 offset:42752
  v_mfma_f32_32x32x16_bf16 v[192:207], v[120:123], v[28:31], v[192:207]
  ds_read_b64_tr_b16 v[72:73], v224 offset:42048
  ds_read_b64_tr_b16 v[74:75], v224 offset:42816
  v_mfma_f32_32x32x16_bf16 v[208:223], v[124:127], v[28:31], v[208:223]
  ds_read_b64_tr_b16 v[76:77], v224 offset:42112
  ds_read_b64_tr_b16 v[78:79], v224 offset:42880
  s_waitcnt vmcnt(10) lgkmcnt(0)
  s_barrier
  v_mfma_f32_32x32x16_bf16 v[128:143], v[32:35], v[16:19], v[128:143]
  ds_read_b128 v[24:27], v10 offset:0
  ds_read_b64_tr_b16 v[80:81], v224 offset:45056
  ds_read_b64_tr_b16 v[82:83], v224 offset:45824
  v_mfma_f32_32x32x16_bf16 v[144:159], v[36:39], v[16:19], v[144:159]
  s_add_u32 m0, s23, 32768
  s_nop 0
  buffer_load_dwordx4 v5, s[16:19], s21 offen lds
  buffer_load_dwordx4 v6, s[16:19], s21 offen offset:1024 lds
  buffer_load_dwordx4 v7, s[16:19], s21 offen offset:2048 lds
  s_add_u32 s21, s21, 88064
  v_mfma_f32_32x32x16_bf16 v[160:175], v[40:43], v[16:19], v[160:175]
  ds_read_b64_tr_b16 v[84:85], v224 offset:45120
  ds_read_b64_tr_b16 v[86:87], v224 offset:45888
  ds_read_b64_tr_b16 v[88:89], v224 offset:45184
  v_mfma_f32_32x32x16_bf16 v[176:191], v[44:47], v[16:19], v[176:191]
  ds_read_b64_tr_b16 v[90:91], v224 offset:45952
  ds_read_b64_tr_b16 v[92:93], v225 offset:18432
  v_mfma_f32_32x32x16_bf16 v[192:207], v[48:51], v[16:19], v[192:207]
  ds_read_b64_tr_b16 v[94:95], v225 offset:19200
  ds_read_b64_tr_b16 v[96:97], v225 offset:18496
  v_mfma_f32_32x32x16_bf16 v[208:223], v[52:55], v[16:19], v[208:223]
  ds_read_b64_tr_b16 v[98:99], v225 offset:19264
  ds_read_b64_tr_b16 v[100:101], v225 offset:18560
  ds_read_b64_tr_b16 v[102:103], v225 offset:19328
  v_mfma_f32_32x32x16_bf16 v[128:143], v[56:59], v[20:23], v[128:143]
  ds_read_b128 v[28:31], v11 offset:0
  ds_read_b64_tr_b16 v[104:105], v224 offset:48128
  v_mfma_f32_32x32x16_bf16 v[144:159], v[60:63], v[20:23], v[144:159]
  ds_read_b64_tr_b16 v[106:107], v224 offset:48896
  ds_read_b64_tr_b16 v[108:109], v224 offset:48192
  v_mfma_f32_32x32x16_bf16 v[160:175], v[64:67], v[20:23], v[160:175]
  ds_read_b64_tr_b16 v[110:111], v224 offset:48960
  ds_read_b64_tr_b16 v[112:113], v224 offset:48256
  ds_read_b64_tr_b16 v[114:115], v224 offset:49024
  v_mfma_f32_32x32x16_bf16 v[176:191], v[68:71], v[20:23], v[176:191]
  ds_read_b64_tr_b16 v[116:117], v225 offset:21504
  ds_read_b64_tr_b16 v[118:119], v225 offset:22272
  v_mfma_f32_32x32x16_bf16 v[192:207], v[72:75], v[20:23], v[192:207]
  ds_read_b64_tr_b16 v[120:121], v225 offset:21568
  ds_read_b64_tr_b16 v[122:123], v225 offset:22336
  v_mfma_f32_32x32x16_bf16 v[208:223], v[76:79], v[20:23], v[208:223]
  ds_read_b64_tr_b16 v[124:125], v225 offset:21632
  ds_read_b64_tr_b16 v[126:127], v225 offset:22400
  s_waitcnt vmcnt(3) lgkmcnt(0)
  s_barrier
  v_mfma_f32_32x32x16_bf16 v[128:143], v[80:83], v[24:27], v[128:143]
  ds_read_b128 v[16:19], v8 offset:16384
  ds_read_b64_tr_b16 v[32:33], v225 offset:24576
  ds_read_b64_tr_b16 v[34:35], v225 offset:25344
  v_mfma_f32_32x32x16_bf16 v[144:159], v[84:87], v[24:27], v[144:159]
  s_add_u32 m0, s23, 45056
  s_nop 0
  buffer_load_dwordx4 v5, s[16:19], s21 offen lds
  buffer_load_dwordx4 v6, s[16:19], s21 offen offset:1024 lds
  buffer_load_dwordx4 v7, s[16:19], s21 offen offset:2048 lds
  s_add_u32 s21, s21, 88064
  s_add_u32 m0, s22, 0
  s_nop 0
  buffer_load_dwordx4 v1, s[12:15], s20 offen lds
  buffer_load_dwordx4 v2, s[12:15], s20 offen offset:1024 lds
  buffer_load_dwordx4 v3, s[12:15], s20 offen offset:2048 lds
  buffer_load_dwordx4 v4, s[12:15], s20 offen offset:3072 lds
  s_add_u32 s20, s20, 128
  v_mfma_f32_32x32x16_bf16 v[160:175], v[88:91], v[24:27], v[160:175]
  ds_read_b64_tr_b16 v[36:37], v225 offset:24640
  ds_read_b64_tr_b16 v[38:39], v225 offset:25408
  ds_read_b64_tr_b16 v[40:41], v225 offset:24704
  v_mfma_f32_32x32x16_bf16 v[176:191], v[92:95], v[24:27], v[176:191]
  ds_read_b64_tr_b16 v[42:43], v225 offset:25472
  ds_read_b64_tr_b16 v[44:45], v225 offset:30720
  v_mfma_f32_32x32x16_bf16 v[192:207], v[96:99], v[24:27], v[192:207]
  ds_read_b64_tr_b16 v[46:47], v225 offset:31488
  ds_read_b64_tr_b16 v[48:49], v225 offset:30784
  v_mfma_f32_32x32x16_bf16 v[208:223], v[100:103], v[24:27], v[208:223]
  ds_read_b64_tr_b16 v[50:51], v225 offset:31552
  ds_read_b64_tr_b16 v[52:53], v225 offset:30848
  ds_read_b64_tr_b16 v[54:55], v225 offset:31616
  v_mfma_f32_32x32x16_bf16 v[128:143], v[104:107], v[28:31], v[128:143]
  ds_read_b128 v[20:23], v9 offset:16384
  ds_read_b64_tr_b16 v[56:57], v225 offset:27648
  v_mfma_f32_32x32x16_bf16 v[144:159], v[108:111], v[28:31], v[144:159]
  ds_read_b64_tr_b16 v[58:59], v225 offset:28416
  ds_read_b64_tr_b16 v[60:61], v225 offset:27712
  v_mfma_f32_32x32x16_bf16 v[160:175], v[112:115], v[28:31], v[160:175]
  ds_read_b64_tr_b16 v[62:63], v225 offset:28480
  ds_read_b64_tr_b16 v[64:65], v225 offset:27776
  ds_read_b64_tr_b16 v[66:67], v225 offset:28544
  v_mfma_f32_32x32x16_bf16 v[176:191], v[116:119], v[28:31], v[176:191]
  ds_read_b64_tr_b16 v[68:69], v225 offset:33792
  ds_read_b64_tr_b16 v[70:71], v225 offset:34560
  v_mfma_f32_32x32x16_bf16 v[192:207], v[120:123], v[28:31], v[192:207]
  ds_read_b64_tr_b16 v[72:73], v225 offset:33856
  ds_read_b64_tr_b16 v[74:75], v225 offset:34624
  v_mfma_f32_32x32x16_bf16 v[208:223], v[124:127], v[28:31], v[208:223]
  ds_read_b64_tr_b16 v[76:77], v225 offset:33920
  ds_read_b64_tr_b16 v[78:79], v225 offset:34688
  s_waitcnt vmcnt(10) lgkmcnt(0)
  s_barrier
  v_mfma_f32_32x32x16_bf16 v[128:143], v[32:35], v[16:19], v[128:143]
  ds_read_b128 v[24:27], v10 offset:16384
  ds_read_b64_tr_b16 v[80:81], v225 offset:36864
  ds_read_b64_tr_b16 v[82:83], v225 offset:37632
  v_mfma_f32_32x32x16_bf16 v[144:159], v[36:39], v[16:19], v[144:159]
  s_add_u32 m0, s23, 57344
  s_nop 0
  buffer_load_dwordx4 v5, s[16:19], s21 offen lds
  buffer_load_dwordx4 v6, s[16:19], s21 offen offset:1024 lds
  buffer_load_dwordx4 v7, s[16:19], s21 offen offset:2048 lds
  s_add_u32 s21, s21, 88064
  v_mfma_f32_32x32x16_bf16 v[160:175], v[40:43], v[16:19], v[160:175]
  ds_read_b64_tr_b16 v[84:85], v225 offset:36928
  ds_read_b64_tr_b16 v[86:87], v225 offset:37696
  ds_read_b64_tr_b16 v[88:89], v225 offset:36992
  v_mfma_f32_32x32x16_bf16 v[176:191], v[44:47], v[16:19], v[176:191]
  ds_read_b64_tr_b16 v[90:91], v225 offset:37760
  ds_read_b64_tr_b16 v[92:93], v225 offset:43008
  v_mfma_f32_32x32x16_bf16 v[192:207], v[48:51], v[16:19], v[192:207]
  ds_read_b64_tr_b16 v[94:95], v225 offset:43776
  ds_read_b64_tr_b16 v[96:97], v225 offset:43072
  v_mfma_f32_32x32x16_bf16 v[208:223], v[52:55], v[16:19], v[208:223]
  ds_read_b64_tr_b16 v[98:99], v225 offset:43840
  ds_read_b64_tr_b16 v[100:101], v225 offset:43136
  ds_read_b64_tr_b16 v[102:103], v225 offset:43904
  v_mfma_f32_32x32x16_bf16 v[128:143], v[56:59], v[20:23], v[128:143]
  ds_read_b128 v[28:31], v11 offset:16384
  ds_read_b64_tr_b16 v[104:105], v225 offset:39936
  v_mfma_f32_32x32x16_bf16 v[144:159], v[60:63], v[20:23], v[144:159]
  ds_read_b64_tr_b16 v[106:107], v225 offset:40704
  ds_read_b64_tr_b16 v[108:109], v225 offset:40000
  v_mfma_f32_32x32x16_bf16 v[160:175], v[64:67], v[20:23], v[160:175]
  ds_read_b64_tr_b16 v[110:111], v225 offset:40768
  ds_read_b64_tr_b16 v[112:113], v225 offset:40064
  ds_read_b64_tr_b16 v[114:115], v225 offset:40832
  v_mfma_f32_32x32x16_bf16 v[176:191], v[68:71], v[20:23], v[176:191]
  ds_read_b64_tr_b16 v[116:117], v225 offset:46080
  ds_read_b64_tr_b16 v[118:119], v225 offset:46848
  v_mfma_f32_32x32x16_bf16 v[192:207], v[72:75], v[20:23], v[192:207]
  ds_read_b64_tr_b16 v[120:121], v225 offset:46144
  ds_read_b64_tr_b16 v[122:123], v225 offset:46912
  v_mfma_f32_32x32x16_bf16 v[208:223], v[76:79], v[20:23], v[208:223]
  ds_read_b64_tr_b16 v[124:125], v225 offset:46208
  ds_read_b64_tr_b16 v[126:127], v225 offset:46976
  s_waitcnt vmcnt(3) lgkmcnt(0)
  s_barrier
  v_mfma_f32_32x32x16_bf16 v[128:143], v[80:83], v[24:27], v[128:143]
  ds_read_b128 v[16:19], v8 offset:0
  ds_read_b64_tr_b16 v[32:33], v224 offset:32768
  ds_read_b64_tr_b16 v[34:35], v224 offset:33536
  v_mfma_f32_32x32x16_bf16 v[144:159], v[84:87], v[24:27], v[144:159]
  s_add_u32 m0, s23, 69632
  s_nop 0
  buffer_load_dwordx4 v5, s[16:19], s21 offen lds
  buffer_load_dwordx4 v6, s[16:19], s21 offen offset:1024 lds
  buffer_load_dwordx4 v7, s[16:19], s21 offen offset:2048 lds
  s_add_u32 s21, s21, 88064
  s_add_u32 m0, s22, 16384
  s_nop 0
  buffer_load_dwordx4 v1, s[12:15], s20 offen lds
  buffer_load_dwordx4 v2, s[12:15], s20 offen offset:1024 lds
  buffer_load_dwordx4 v3, s[12:15], s20 offen offset:2048 lds
  buffer_load_dwordx4 v4, s[12:15], s20 offen offset:3072 lds
  s_add_u32 s20, s20, 128
  v_mfma_f32_32x32x16_bf16 v[160:175], v[88:91], v[24:27], v[160:175]
  ds_read_b64_tr_b16 v[36:37], v224 offset:32832
  ds_read_b64_tr_b16 v[38:39], v224 offset:33600
  ds_read_b64_tr_b16 v[40:41], v224 offset:32896
  v_mfma_f32_32x32x16_bf16 v[176:191], v[92:95], v[24:27], v[176:191]
  ds_read_b64_tr_b16 v[42:43], v224 offset:33664
  ds_read_b64_tr_b16 v[44:45], v224 offset:38912
  v_mfma_f32_32x32x16_bf16 v[192:207], v[96:99], v[24:27], v[192:207]
  ds_read_b64_tr_b16 v[46:47], v224 offset:39680
  ds_read_b64_tr_b16 v[48:49], v224 offset:38976
  v_mfma_f32_32x32x16_bf16 v[208:223], v[100:103], v[24:27], v[208:223]
  ds_read_b64_tr_b16 v[50:51], v224 offset:39744
  ds_read_b64_tr_b16 v[52:53], v224 offset:39040
  ds_read_b64_tr_b16 v[54:55], v224 offset:39808
  v_mfma_f32_32x32x16_bf16 v[128:143], v[104:107], v[28:31], v[128:143]
  ds_read_b128 v[20:23], v9 offset:0
  ds_read_b64_tr_b16 v[56:57], v224 offset:35840
  v_mfma_f32_32x32x16_bf16 v[144:159], v[108:111], v[28:31], v[144:159]
  ds_read_b64_tr_b16 v[58:59], v224 offset:36608
  ds_read_b64_tr_b16 v[60:61], v224 offset:35904
  v_mfma_f32_32x32x16_bf16 v[160:175], v[112:115], v[28:31], v[160:175]
  ds_read_b64_tr_b16 v[62:63], v224 offset:36672
  ds_read_b64_tr_b16 v[64:65], v224 offset:35968
  ds_read_b64_tr_b16 v[66:67], v224 offset:36736
  v_mfma_f32_32x32x16_bf16 v[176:191], v[116:119], v[28:31], v[176:191]
  ds_read_b64_tr_b16 v[68:69], v224 offset:41984
  ds_read_b64_tr_b16 v[70:71], v224 offset:42752
  v_mfma_f32_32x32x16_bf16 v[192:207], v[120:123], v[28:31], v[192:207]
  ds_read_b64_tr_b16 v[72:73], v224 offset:42048
  ds_read_b64_tr_b16 v[74:75], v224 offset:42816
  v_mfma_f32_32x32x16_bf16 v[208:223], v[124:127], v[28:31], v[208:223]
  ds_read_b64_tr_b16 v[76:77], v224 offset:42112
  ds_read_b64_tr_b16 v[78:79], v224 offset:42880
  s_waitcnt vmcnt(10) lgkmcnt(0)
  s_barrier
  v_mfma_f32_32x32x16_bf16 v[128:143], v[32:35], v[16:19], v[128:143]
  ds_read_b128 v[24:27], v10 offset:0
  ds_read_b64_tr_b16 v[80:81], v224 offset:45056
  ds_read_b64_tr_b16 v[82:83], v224 offset:45824
  v_mfma_f32_32x32x16_bf16 v[144:159], v[36:39], v[16:19], v[144:159]
  s_add_u32 m0, s23, 32768
  s_nop 0
  buffer_load_dwordx4 v5, s[16:19], s21 offen lds
  buffer_load_dwordx4 v6, s[16:19], s21 offen offset:1024 lds
  buffer_load_dwordx4 v7, s[16:19], s21 offen offset:2048 lds
  s_add_u32 s21, s21, 88064
  v_mfma_f32_32x32x16_bf16 v[160:175], v[40:43], v[16:19], v[160:175]
  ds_read_b64_tr_b16 v[84:85], v224 offset:45120
  ds_read_b64_tr_b16 v[86:87], v224 offset:45888
  ds_read_b64_tr_b16 v[88:89], v224 offset:45184
  v_mfma_f32_32x32x16_bf16 v[176:191], v[44:47], v[16:19], v[176:191]
  ds_read_b64_tr_b16 v[90:91], v224 offset:45952
  ds_read_b64_tr_b16 v[92:93], v225 offset:18432
  v_mfma_f32_32x32x16_bf16 v[192:207], v[48:51], v[16:19], v[192:207]
  ds_read_b64_tr_b16 v[94:95], v225 offset:19200
  ds_read_b64_tr_b16 v[96:97], v225 offset:18496
  v_mfma_f32_32x32x16_bf16 v[208:223], v[52:55], v[16:19], v[208:223]
  ds_read_b64_tr_b16 v[98:99], v225 offset:19264
  ds_read_b64_tr_b16 v[100:101], v225 offset:18560
  ds_read_b64_tr_b16 v[102:103], v225 offset:19328
  v_mfma_f32_32x32x16_bf16 v[128:143], v[56:59], v[20:23], v[128:143]
  ds_read_b128 v[28:31], v11 offset:0
  ds_read_b64_tr_b16 v[104:105], v224 offset:48128
  v_mfma_f32_32x32x16_bf16 v[144:159], v[60:63], v[20:23], v[144:159]
  ds_read_b64_tr_b16 v[106:107], v224 offset:48896
  ds_read_b64_tr_b16 v[108:109], v224 offset:48192
  v_mfma_f32_32x32x16_bf16 v[160:175], v[64:67], v[20:23], v[160:175]
  ds_read_b64_tr_b16 v[110:111], v224 offset:48960
  ds_read_b64_tr_b16 v[112:113], v224 offset:48256
  ds_read_b64_tr_b16 v[114:115], v224 offset:49024
  v_mfma_f32_32x32x16_bf16 v[176:191], v[68:71], v[20:23], v[176:191]
  ds_read_b64_tr_b16 v[116:117], v225 offset:21504
  ds_read_b64_tr_b16 v[118:119], v225 offset:22272
  v_mfma_f32_32x32x16_bf16 v[192:207], v[72:75], v[20:23], v[192:207]
  ds_read_b64_tr_b16 v[120:121], v225 offset:21568
  ds_read_b64_tr_b16 v[122:123], v225 offset:22336
  v_mfma_f32_32x32x16_bf16 v[208:223], v[76:79], v[20:23], v[208:223]
  ds_read_b64_tr_b16 v[124:125], v225 offset:21632
  ds_read_b64_tr_b16 v[126:127], v225 offset:22400
  s_waitcnt vmcnt(3) lgkmcnt(0)
  s_barrier
  v_mfma_f32_32x32x16_bf16 v[128:143], v[80:83], v[24:27], v[128:143]
  ds_read_b128 v[16:19], v8 offset:16384
  ds_read_b64_tr_b16 v[32:33], v225 offset:24576
  ds_read_b64_tr_b16 v[34:35], v225 offset:25344
  v_mfma_f32_32x32x16_bf16 v[144:159], v[84:87], v[24:27], v[144:159]
  s_add_u32 m0, s23, 45056
  s_nop 0
  buffer_load_dwordx4 v5, s[16:19], s21 offen lds
  buffer_load_dwordx4 v6, s[16:19], s21 offen offset:1024 lds
  buffer_load_dwordx4 v7, s[16:19], s21 offen offset:2048 lds
  s_add_u32 s21, s21, 88064
  s_add_u32 m0, s22, 0
  s_nop 0
  buffer_load_dwordx4 v1, s[12:15], s20 offen lds
  buffer_load_dwordx4 v2, s[12:15], s20 offen offset:1024 lds
  buffer_load_dwordx4 v3, s[12:15], s20 offen offset:2048 lds
  buffer_load_dwordx4 v4, s[12:15], s20 offen offset:3072 lds
  s_add_u32 s20, s20, 128
  v_mfma_f32_32x32x16_bf16 v[160:175], v[88:91], v[24:27], v[160:175]
  ds_read_b64_tr_b16 v[36:37], v225 offset:24640
  ds_read_b64_tr_b16 v[38:39], v225 offset:25408
  ds_read_b64_tr_b16 v[40:41], v225 offset:24704
  v_mfma_f32_32x32x16_bf16 v[176:191], v[92:95], v[24:27], v[176:191]
  ds_read_b64_tr_b16 v[42:43], v225 offset:25472
  ds_read_b64_tr_b16 v[44:45], v225 offset:30720
  v_mfma_f32_32x32x16_bf16 v[192:207], v[96:99], v[24:27], v[192:207]
  ds_read_b64_tr_b16 v[46:47], v225 offset:31488
  ds_read_b64_tr_b16 v[48:49], v225 offset:30784
  v_mfma_f32_32x32x16_bf16 v[208:223], v[100:103], v[24:27], v[208:223]
  ds_read_b64_tr_b16 v[50:51], v225 offset:31552
  ds_read_b64_tr_b16 v[52:53], v225 offset:30848
  ds_read_b64_tr_b16 v[54:55], v225 offset:31616
  v_mfma_f32_32x32x16_bf16 v[128:143], v[104:107], v[28:31], v[128:143]
  ds_read_b128 v[20:23], v9 offset:16384
  ds_read_b64_tr_b16 v[56:57], v225 offset:27648
  v_mfma_f32_32x32x16_bf16 v[144:159], v[108:111], v[28:31], v[144:159]
  ds_read_b64_tr_b16 v[58:59], v225 offset:28416
  ds_read_b64_tr_b16 v[60:61], v225 offset:27712
  v_mfma_f32_32x32x16_bf16 v[160:175], v[112:115], v[28:31], v[160:175]
  ds_read_b64_tr_b16 v[62:63], v225 offset:28480
  ds_read_b64_tr_b16 v[64:65], v225 offset:27776
  ds_read_b64_tr_b16 v[66:67], v225 offset:28544
  v_mfma_f32_32x32x16_bf16 v[176:191], v[116:119], v[28:31], v[176:191]
  ds_read_b64_tr_b16 v[68:69], v225 offset:33792
  ds_read_b64_tr_b16 v[70:71], v225 offset:34560
  v_mfma_f32_32x32x16_bf16 v[192:207], v[120:123], v[28:31], v[192:207]
  ds_read_b64_tr_b16 v[72:73], v225 offset:33856
  ds_read_b64_tr_b16 v[74:75], v225 offset:34624
  v_mfma_f32_32x32x16_bf16 v[208:223], v[124:127], v[28:31], v[208:223]
  ds_read_b64_tr_b16 v[76:77], v225 offset:33920
  ds_read_b64_tr_b16 v[78:79], v225 offset:34688
  s_waitcnt vmcnt(10) lgkmcnt(0)
  s_barrier
  v_mfma_f32_32x32x16_bf16 v[128:143], v[32:35], v[16:19], v[128:143]
  ds_read_b128 v[24:27], v10 offset:16384
  ds_read_b64_tr_b16 v[80:81], v225 offset:36864
  ds_read_b64_tr_b16 v[82:83], v225 offset:37632
  v_mfma_f32_32x32x16_bf16 v[144:159], v[36:39], v[16:19], v[144:159]
  s_add_u32 m0, s23, 57344
  s_nop 0
  buffer_load_dwordx4 v5, s[16:19], s21 offen lds
  buffer_load_dwordx4 v6, s[16:19], s21 offen offset:1024 lds
  buffer_load_dwordx4 v7, s[16:19], s21 offen offset:2048 lds
  s_add_u32 s21, s21, 88064
  v_mfma_f32_32x32x16_bf16 v[160:175], v[40:43], v[16:19], v[160:175]
  ds_read_b64_tr_b16 v[84:85], v225 offset:36928
  ds_read_b64_tr_b16 v[86:87], v225 offset:37696
  ds_read_b64_tr_b16 v[88:89], v225 offset:36992
  v_mfma_f32_32x32x16_bf16 v[176:191], v[44:47], v[16:19], v[176:191]
  ds_read_b64_tr_b16 v[90:91], v225 offset:37760
  ds_read_b64_tr_b16 v[92:93], v225 offset:43008
  v_mfma_f32_32x32x16_bf16 v[192:207], v[48:51], v[16:19], v[192:207]
  ds_read_b64_tr_b16 v[94:95], v225 offset:43776
  ds_read_b64_tr_b16 v[96:97], v225 offset:43072
  v_mfma_f32_32x32x16_bf16 v[208:223], v[52:55], v[16:19], v[208:223]
  ds_read_b64_tr_b16 v[98:99], v225 offset:43840
  ds_read_b64_tr_b16 v[100:101], v225 offset:43136
  ds_read_b64_tr_b16 v[102:103], v225 offset:43904
  v_mfma_f32_32x32x16_bf16 v[128:143], v[56:59], v[20:23], v[128:143]
  ds_read_b128 v[28:31], v11 offset:16384
  ds_read_b64_tr_b16 v[104:105], v225 offset:39936
  v_mfma_f32_32x32x16_bf16 v[144:159], v[60:63], v[20:23], v[144:159]
  ds_read_b64_tr_b16 v[106:107], v225 offset:40704
  ds_read_b64_tr_b16 v[108:109], v225 offset:40000
  v_mfma_f32_32x32x16_bf16 v[160:175], v[64:67], v[20:23], v[160:175]
  ds_read_b64_tr_b16 v[110:111], v225 offset:40768
  ds_read_b64_tr_b16 v[112:113], v225 offset:40064
  ds_read_b64_tr_b16 v[114:115], v225 offset:40832
  v_mfma_f32_32x32x16_bf16 v[176:191], v[68:71], v[20:23], v[176:191]
  ds_read_b64_tr_b16 v[116:117], v225 offset:46080
  ds_read_b64_tr_b16 v[118:119], v225 offset:46848
  v_mfma_f32_32x32x16_bf16 v[192:207], v[72:75], v[20:23], v[192:207]
  ds_read_b64_tr_b16 v[120:121], v225 offset:46144
  ds_read_b64_tr_b16 v[122:123], v225 offset:46912
  v_mfma_f32_32x32x16_bf16 v[208:223], v[76:79], v[20:23], v[208:223]
  ds_read_b64_tr_b16 v[124:125], v225 offset:46208
  ds_read_b64_tr_b16 v[126:127], v225 offset:46976
  s_waitcnt vmcnt(3) lgkmcnt(0)
  s_barrier
  v_mfma_f32_32x32x16_bf16 v[128:143], v[80:83], v[24:27], v[128:143]
  ds_read_b128 v[16:19], v8 offset:0
  ds_read_b64_tr_b16 v[32:33], v224 offset:32768
  ds_read_b64_tr_b16 v[34:35], v224 offset:33536
  v_mfma_f32_32x32x16_bf16 v[144:159], v[84:87], v[24:27], v[144:159]
  s_add_u32 m0, s23, 69632
  s_nop 0
  buffer_load_dwordx4 v5, s[16:19], s21 offen lds
  buffer_load_dwordx4 v6, s[16:19], s21 offen offset:1024 lds
  buffer_load_dwordx4 v7, s[16:19], s21 offen offset:2048 lds
  s_add_u32 s21, s21, 88064
  s_add_u32 m0, s22, 16384
  s_nop 0
  buffer_load_dwordx4 v1, s[12:15], s20 offen lds
  buffer_load_dwordx4 v2, s[12:15], s20 offen offset:1024 lds
  buffer_load_dwordx4 v3, s[12:15], s20 offen offset:2048 lds
  buffer_load_dwordx4 v4, s[12:15], s20 offen offset:3072 lds
  s_add_u32 s20, s20, 128
  v_mfma_f32_32x32x16_bf16 v[160:175], v[88:91], v[24:27], v[160:175]
  ds_read_b64_tr_b16 v[36:37], v224 offset:32832
  ds_read_b64_tr_b16 v[38:39], v224 offset:33600
  ds_read_b64_tr_b16 v[40:41], v224 offset:32896
  v_mfma_f32_32x32x16_bf16 v[176:191], v[92:95], v[24:27], v[176:191]
  ds_read_b64_tr_b16 v[42:43], v224 offset:33664
  ds_read_b64_tr_b16 v[44:45], v224 offset:38912
  v_mfma_f32_32x32x16_bf16 v[192:207], v[96:99], v[24:27], v[192:207]
  ds_read_b64_tr_b16 v[46:47], v224 offset:39680
  ds_read_b64_tr_b16 v[48:49], v224 offset:38976
  v_mfma_f32_32x32x16_bf16 v[208:223], v[100:103], v[24:27], v[208:223]
  ds_read_b64_tr_b16 v[50:51], v224 offset:39744
  ds_read_b64_tr_b16 v[52:53], v224 offset:39040
  ds_read_b64_tr_b16 v[54:55], v224 offset:39808
  v_mfma_f32_32x32x16_bf16 v[128:143], v[104:107], v[28:31], v[128:143]
  ds_read_b128 v[20:23], v9 offset:0
  ds_read_b64_tr_b16 v[56:57], v224 offset:35840
  v_mfma_f32_32x32x16_bf16 v[144:159], v[108:111], v[28:31], v[144:159]
  ds_read_b64_tr_b16 v[58:59], v224 offset:36608
  ds_read_b64_tr_b16 v[60:61], v224 offset:35904
  v_mfma_f32_32x32x16_bf16 v[160:175], v[112:115], v[28:31], v[160:175]
  ds_read_b64_tr_b16 v[62:63], v224 offset:36672
  ds_read_b64_tr_b16 v[64:65], v224 offset:35968
  ds_read_b64_tr_b16 v[66:67], v224 offset:36736
  v_mfma_f32_32x32x16_bf16 v[176:191], v[116:119], v[28:31], v[176:191]
  ds_read_b64_tr_b16 v[68:69], v224 offset:41984
  ds_read_b64_tr_b16 v[70:71], v224 offset:42752
  v_mfma_f32_32x32x16_bf16 v[192:207], v[120:123], v[28:31], v[192:207]
  ds_read_b64_tr_b16 v[72:73], v224 offset:42048
  ds_read_b64_tr_b16 v[74:75], v224 offset:42816
  v_mfma_f32_32x32x16_bf16 v[208:223], v[124:127], v[28:31], v[208:223]
  ds_read_b64_tr_b16 v[76:77], v224 offset:42112
  ds_read_b64_tr_b16 v[78:79], v224 offset:42880
  s_waitcnt vmcnt(10) lgkmcnt(0)
  s_barrier
  v_mfma_f32_32x32x16_bf16 v[128:143], v[32:35], v[16:19], v[128:143]
  ds_read_b128 v[24:27], v10 offset:0
  ds_read_b64_tr_b16 v[80:81], v224 offset:45056
  ds_read_b64_tr_b16 v[82:83], v224 offset:45824
  v_mfma_f32_32x32x16_bf16 v[144:159], v[36:39], v[16:19], v[144:159]
  v_mfma_f32_32x32x16_bf16 v[160:175], v[40:43], v[16:19], v[160:175]
  ds_read_b64_tr_b16 v[84:85], v224 offset:45120
  ds_read_b64_tr_b16 v[86:87], v224 offset:45888
  ds_read_b64_tr_b16 v[88:89], v224 offset:45184
  v_mfma_f32_32x32x16_bf16 v[176:191], v[44:47], v[16:19], v[176:191]
  ds_read_b64_tr_b16 v[90:91], v224 offset:45952
  ds_read_b64_tr_b16 v[92:93], v225 offset:18432
  v_mfma_f32_32x32x16_bf16 v[192:207], v[48:51], v[16:19], v[192:207]
  ds_read_b64_tr_b16 v[94:95], v225 offset:19200
  ds_read_b64_tr_b16 v[96:97], v225 offset:18496
  v_mfma_f32_32x32x16_bf16 v[208:223], v[52:55], v[16:19], v[208:223]
  ds_read_b64_tr_b16 v[98:99], v225 offset:19264
  ds_read_b64_tr_b16 v[100:101], v225 offset:18560
  ds_read_b64_tr_b16 v[102:103], v225 offset:19328
  v_mfma_f32_32x32x16_bf16 v[128:143], v[56:59], v[20:23], v[128:143]
  ds_read_b128 v[28:31], v11 offset:0
  ds_read_b64_tr_b16 v[104:105], v224 offset:48128
  v_mfma_f32_32x32x16_bf16 v[144:159], v[60:63], v[20:23], v[144:159]
  ds_read_b64_tr_b16 v[106:107], v224 offset:48896
  ds_read_b64_tr_b16 v[108:109], v224 offset:48192
  v_mfma_f32_32x32x16_bf16 v[160:175], v[64:67], v[20:23], v[160:175]
  ds_read_b64_tr_b16 v[110:111], v224 offset:48960
  ds_read_b64_tr_b16 v[112:113], v224 offset:48256
  ds_read_b64_tr_b16 v[114:115], v224 offset:49024
  v_mfma_f32_32x32x16_bf16 v[176:191], v[68:71], v[20:23], v[176:191]
  ds_read_b64_tr_b16 v[116:117], v225 offset:21504
  ds_read_b64_tr_b16 v[118:119], v225 offset:22272
  v_mfma_f32_32x32x16_bf16 v[192:207], v[72:75], v[20:23], v[192:207]
  ds_read_b64_tr_b16 v[120:121], v225 offset:21568
  ds_read_b64_tr_b16 v[122:123], v225 offset:22336
  v_mfma_f32_32x32x16_bf16 v[208:223], v[76:79], v[20:23], v[208:223]
  ds_read_b64_tr_b16 v[124:125], v225 offset:21632
  ds_read_b64_tr_b16 v[126:127], v225 offset:22400
  s_waitcnt vmcnt(0) lgkmcnt(0)
  s_barrier
  v_mfma_f32_32x32x16_bf16 v[128:143], v[80:83], v[24:27], v[128:143]
  ds_read_b128 v[16:19], v8 offset:16384
  ds_read_b64_tr_b16 v[32:33], v225 offset:24576
  ds_read_b64_tr_b16 v[34:35], v225 offset:25344
  v_mfma_f32_32x32x16_bf16 v[144:159], v[84:87], v[24:27], v[144:159]
  v_mfma_f32_32x32x16_bf16 v[160:175], v[88:91], v[24:27], v[160:175]
  ds_read_b64_tr_b16 v[36:37], v225 offset:24640
  ds_read_b64_tr_b16 v[38:39], v225 offset:25408
  ds_read_b64_tr_b16 v[40:41], v225 offset:24704
  v_mfma_f32_32x32x16_bf16 v[176:191], v[92:95], v[24:27], v[176:191]
  ds_read_b64_tr_b16 v[42:43], v225 offset:25472
  ds_read_b64_tr_b16 v[44:45], v225 offset:30720
  v_mfma_f32_32x32x16_bf16 v[192:207], v[96:99], v[24:27], v[192:207]
  ds_read_b64_tr_b16 v[46:47], v225 offset:31488
  ds_read_b64_tr_b16 v[48:49], v225 offset:30784
  v_mfma_f32_32x32x16_bf16 v[208:223], v[100:103], v[24:27], v[208:223]
  ds_read_b64_tr_b16 v[50:51], v225 offset:31552
  ds_read_b64_tr_b16 v[52:53], v225 offset:30848
  ds_read_b64_tr_b16 v[54:55], v225 offset:31616
  v_mfma_f32_32x32x16_bf16 v[128:143], v[104:107], v[28:31], v[128:143]
  ds_read_b128 v[20:23], v9 offset:16384
  ds_read_b64_tr_b16 v[56:57], v225 offset:27648
  v_mfma_f32_32x32x16_bf16 v[144:159], v[108:111], v[28:31], v[144:159]
  ds_read_b64_tr_b16 v[58:59], v225 offset:28416
  ds_read_b64_tr_b16 v[60:61], v225 offset:27712
  v_mfma_f32_32x32x16_bf16 v[160:175], v[112:115], v[28:31], v[160:175]
  ds_read_b64_tr_b16 v[62:63], v225 offset:28480
  ds_read_b64_tr_b16 v[64:65], v225 offset:27776
  ds_read_b64_tr_b16 v[66:67], v225 offset:28544
  v_mfma_f32_32x32x16_bf16 v[176:191], v[116:119], v[28:31], v[176:191]
  ds_read_b64_tr_b16 v[68:69], v225 offset:33792
  ds_read_b64_tr_b16 v[70:71], v225 offset:34560
  v_mfma_f32_32x32x16_bf16 v[192:207], v[120:123], v[28:31], v[192:207]
  ds_read_b64_tr_b16 v[72:73], v225 offset:33856
  ds_read_b64_tr_b16 v[74:75], v225 offset:34624
  v_mfma_f32_32x32x16_bf16 v[208:223], v[124:127], v[28:31], v[208:223]
  ds_read_b64_tr_b16 v[76:77], v225 offset:33920
  ds_read_b64_tr_b16 v[78:79], v225 offset:34688
  s_waitcnt vmcnt(0) lgkmcnt(0)
  s_barrier
  v_mfma_f32_32x32x16_bf16 v[128:143], v[32:35], v[16:19], v[128:143]
  ds_read_b128 v[24:27], v10 offset:16384
  ds_read_b64_tr_b16 v[80:81], v225 offset:36864
  ds_read_b64_tr_b16 v[82:83], v225 offset:37632
  v_mfma_f32_32x32x16_bf16 v[144:159], v[36:39], v[16:19], v[144:159]
  v_mfma_f32_32x32x16_bf16 v[160:175], v[40:43], v[16:19], v[160:175]
  ds_read_b64_tr_b16 v[84:85], v225 offset:36928
  ds_read_b64_tr_b16 v[86:87], v225 offset:37696
  ds_read_b64_tr_b16 v[88:89], v225 offset:36992
  v_mfma_f32_32x32x16_bf16 v[176:191], v[44:47], v[16:19], v[176:191]
  ds_read_b64_tr_b16 v[90:91], v225 offset:37760
  ds_read_b64_tr_b16 v[92:93], v225 offset:43008
  v_mfma_f32_32x32x16_bf16 v[192:207], v[48:51], v[16:19], v[192:207]
  ds_read_b64_tr_b16 v[94:95], v225 offset:43776
  ds_read_b64_tr_b16 v[96:97], v225 offset:43072
  v_mfma_f32_32x32x16_bf16 v[208:223], v[52:55], v[16:19], v[208:223]
  ds_read_b64_tr_b16 v[98:99], v225 offset:43840
  ds_read_b64_tr_b16 v[100:101], v225 offset:43136
  ds_read_b64_tr_b16 v[102:103], v225 offset:43904
  v_mfma_f32_32x32x16_bf16 v[128:143], v[56:59], v[20:23], v[128:143]
  ds_read_b128 v[28:31], v11 offset:16384
  ds_read_b64_tr_b16 v[104:105], v225 offset:39936
  v_mfma_f32_32x32x16_bf16 v[144:159], v[60:63], v[20:23], v[144:159]
  ds_read_b64_tr_b16 v[106:107], v225 offset:40704
  ds_read_b64_tr_b16 v[108:109], v225 offset:40000
  v_mfma_f32_32x32x16_bf16 v[160:175], v[64:67], v[20:23], v[160:175]
  ds_read_b64_tr_b16 v[110:111], v225 offset:40768
  ds_read_b64_tr_b16 v[112:113], v225 offset:40064
  ds_read_b64_tr_b16 v[114:115], v225 offset:40832
  v_mfma_f32_32x32x16_bf16 v[176:191], v[68:71], v[20:23], v[176:191]
  ds_read_b64_tr_b16 v[116:117], v225 offset:46080
  ds_read_b64_tr_b16 v[118:119], v225 offset:46848
  v_mfma_f32_32x32x16_bf16 v[192:207], v[72:75], v[20:23], v[192:207]
  ds_read_b64_tr_b16 v[120:121], v225 offset:46144
  ds_read_b64_tr_b16 v[122:123], v225 offset:46912
  v_mfma_f32_32x32x16_bf16 v[208:223], v[76:79], v[20:23], v[208:223]
  ds_read_b64_tr_b16 v[124:125], v225 offset:46208
  ds_read_b64_tr_b16 v[126:127], v225 offset:46976
  s_waitcnt lgkmcnt(0)
  v_mfma_f32_32x32x16_bf16 v[128:143], v[80:83], v[24:27], v[128:143]
  v_mfma_f32_32x32x16_bf16 v[144:159], v[84:87], v[24:27], v[144:159]
  v_mfma_f32_32x32x16_bf16 v[160:175], v[88:91], v[24:27], v[160:175]
  v_mfma_f32_32x32x16_bf16 v[176:191], v[92:95], v[24:27], v[176:191]
  v_mfma_f32_32x32x16_bf16 v[192:207], v[96:99], v[24:27], v[192:207]
  v_mfma_f32_32x32x16_bf16 v[208:223], v[100:103], v[24:27], v[208:223]
  v_mfma_f32_32x32x16_bf16 v[128:143], v[104:107], v[28:31], v[128:143]
  v_mfma_f32_32x32x16_bf16 v[144:159], v[108:111], v[28:31], v[144:159]
  v_mfma_f32_32x32x16_bf16 v[160:175], v[112:115], v[28:31], v[160:175]
  v_mfma_f32_32x32x16_bf16 v[176:191], v[116:119], v[28:31], v[176:191]
  v_mfma_f32_32x32x16_bf16 v[192:207], v[120:123], v[28:31], v[192:207]
  v_mfma_f32_32x32x16_bf16 v[208:223], v[124:127], v[28:31], v[208:223]
  s_branch g_loop_done
g_np2:
  s_add_u32 m0, s22, 0
  s_nop 0
  buffer_load_dwordx4 v1, s[12:15], s20 offen lds
  buffer_load_dwordx4 v2, s[12:15], s20 offen offset:1024 lds
  buffer_load_dwordx4 v3, s[12:15], s20 offen offset:2048 lds
  buffer_load_dwordx4 v4, s[12:15], s20 offen offset:3072 lds
  s_add_u32 s20, s20, 128
  s_add_u32 m0, s23, 32768
  s_nop 0
  buffer_load_dwordx4 v5, s[16:19], s21 offen lds
  buffer_load_dwordx4 v6, s[16:19], s21 offen offset:1024 lds
  buffer_load_dwordx4 v7, s[16:19], s21 offen offset:2048 lds
  s_add_u32 s21, s21, 88064
  s_add_u32 m0, s23, 45056
  s_nop 0
  buffer_load_dwordx4 v5, s[16:19], s21 offen lds
  buffer_load_dwordx4 v6, s[16:19], s21 offen offset:1024 lds
  buffer_load_dwordx4 v7, s[16:19], s21 offen offset:2048 lds
  s_add_u32 s21, s21, 88064
  s_add_u32 m0, s22, 16384
  s_nop 0
  buffer_load_dwordx4 v1, s[12:15], s20 offen lds
  buffer_load_dwordx4 v2, s[12:15], s20 offen offset:1024 lds
  buffer_load_dwordx4 v3, s[12:15], s20 offen offset:2048 lds
  buffer_load_dwordx4 v4, s[12:15], s20 offen offset:3072 lds
  s_add_u32 s20, s20, 128
  s_add_u32 m0, s23, 57344
  s_nop 0
  buffer_load_dwordx4 v5, s[16:19], s21 offen lds
  buffer_load_dwordx4 v6, s[16:19], s21 offen offset:1024 lds
  buffer_load_dwordx4 v7, s[16:19], s21 offen offset:2048 lds
  s_add_u32 s21, s21, 88064
  s_add_u32 m0, s23, 69632
  s_nop 0
  buffer_load_dwordx4 v5, s[16:19], s21 offen lds
  buffer_load_dwordx4 v6, s[16:19], s21 offen offset:1024 lds
  buffer_load_dwordx4 v7, s[16:19], s21 offen offset:2048 lds
  s_add_u32 s21, s21, 88064
  v_mov_b32 v128, 0
  v_mov_b32 v129, 0
  v_mov_b32 v130, 0
  v_mov_b32 v131, 0
  v_mov_b32 v132, 0
  v_mov_b32 v133, 0
  v_mov_b32 v134, 0
  v_mov_b32 v135, 0
  v_mov_b32 v136, 0
  v_mov_b32 v137, 0
  v_mov_b32 v138, 0
  v_mov_b32 v139, 0
  v_mov_b32 v140, 0
  v_mov_b32 v141, 0
  v_mov_b32 v142, 0
  v_mov_b32 v143, 0
  v_mov_b32 v144, 0
  v_mov_b32 v145, 0
  v_mov_b32 v146, 0
  v_mov_b32 v147, 0
  v_mov_b32 v148, 0
  v_mov_b32 v149, 0
  v_mov_b32 v150, 0
  v_mov_b32 v151, 0
  v_mov_b32 v152, 0
  v_mov_b32 v153, 0
  v_mov_b32 v154, 0
  v_mov_b32 v155, 0
  v_mov_b32 v156, 0
  v_mov_b32 v157, 0
  v_mov_b32 v158, 0
  v_mov_b32 v159, 0
  v_mov_b32 v160, 0
  v_mov_b32 v161, 0
  v_mov_b32 v162, 0
  v_mov_b32 v163, 0
  v_mov_b32 v164, 0
  v_mov_b32 v165, 0
  v_mov_b32 v166, 0
  v_mov_b32 v167, 0
  v_mov_b32 v168, 0
  v_mov_b32 v169, 0
  v_mov_b32 v170, 0
  v_mov_b32 v171, 0
  v_mov_b32 v172, 0
  v_mov_b32 v173, 0
  v_mov_b32 v174, 0
  v_mov_b32 v175, 0
  v_mov_b32 v176, 0
  v_mov_b32 v177, 0
  v_mov_b32 v178, 0
  v_mov_b32 v179, 0
  v_mov_b32 v180, 0
  v_mov_b32 v181, 0
  v_mov_b32 v182, 0
  v_mov_b32 v183, 0
  v_mov_b32 v184, 0
  v_mov_b32 v185, 0
  v_mov_b32 v186, 0
  v_mov_b32 v187, 0
  v_mov_b32 v188, 0
  v_mov_b32 v189, 0
  v_mov_b32 v190, 0
  v_mov_b32 v191, 0
  v_mov_b32 v192, 0
  v_mov_b32 v193, 0
  v_mov_b32 v194, 0
  v_mov_b32 v195, 0
  v_mov_b32 v196, 0
  v_mov_b32 v197, 0
  v_mov_b32 v198, 0
  v_mov_b32 v199, 0
  v_mov_b32 v200, 0
  v_mov_b32 v201, 0
  v_mov_b32 v202, 0
  v_mov_b32 v203, 0
  v_mov_b32 v204, 0
  v_mov_b32 v205, 0
  v_mov_b32 v206, 0
  v_mov_b32 v207, 0
  v_mov_b32 v208, 0
  v_mov_b32 v209, 0
  v_mov_b32 v210, 0
  v_mov_b32 v211, 0
  v_mov_b32 v212, 0
  v_mov_b32 v213, 0
  v_mov_b32 v214, 0
  v_mov_b32 v215, 0
  v_mov_b32 v216, 0
  v_mov_b32 v217, 0
  v_mov_b32 v218, 0
  v_mov_b32 v219, 0
  v_mov_b32 v220, 0
  v_mov_b32 v221, 0
  v_mov_b32 v222, 0
  v_mov_b32 v223, 0
  s_setprio 0
  s_waitcnt vmcnt(13)
  s_barrier
  ds_read_b128 v[16:19], v8 offset:0
  ds_read_b64_tr_b16 v[32:33], v224 offset:32768
  ds_read_b64_tr_b16 v[34:35], v224 offset:33536
  ds_read_b64_tr_b16 v[36:37], v224 offset:32832
  ds_read_b64_tr_b16 v[38:39], v224 offset:33600
  ds_read_b64_tr_b16 v[44:45], v224 offset:38912
  ds_read_b64_tr_b16 v[46:47], v224 offset:39680
  ds_read_b64_tr_b16 v[48:49], v224 offset:38976
  ds_read_b64_tr_b16 v[50:51], v224 offset:39744
  ds_read_b128 v[20:23], v9 offset:0
  ds_read_b64_tr_b16 v[56:57], v224 offset:35840
  ds_read_b64_tr_b16 v[58:59], v224 offset:36608
  ds_read_b64_tr_b16 v[60:61], v224 offset:35904
  ds_read_b64_tr_b16 v[62:63], v224 offset:36672
  ds_read_b64_tr_b16 v[68:69], v224 offset:41984
  ds_read_b64_tr_b16 v[70:71], v224 offset:42752
  ds_read_b64_tr_b16 v[72:73], v224 offset:42048
  ds_read_b64_tr_b16 v[74:75], v224 offset:42816
  s_waitcnt vmcnt(10) lgkmcnt(0)
  s_barrier
  v_mfma_f32_32x32x16_bf16 v[128:143], v[32:35], v[16:19], v[128:143]
  ds_read_b128 v[24:27], v10 offset:0
  ds_read_b64_tr_b16 v[80:81], v224 offset:45056
  ds_read_b64_tr_b16 v[82:83], v224 offset:45824
  v_mfma_f32_32x32x16_bf16 v[144:159], v[36:39], v[16:19], v[144:159]
  s_add_u32 m0, s23, 32768
  s_nop 0
  buffer_load_dwordx4 v5, s[16:19], s21 offen lds
  buffer_load_dwordx4 v6, s[16:19], s21 offen offset:1024 lds
  buffer_load_dwordx4 v7, s[16:19], s21 offen offset:2048 lds
  s_add_u32 s21, s21, 88064
  v_mfma_f32_32x32x16_bf16 v[176:191], v[44:47], v[16:19], v[176:191]
  ds_read_b64_tr_b16 v[84:85], v224 offset:45120
  ds_read_b64_tr_b16 v[86:87], v224 offset:45888
  ds_read_b64_tr_b16 v[92:93], v225 offset:18432
  v_mfma_f32_32x32x16_bf16 v[192:207], v[48:51], v[16:19], v[192:207]
  ds_read_b64_tr_b16 v[94:95], v225 offset:19200
  ds_read_b64_tr_b16 v[96:97], v225 offset:18496
  v_mfma_f32_32x32x16_bf16 v[128:143], v[56:59], v[20:23], v[128:143]
  ds_read_b64_tr_b16 v[98:99], v225 offset:19264
  ds_read_b128 v[28:31], v11 offset:0
  ds_read_b64_tr_b16 v[104:105], v224 offset:48128
  v_mfma_f32_32x32x16_bf16 v[144:159], v[60:63], v[20:23], v[144:159]
  ds_read_b64_tr_b16 v[106:107], v224 offset:48896
  ds_read_b64_tr_b16 v[108:109], v224 offset:48192
  v_mfma_f32_32x32x16_bf16 v[176:191], v[68:71], v[20:23], v[176:191]
  ds_read_b64_tr_b16 v[110:111], v224 offset:48960
  ds_read_b64_tr_b16 v[116:117], v225 offset:21504
  ds_read_b64_tr_b16 v[118:119], v225 offset:22272
  v_mfma_f32_32x32x16_bf16 v[192:207], v[72:75], v[20:23], v[192:207]
  ds_read_b64_tr_b16 v[120:121], v225 offset:21568
  ds_read_b64_tr_b16 v[122:123], v225 offset:22336
  s_waitcnt vmcnt(6) lgkmcnt(0)
  s_barrier
  v_mfma_f32_32x32x16_bf16 v[128:143], v[80:83], v[24:27], v[128:143]
  ds_read_b128 v[16:19], v8 offset:16384
  ds_read_b64_tr_b16 v[32:33], v225 offset:24576
  ds_read_b64_tr_b16 v[34:35], v225 offset:25344
  v_mfma_f32_32x32x16_bf16 v[144:159], v[84:87], v[24:27], v[144:159]
  s_add_u32 m0, s23, 45056
  s_nop 0
  buffer_load_dwordx4 v5, s[16:19], s21 offen lds
  buffer_load_dwordx4 v6, s[16:19], s21 offen offset:1024 lds
  buffer_load_dwordx4 v7, s[16:19], s21 offen offset:2048 lds
  s_add_u32 s21, s21, 88064
  s_add_u32 m0, s22, 0
  s_nop 0
  buffer_load_dwordx4 v1, s[12:15], s20 offen lds
  buffer_load_dwordx4 v2, s[12:15], s20 offen offset:1024 lds
  buffer_load_dwordx4 v3, s[12:15], s20 offen offset:2048 lds
  buffer_load_dwordx4 v4, s[12:15], s20 offen offset:3072 lds
  s_add_u32 s20, s20, 128
  v_mfma_f32_32x32x16_bf16 v[176:191], v[92:95], v[24:27], v[176:191]
  ds_read_b64_tr_b16 v[36:37], v225 offset:24640
  ds_read_b64_tr_b16 v[38:39], v225 offset:25408
  ds_read_b64_tr_b16 v[44:45], v225 offset:30720
  v_mfma_f32_32x32x16_bf16 v[192:207], v[96:99], v[24:27], v[192:207]
  ds_read_b64_tr_b16 v[46:47], v225 offset:31488
  ds_read_b64_tr_b16 v[48:49], v225 offset:30784
  v_mfma_f32_32x32x16_bf16 v[128:143], v[104:107], v[28:31], v[128:143]
  ds_read_b64_tr_b16 v[50:51], v225 offset:31552
  ds_read_b128 v[20:23], v9 offset:16384
  ds_read_b64_tr_b16 v[56:57], v225 offset:27648
  v_mfma_f32_32x32x16_bf16 v[144:159], v[108:111], v[28:31], v[144:159]
  ds_read_b64_tr_b16 v[58:59], v225 offset:28416
  ds_read_b64_tr_b16 v[60:61], v225 offset:27712
  v_mfma_f32_32x32x16_bf16 v[176:191], v[116:119], v[28:31], v[176:191]
  ds_read_b64_tr_b16 v[62:63], v225 offset:28480
  ds_read_b64_tr_b16 v[68:69], v225 offset:33792
  ds_read_b64_tr_b16 v[70:71], v225 offset:34560
  v_mfma_f32_32x32x16_bf16 v[192:207], v[120:123], v[28:31], v[192:207]
  ds_read_b64_tr_b16 v[72:73], v225 offset:33856
  ds_read_b64_tr_b16 v[74:75], v225 offset:34624
  s_waitcnt vmcnt(10) lgkmcnt(0)
  s_barrier
  v_mfma_f32_32x32x16_bf16 v[128:143], v[32:35], v[16:19], v[128:143]
  ds_read_b128 v[24:27], v10 offset:16384
  ds_read_b64_tr_b16 v[80:81], v225 offset:36864
  ds_read_b64_tr_b16 v[82:83], v225 offset:37632
  v_mfma_f32_32x32x16_bf16 v[144:159], v[36:39], v[16:19], v[144:159]
  s_add_u32 m0, s23, 57344
  s_nop 0
  buffer_load_dwordx4 v5, s[16:19], s21 offen lds
  buffer_load_dwordx4 v6, s[16:19], s21 offen offset:1024 lds
  buffer_load_dwordx4 v7, s[16:19], s21 offen offset:2048 lds
  s_add_u32 s21, s21, 88064
  v_mfma_f32_32x32x16_bf16 v[176:191], v[44:47], v[16:19], v[176:191]
  ds_read_b64_tr_b16 v[84:85], v225 offset:36928
  ds_read_b64_tr_b16 v[86:87], v225 offset:37696
  ds_read_b64_tr_b16 v[92:93], v225 offset:43008
  v_mfma_f32_32x32x16_bf16 v[192:207], v[48:51], v[16:19], v[192:207]
  ds_read_b64_tr_b16 v[94:95], v225 offset:43776
  ds_read_b64_tr_b16 v[96:97], v225 offset:43072
  v_mfma_f32_32x32x16_bf16 v[128:143], v[56:59], v[20:23], v[128:143]
  ds_read_b64_tr_b16 v[98:99], v225 offset:43840
  ds_read_b128 v[28:31], v11 offset:16384
  ds_read_b64_tr_b16 v[104:105], v225 offset:39936
  v_mfma_f32_32x32x16_bf16 v[144:159], v[60:63], v[20:23], v[144:159]
  ds_read_b64_tr_b16 v[106:107], v225 offset:40704
  ds_read_b64_tr_b16 v[108:109], v225 offset:40000
  v_mfma_f32_32x32x16_bf16 v[176:191], v[68:71], v[20:23], v[176:191]
  ds_read_b64_tr_b16 v[110:111], v225 offset:40768
  ds_read_b64_tr_b16 v[116:117], v225 offset:46080
  ds_read_b64_tr_b16 v[118:119], v225 offset:46848
  v_mfma_f32_32x32x16_bf16 v[192:207], v[72:75], v[20:23], v[192:207]
  ds_read_b64_tr_b16 v[120:121], v225 offset:46144
  ds_read_b64_tr_b16 v[122:123], v225 offset:46912
  s_waitcnt vmcnt(3) lgkmcnt(0)
  s_barrier
  v_mfma_f32_32x32x16_bf16 v[128:143], v[80:83], v[24:27], v[128:143]
  ds_read_b128 v[16:19], v8 offset:0
  ds_read_b64_tr_b16 v[32:33], v224 offset:32768
  ds_read_b64_tr_b16 v[34:35], v224 offset:33536
  v_mfma_f32_32x32x16_bf16 v[144:159], v[84:87], v[24:27], v[144:159]
  s_add_u32 m0, s23, 69632
  s_nop 0
  buffer_load_dwordx4 v5, s[16:19], s21 offen lds
  buffer_load_dwordx4 v6, s[16:19], s21 offen offset:1024 lds
  buffer_load_dwordx4 v7, s[16:19], s21 offen offset:2048 lds
  s_add_u32 s21, s21, 88064
  s_add_u32 m0, s22, 16384
  s_nop 0
  buffer_load_dwordx4 v1, s[12:15], s20 offen lds
  buffer_load_dwordx4 v2, s[12:15], s20 offen offset:1024 lds
  buffer_load_dwordx4 v3, s[12:15], s20 offen offset:2048 lds
  buffer_load_dwordx4 v4, s[12:15], s20 offen offset:3072 lds
  s_add_u32 s20, s20, 128
  v_mfma_f32_32x32x16_bf16 v[176:191], v[92:95], v[24:27], v[176:191]
  ds_read_b64_tr_b16 v[36:37], v224 offset:32832
  ds_read_b64_tr_b16 v[38:39], v224 offset:33600
  ds_read_b64_tr_b16 v[44:45], v224 offset:38912
  v_mfma_f32_32x32x16_bf16 v[192:207], v[96:99], v[24:27], v[192:207]
  ds_read_b64_tr_b16 v[46:47], v224 offset:39680
  ds_read_b64_tr_b16 v[48:49], v224 offset:38976
  v_mfma_f32_32x32x16_bf16 v[128:143], v[104:107], v[28:31], v[128:143]
  ds_read_b64_tr_b16 v[50:51], v224 offset:39744
  ds_read_b128 v[20:23], v9 offset:0
  ds_read_b64_tr_b16 v[56:57], v224 offset:35840
  v_mfma_f32_32x32x16_bf16 v[144:159], v[108:111], v[28:31], v[144:159]
  ds_read_b64_tr_b16 v[58:59], v224 offset:36608
  ds_read_b64_tr_b16 v[60:61], v224 offset:35904
  v_mfma_f32_32x32x16_bf16 v[176:191], v[116:119], v[28:31], v[176:191]
  ds_read_b64_tr_b16 v[62:63], v224 offset:36672
  ds_read_b64_tr_b16 v[68:69], v224 offset:41984
  ds_read_b64_tr_b16 v[70:71], v224 offset:42752
  v_mfma_f32_32x32x16_bf16 v[192:207], v[120:123], v[28:31], v[192:207]
  ds_read_b64_tr_b16 v[72:73], v224 offset:42048
  ds_read_b64_tr_b16 v[74:75], v224 offset:42816
  s_waitcnt vmcnt(10) lgkmcnt(0)
  s_barrier
  v_mfma_f32_32x32x16_bf16 v[128:143], v[32:35], v[16:19], v[128:143]
  ds_read_b128 v[24:27], v10 offset:0
  ds_read_b64_tr_b16 v[80:81], v224 offset:45056
  ds_read_b64_tr_b16 v[82:83], v224 offset:45824
  v_mfma_f32_32x32x16_bf16 v[144:159], v[36:39], v[16:19], v[144:159]
  s_add_u32 m0, s23, 32768
  s_nop 0
  buffer_load_dwordx4 v5, s[16:19], s21 offen lds
  buffer_load_dwordx4 v6, s[16:19], s21 offen offset:1024 lds
  buffer_load_dwordx4 v7, s[16:19], s21 offen offset:2048 lds
  s_add_u32 s21, s21, 88064
  v_mfma_f32_32x32x16_bf16 v[176:191], v[44:47], v[16:19], v[176:191]
  ds_read_b64_tr_b16 v[84:85], v224 offset:45120
  ds_read_b64_tr_b16 v[86:87], v224 offset:45888
  ds_read_b64_tr_b16 v[92:93], v225 offset:18432
  v_mfma_f32_32x32x16_bf16 v[192:207], v[48:51], v[16:19], v[192:207]
  ds_read_b64_tr_b16 v[94:95], v225 offset:19200
  ds_read_b64_tr_b16 v[96:97], v225 offset:18496
  v_mfma_f32_32x32x16_bf16 v[128:143], v[56:59], v[20:23], v[128:143]
  ds_read_b64_tr_b16 v[98:99], v225 offset:19264
  ds_read_b128 v[28:31], v11 offset:0
  ds_read_b64_tr_b16 v[104:105], v224 offset:48128
  v_mfma_f32_32x32x16_bf16 v[144:159], v[60:63], v[20:23], v[144:159]
  ds_read_b64_tr_b16 v[106:107], v224 offset:48896
  ds_read_b64_tr_b16 v[108:109], v224 offset:48192
  v_mfma_f32_32x32x16_bf16 v[176:191], v[68:71], v[20:23], v[176:191]
  ds_read_b64_tr_b16 v[110:111], v224 offset:48960
  ds_read_b64_tr_b16 v[116:117], v225 offset:21504
  ds_read_b64_tr_b16 v[118:119], v225 offset:22272
  v_mfma_f32_32x32x16_bf16 v[192:207], v[72:75], v[20:23], v[192:207]
  ds_read_b64_tr_b16 v[120:121], v225 offset:21568
  ds_read_b64_tr_b16 v[122:123], v225 offset:22336
  s_waitcnt vmcnt(3) lgkmcnt(0)
  s_barrier
  v_mfma_f32_32x32x16_bf16 v[128:143], v[80:83], v[24:27], v[128:143]
  ds_read_b128 v[16:19], v8 offset:16384
  ds_read_b64_tr_b16 v[32:33], v225 offset:24576
  ds_read_b64_tr_b16 v[34:35], v225 offset:25344
  v_mfma_f32_32x32x16_bf16 v[144:159], v[84:87], v[24:27], v[144:159]
  s_add_u32 m0, s23, 45056
  s_nop 0
  buffer_load_dwordx4 v5, s[16:19], s21 offen lds
  buffer_load_dwordx4 v6, s[16:19], s21 offen offset:1024 lds
  buffer_load_dwordx4 v7, s[16:19], s21 offen offset:2048 lds
  s_add_u32 s21, s21, 88064
  s_add_u32 m0, s22, 0
  s_nop 0
  buffer_load_dwordx4 v1, s[12:15], s20 offen lds
  buffer_load_dwordx4 v2, s[12:15], s20 offen offset:1024 lds
  buffer_load_dwordx4 v3, s[12:15], s20 offen offset:2048 lds
  buffer_load_dwordx4 v4, s[12:15], s20 offen offset:3072 lds
  s_add_u32 s20, s20, 128
  v_mfma_f32_32x32x16_bf16 v[176:191], v[92:95], v[24:27], v[176:191]
  ds_read_b64_tr_b16 v[36:37], v225 offset:24640
  ds_read_b64_tr_b16 v[38:39], v225 offset:25408
  ds_read_b64_tr_b16 v[44:45], v225 offset:30720
  v_mfma_f32_32x32x16_bf16 v[192:207], v[96:99], v[24:27], v[192:207]
  ds_read_b64_tr_b16 v[46:47], v225 offset:31488
  ds_read_b64_tr_b16 v[48:49], v225 offset:30784
  v_mfma_f32_32x32x16_bf16 v[128:143], v[104:107], v[28:31], v[128:143]
  ds_read_b64_tr_b16 v[50:51], v225 offset:31552
  ds_read_b128 v[20:23], v9 offset:16384
  ds_read_b64_tr_b16 v[56:57], v225 offset:27648
  v_mfma_f32_32x32x16_bf16 v[144:159], v[108:111], v[28:31], v[144:159]
  ds_read_b64_tr_b16 v[58:59], v225 offset:28416
  ds_read_b64_tr_b16 v[60:61], v225 offset:27712
  v_mfma_f32_32x32x16_bf16 v[176:191], v[116:119], v[28:31], v[176:191]
  ds_read_b64_tr_b16 v[62:63], v225 offset:28480
  ds_read_b64_tr_b16 v[68:69], v225 offset:33792
  ds_read_b64_tr_b16 v[70:71], v225 offset:34560
  v_mfma_f32_32x32x16_bf16 v[192:207], v[120:123], v[28:31], v[192:207]
  ds_read_b64_tr_b16 v[72:73], v225 offset:33856
  ds_read_b64_tr_b16 v[74:75], v225 offset:34624
  s_waitcnt vmcnt(10) lgkmcnt(0)
  s_barrier
  v_mfma_f32_32x32x16_bf16 v[128:143], v[32:35], v[16:19], v[128:143]
  ds_read_b128 v[24:27], v10 offset:16384
  ds_read_b64_tr_b16 v[80:81], v225 offset:36864
  ds_read_b64_tr_b16 v[82:83], v225 offset:37632
  v_mfma_f32_32x32x16_bf16 v[144:159], v[36:39], v[16:19], v[144:159]
  s_add_u32 m0, s23, 57344
  s_nop 0
  buffer_load_dwordx4 v5, s[16:19], s21 offen lds
  buffer_load_dwordx4 v6, s[16:19], s21 offen offset:1024 lds
  buffer_load_dwordx4 v7, s[16:19], s21 offen offset:2048 lds
  s_add_u32 s21, s21, 88064
  v_mfma_f32_32x32x16_bf16 v[176:191], v[44:47], v[16:19], v[176:191]
  ds_read_b64_tr_b16 v[84:85], v225 offset:36928
  ds_read_b64_tr_b16 v[86:87], v225 offset:37696
  ds_read_b64_tr_b16 v[92:93], v225 offset:43008
  v_mfma_f32_32x32x16_bf16 v[192:207], v[48:51], v[16:19], v[192:207]
  ds_read_b64_tr_b16 v[94:95], v225 offset:43776
  ds_read_b64_tr_b16 v[96:97], v225 offset:43072
  v_mfma_f32_32x32x16_bf16 v[128:143], v[56:59], v[20:23], v[128:143]
  ds_read_b64_tr_b16 v[98:99], v225 offset:43840
  ds_read_b128 v[28:31], v11 offset:16384
  ds_read_b64_tr_b16 v[104:105], v225 offset:39936
  v_mfma_f32_32x32x16_bf16 v[144:159], v[60:63], v[20:23], v[144:159]
  ds_read_b64_tr_b16 v[106:107], v225 offset:40704
  ds_read_b64_tr_b16 v[108:109], v225 offset:40000
  v_mfma_f32_32x32x16_bf16 v[176:191], v[68:71], v[20:23], v[176:191]
  ds_read_b64_tr_b16 v[110:111], v225 offset:40768
  ds_read_b64_tr_b16 v[116:117], v225 offset:46080
  ds_read_b64_tr_b16 v[118:119], v225 offset:46848
  v_mfma_f32_32x32x16_bf16 v[192:207], v[72:75], v[20:23], v[192:207]
  ds_read_b64_tr_b16 v[120:121], v225 offset:46144
  ds_read_b64_tr_b16 v[122:123], v225 offset:46912
  s_waitcnt vmcnt(3) lgkmcnt(0)
  s_barrier
  v_mfma_f32_32x32x16_bf16 v[128:143], v[80:83], v[24:27], v[128:143]
  ds_read_b128 v[16:19], v8 offset:0
  ds_read_b64_tr_b16 v[32:33], v224 offset:32768
  ds_read_b64_tr_b16 v[34:35], v224 offset:33536
  v_mfma_f32_32x32x16_bf16 v[144:159], v[84:87], v[24:27], v[144:159]
  s_add_u32 m0, s23, 69632
  s_nop 0
  buffer_load_dwordx4 v5, s[16:19], s21 offen lds
  buffer_load_dwordx4 v6, s[16:19], s21 offen offset:1024 lds
  buffer_load_dwordx4 v7, s[16:19], s21 offen offset:2048 lds
  s_add_u32 s21, s21, 88064
  s_add_u32 m0, s22, 16384
  s_nop 0
  buffer_load_dwordx4 v1, s[12:15], s20 offen lds
  buffer_load_dwordx4 v2, s[12:15], s20 offen offset:1024 lds
  buffer_load_dwordx4 v3, s[12:15], s20 offen offset:2048 lds
  buffer_load_dwordx4 v4, s[12:15], s20 offen offset:3072 lds
  s_add_u32 s20, s20, 128
  v_mfma_f32_32x32x16_bf16 v[176:191], v[92:95], v[24:27], v[176:191]
  ds_read_b64_tr_b16 v[36:37], v224 offset:32832
  ds_read_b64_tr_b16 v[38:39], v224 offset:33600
  ds_read_b64_tr_b16 v[44:45], v224 offset:38912
  v_mfma_f32_32x32x16_bf16 v[192:207], v[96:99], v[24:27], v[192:207]
  ds_read_b64_tr_b16 v[46:47], v224 offset:39680
  ds_read_b64_tr_b16 v[48:49], v224 offset:38976
  v_mfma_f32_32x32x16_bf16 v[128:143], v[104:107], v[28:31], v[128:143]
  ds_read_b64_tr_b16 v[50:51], v224 offset:39744
  ds_read_b128 v[20:23], v9 offset:0
  ds_read_b64_tr_b16 v[56:57], v224 offset:35840
  v_mfma_f32_32x32x16_bf16 v[144:159], v[108:111], v[28:31], v[144:159]
  ds_read_b64_tr_b16 v[58:59], v224 offset:36608
  ds_read_b64_tr_b16 v[60:61], v224 offset:35904
  v_mfma_f32_32x32x16_bf16 v[176:191], v[116:119], v[28:31], v[176:191]
  ds_read_b64_tr_b16 v[62:63], v224 offset:36672
  ds_read_b64_tr_b16 v[68:69], v224 offset:41984
  ds_read_b64_tr_b16 v[70:71], v224 offset:42752
  v_mfma_f32_32x32x16_bf16 v[192:207], v[120:123], v[28:31], v[192:207]
  ds_read_b64_tr_b16 v[72:73], v224 offset:42048
  ds_read_b64_tr_b16 v[74:75], v224 offset:42816
  s_waitcnt vmcnt(10) lgkmcnt(0)
  s_barrier
  v_mfma_f32_32x32x16_bf16 v[128:143], v[32:35], v[16:19], v[128:143]
  ds_read_b128 v[24:27], v10 offset:0
  ds_read_b64_tr_b16 v[80:81], v224 offset:45056
  ds_read_b64_tr_b16 v[82:83], v224 offset:45824
  v_mfma_f32_32x32x16_bf16 v[144:159], v[36:39], v[16:19], v[144:159]
  s_add_u32 m0, s23, 32768
  s_nop 0
  buffer_load_dwordx4 v5, s[16:19], s21 offen lds
  buffer_load_dwordx4 v6, s[16:19], s21 offen offset:1024 lds
  buffer_load_dwordx4 v7, s[16:19], s21 offen offset:2048 lds
  s_add_u32 s21, s21, 88064
  v_mfma_f32_32x32x16_bf16 v[176:191], v[44:47], v[16:19], v[176:191]
  ds_read_b64_tr_b16 v[84:85], v224 offset:45120
  ds_read_b64_tr_b16 v[86:87], v224 offset:45888
  ds_read_b64_tr_b16 v[92:93], v225 offset:18432
  v_mfma_f32_32x32x16_bf16 v[192:207], v[48:51], v[16:19], v[192:207]
  ds_read_b64_tr_b16 v[94:95], v225 offset:19200
  ds_read_b64_tr_b16 v[96:97], v225 offset:18496
  v_mfma_f32_32x32x16_bf16 v[128:143], v[56:59], v[20:23], v[128:143]
  ds_read_b64_tr_b16 v[98:99], v225 offset:19264
  ds_read_b128 v[28:31], v11 offset:0
  ds_read_b64_tr_b16 v[104:105], v224 offset:48128
  v_mfma_f32_32x32x16_bf16 v[144:159], v[60:63], v[20:23], v[144:159]
  ds_read_b64_tr_b16 v[106:107], v224 offset:48896
  ds_read_b64_tr_b16 v[108:109], v224 offset:48192
  v_mfma_f32_32x32x16_bf16 v[176:191], v[68:71], v[20:23], v[176:191]
  ds_read_b64_tr_b16 v[110:111], v224 offset:48960
  ds_read_b64_tr_b16 v[116:117], v225 offset:21504
  ds_read_b64_tr_b16 v[118:119], v225 offset:22272
  v_mfma_f32_32x32x16_bf16 v[192:207], v[72:75], v[20:23], v[192:207]
  ds_read_b64_tr_b16 v[120:121], v225 offset:21568
  ds_read_b64_tr_b16 v[122:123], v225 offset:22336
  s_waitcnt vmcnt(3) lgkmcnt(0)
  s_barrier
  v_mfma_f32_32x32x16_bf16 v[128:143], v[80:83], v[24:27], v[128:143]
  ds_read_b128 v[16:19], v8 offset:16384
  ds_read_b64_tr_b16 v[32:33], v225 offset:24576
  ds_read_b64_tr_b16 v[34:35], v225 offset:25344
  v_mfma_f32_32x32x16_bf16 v[144:159], v[84:87], v[24:27], v[144:159]
  s_add_u32 m0, s23, 45056
  s_nop 0
  buffer_load_dwordx4 v5, s[16:19], s21 offen lds
  buffer_load_dwordx4 v6, s[16:19], s21 offen offset:1024 lds
  buffer_load_dwordx4 v7, s[16:19], s21 offen offset:2048 lds
  s_add_u32 s21, s21, 88064
  s_add_u32 m0, s22, 0
  s_nop 0
  buffer_load_dwordx4 v1, s[12:15], s20 offen lds
  buffer_load_dwordx4 v2, s[12:15], s20 offen offset:1024 lds
  buffer_load_dwordx4 v3, s[12:15], s20 offen offset:2048 lds
  buffer_load_dwordx4 v4, s[12:15], s20 offen offset:3072 lds
  s_add_u32 s20, s20, 128
  v_mfma_f32_32x32x16_bf16 v[176:191], v[92:95], v[24:27], v[176:191]
  ds_read_b64_tr_b16 v[36:37], v225 offset:24640
  ds_read_b64_tr_b16 v[38:39], v225 offset:25408
  ds_read_b64_tr_b16 v[44:45], v225 offset:30720
  v_mfma_f32_32x32x16_bf16 v[192:207], v[96:99], v[24:27], v[192:207]
  ds_read_b64_tr_b16 v[46:47], v225 offset:31488
  ds_read_b64_tr_b16 v[48:49], v225 offset:30784
  v_mfma_f32_32x32x16_bf16 v[128:143], v[104:107], v[28:31], v[128:143]
  ds_read_b64_tr_b16 v[50:51], v225 offset:31552
  ds_read_b128 v[20:23], v9 offset:16384
  ds_read_b64_tr_b16 v[56:57], v225 offset:27648
  v_mfma_f32_32x32x16_bf16 v[144:159], v[108:111], v[28:31], v[144:159]
  ds_read_b64_tr_b16 v[58:59], v225 offset:28416
  ds_read_b64_tr_b16 v[60:61], v225 offset:27712
  v_mfma_f32_32x32x16_bf16 v[176:191], v[116:119], v[28:31], v[176:191]
  ds_read_b64_tr_b16 v[62:63], v225 offset:28480
  ds_read_b64_tr_b16 v[68:69], v225 offset:33792
  ds_read_b64_tr_b16 v[70:71], v225 offset:34560
  v_mfma_f32_32x32x16_bf16 v[192:207], v[120:123], v[28:31], v[192:207]
  ds_read_b64_tr_b16 v[72:73], v225 offset:33856
  ds_read_b64_tr_b16 v[74:75], v225 offset:34624
  s_waitcnt vmcnt(10) lgkmcnt(0)
  s_barrier
  v_mfma_f32_32x32x16_bf16 v[128:143], v[32:35], v[16:19], v[128:143]
  ds_read_b128 v[24:27], v10 offset:16384
  ds_read_b64_tr_b16 v[80:81], v225 offset:36864
  ds_read_b64_tr_b16 v[82:83], v225 offset:37632
  v_mfma_f32_32x32x16_bf16 v[144:159], v[36:39], v[16:19], v[144:159]
  s_add_u32 m0, s23, 57344
  s_nop 0
  buffer_load_dwordx4 v5, s[16:19], s21 offen lds
  buffer_load_dwordx4 v6, s[16:19], s21 offen offset:1024 lds
  buffer_load_dwordx4 v7, s[16:19], s21 offen offset:2048 lds
  s_add_u32 s21, s21, 88064
  v_mfma_f32_32x32x16_bf16 v[176:191], v[44:47], v[16:19], v[176:191]
  ds_read_b64_tr_b16 v[84:85], v225 offset:36928
  ds_read_b64_tr_b16 v[86:87], v225 offset:37696
  ds_read_b64_tr_b16 v[92:93], v225 offset:43008
  v_mfma_f32_32x32x16_bf16 v[192:207], v[48:51], v[16:19], v[192:207]
  ds_read_b64_tr_b16 v[94:95], v225 offset:43776
  ds_read_b64_tr_b16 v[96:97], v225 offset:43072
  v_mfma_f32_32x32x16_bf16 v[128:143], v[56:59], v[20:23], v[128:143]
  ds_read_b64_tr_b16 v[98:99], v225 offset:43840
  ds_read_b128 v[28:31], v11 offset:16384
  ds_read_b64_tr_b16 v[104:105], v225 offset:39936
  v_mfma_f32_32x32x16_bf16 v[144:159], v[60:63], v[20:23], v[144:159]
  ds_read_b64_tr_b16 v[106:107], v225 offset:40704
  ds_read_b64_tr_b16 v[108:109], v225 offset:40000
  v_mfma_f32_32x32x16_bf16 v[176:191], v[68:71], v[20:23], v[176:191]
  ds_read_b64_tr_b16 v[110:111], v225 offset:40768
  ds_read_b64_tr_b16 v[116:117], v225 offset:46080
  ds_read_b64_tr_b16 v[118:119], v225 offset:46848
  v_mfma_f32_32x32x16_bf16 v[192:207], v[72:75], v[20:23], v[192:207]
  ds_read_b64_tr_b16 v[120:121], v225 offset:46144
  ds_read_b64_tr_b16 v[122:123], v225 offset:46912
  s_waitcnt vmcnt(3) lgkmcnt(0)
  s_barrier
  v_mfma_f32_32x32x16_bf16 v[128:143], v[80:83], v[24:27], v[128:143]
  ds_read_b128 v[16:19], v8 offset:0
  ds_read_b64_tr_b16 v[32:33], v224 offset:32768
  ds_read_b64_tr_b16 v[34:35], v224 offset:33536
  v_mfma_f32_32x32x16_bf16 v[144:159], v[84:87], v[24:27], v[144:159]
  s_add_u32 m0, s23, 69632
  s_nop 0
  buffer_load_dwordx4 v5, s[16:19], s21 offen lds
  buffer_load_dwordx4 v6, s[16:19], s21 offen offset:1024 lds
  buffer_load_dwordx4 v7, s[16:19], s21 offen offset:2048 lds
  s_add_u32 s21, s21, 88064
  s_add_u32 m0, s22, 16384
  s_nop 0
  buffer_load_dwordx4 v1, s[12:15], s20 offen lds
  buffer_load_dwordx4 v2, s[12:15], s20 offen offset:1024 lds
  buffer_load_dwordx4 v3, s[12:15], s20 offen offset:2048 lds
  buffer_load_dwordx4 v4, s[12:15], s20 offen offset:3072 lds
  s_add_u32 s20, s20, 128
  v_mfma_f32_32x32x16_bf16 v[176:191], v[92:95], v[24:27], v[176:191]
  ds_read_b64_tr_b16 v[36:37], v224 offset:32832
  ds_read_b64_tr_b16 v[38:39], v224 offset:33600
  ds_read_b64_tr_b16 v[44:45], v224 offset:38912
  v_mfma_f32_32x32x16_bf16 v[192:207], v[96:99], v[24:27], v[192:207]
  ds_read_b64_tr_b16 v[46:47], v224 offset:39680
  ds_read_b64_tr_b16 v[48:49], v224 offset:38976
  v_mfma_f32_32x32x16_bf16 v[128:143], v[104:107], v[28:31], v[128:143]
  ds_read_b64_tr_b16 v[50:51], v224 offset:39744
  ds_read_b128 v[20:23], v9 offset:0
  ds_read_b64_tr_b16 v[56:57], v224 offset:35840
  v_mfma_f32_32x32x16_bf16 v[144:159], v[108:111], v[28:31], v[144:159]
  ds_read_b64_tr_b16 v[58:59], v224 offset:36608
  ds_read_b64_tr_b16 v[60:61], v224 offset:35904
  v_mfma_f32_32x32x16_bf16 v[176:191], v[116:119], v[28:31], v[176:191]
  ds_read_b64_tr_b16 v[62:63], v224 offset:36672
  ds_read_b64_tr_b16 v[68:69], v224 offset:41984
  ds_read_b64_tr_b16 v[70:71], v224 offset:42752
  v_mfma_f32_32x32x16_bf16 v[192:207], v[120:123], v[28:31], v[192:207]
  ds_read_b64_tr_b16 v[72:73], v224 offset:42048
  ds_read_b64_tr_b16 v[74:75], v224 offset:42816
  s_waitcnt vmcnt(10) lgkmcnt(0)
  s_barrier
  v_mfma_f32_32x32x16_bf16 v[128:143], v[32:35], v[16:19], v[128:143]
  ds_read_b128 v[24:27], v10 offset:0
  ds_read_b64_tr_b16 v[80:81], v224 offset:45056
  ds_read_b64_tr_b16 v[82:83], v224 offset:45824
  v_mfma_f32_32x32x16_bf16 v[144:159], v[36:39], v[16:19], v[144:159]
  v_mfma_f32_32x32x16_bf16 v[176:191], v[44:47], v[16:19], v[176:191]
  ds_read_b64_tr_b16 v[84:85], v224 offset:45120
  ds_read_b64_tr_b16 v[86:87], v224 offset:45888
  ds_read_b64_tr_b16 v[92:93], v225 offset:18432
  v_mfma_f32_32x32x16_bf16 v[192:207], v[48:51], v[16:19], v[192:207]
  ds_read_b64_tr_b16 v[94:95], v225 offset:19200
  ds_read_b64_tr_b16 v[96:97], v225 offset:18496
  v_mfma_f32_32x32x16_bf16 v[128:143], v[56:59], v[20:23], v[128:143]
  ds_read_b64_tr_b16 v[98:99], v225 offset:19264
  ds_read_b128 v[28:31], v11 offset:0
  ds_read_b64_tr_b16 v[104:105], v224 offset:48128
  v_mfma_f32_32x32x16_bf16 v[144:159], v[60:63], v[20:23], v[144:159]
  ds_read_b64_tr_b16 v[106:107], v224 offset:48896
  ds_read_b64_tr_b16 v[108:109], v224 offset:48192
  v_mfma_f32_32x32x16_bf16 v[176:191], v[68:71], v[20:23], v[176:191]
  ds_read_b64_tr_b16 v[110:111], v224 offset:48960
  ds_read_b64_tr_b16 v[116:117], v225 offset:21504
  ds_read_b64_tr_b16 v[118:119], v225 offset:22272
  v_mfma_f32_32x32x16_bf16 v[192:207], v[72:75], v[20:23], v[192:207]
  ds_read_b64_tr_b16 v[120:121], v225 offset:21568
  ds_read_b64_tr_b16 v[122:123], v225 offset:22336
  s_waitcnt vmcnt(0) lgkmcnt(0)
  s_barrier
  v_mfma_f32_32x32x16_bf16 v[128:143], v[80:83], v[24:27], v[128:143]
  ds_read_b128 v[16:19], v8 offset:16384
  ds_read_b64_tr_b16 v[32:33], v225 offset:24576
  ds_read_b64_tr_b16 v[34:35], v225 offset:25344
  v_mfma_f32_32x32x16_bf16 v[144:159], v[84:87], v[24:27], v[144:159]
  v_mfma_f32_32x32x16_bf16 v[176:191], v[92:95], v[24:27], v[176:191]
  ds_read_b64_tr_b16 v[36:37], v225 offset:24640
  ds_read_b64_tr_b16 v[38:39], v225 offset:25408
  ds_read_b64_tr_b16 v[44:45], v225 offset:30720
  v_mfma_f32_32x32x16_bf16 v[192:207], v[96:99], v[24:27], v[192:207]
  ds_read_b64_tr_b16 v[46:47], v225 offset:31488
  ds_read_b64_tr_b16 v[48:49], v225 offset:30784
  v_mfma_f32_32x32x16_bf16 v[128:143], v[104:107], v[28:31], v[128:143]
  ds_read_b64_tr_b16 v[50:51], v225 offset:31552
  ds_read_b128 v[20:23], v9 offset:16384
  ds_read_b64_tr_b16 v[56:57], v225 offset:27648
  v_mfma_f32_32x32x16_bf16 v[144:159], v[108:111], v[28:31], v[144:159]
  ds_read_b64_tr_b16 v[58:59], v225 offset:28416
  ds_read_b64_tr_b16 v[60:61], v225 offset:27712
  v_mfma_f32_32x32x16_bf16 v[176:191], v[116:119], v[28:31], v[176:191]
  ds_read_b64_tr_b16 v[62:63], v225 offset:28480
  ds_read_b64_tr_b16 v[68:69], v225 offset:33792
  ds_read_b64_tr_b16 v[70:71], v225 offset:34560
  v_mfma_f32_32x32x16_bf16 v[192:207], v[120:123], v[28:31], v[192:207]
  ds_read_b64_tr_b16 v[72:73], v225 offset:33856
  ds_read_b64_tr_b16 v[74:75], v225 offset:34624
  s_waitcnt vmcnt(0) lgkmcnt(0)
  s_barrier
  v_mfma_f32_32x32x16_bf16 v[128:143], v[32:35], v[16:19], v[128:143]
  ds_read_b128 v[24:27], v10 offset:16384
  ds_read_b64_tr_b16 v[80:81], v225 offset:36864
  ds_read_b64_tr_b16 v[82:83], v225 offset:37632
  v_mfma_f32_32x32x16_bf16 v[144:159], v[36:39], v[16:19], v[144:159]
  v_mfma_f32_32x32x16_bf16 v[176:191], v[44:47], v[16:19], v[176:191]
  ds_read_b64_tr_b16 v[84:85], v225 offset:36928
  ds_read_b64_tr_b16 v[86:87], v225 offset:37696
  ds_read_b64_tr_b16 v[92:93], v225 offset:43008
  v_mfma_f32_32x32x16_bf16 v[192:207], v[48:51], v[16:19], v[192:207]
  ds_read_b64_tr_b16 v[94:95], v225 offset:43776
  ds_read_b64_tr_b16 v[96:97], v225 offset:43072
  v_mfma_f32_32x32x16_bf16 v[128:143], v[56:59], v[20:23], v[128:143]
  ds_read_b64_tr_b16 v[98:99], v225 offset:43840
  ds_read_b128 v[28:31], v11 offset:16384
  ds_read_b64_tr_b16 v[104:105], v225 offset:39936
  v_mfma_f32_32x32x16_bf16 v[144:159], v[60:63], v[20:23], v[144:159]
  ds_read_b64_tr_b16 v[106:107], v225 offset:40704
  ds_read_b64_tr_b16 v[108:109], v225 offset:40000
  v_mfma_f32_32x32x16_bf16 v[176:191], v[68:71], v[20:23], v[176:191]
  ds_read_b64_tr_b16 v[110:111], v225 offset:40768
  ds_read_b64_tr_b16 v[116:117], v225 offset:46080
  ds_read_b64_tr_b16 v[118:119], v225 offset:46848
  v_mfma_f32_32x32x16_bf16 v[192:207], v[72:75], v[20:23], v[192:207]
  ds_read_b64_tr_b16 v[120:121], v225 offset:46144
  ds_read_b64_tr_b16 v[122:123], v225 offset:46912
  s_waitcnt lgkmcnt(0)
  v_mfma_f32_32x32x16_bf16 v[128:143], v[80:83], v[24:27], v[128:143]
  v_mfma_f32_32x32x16_bf16 v[144:159], v[84:87], v[24:27], v[144:159]
  v_mfma_f32_32x32x16_bf16 v[176:191], v[92:95], v[24:27], v[176:191]
  v_mfma_f32_32x32x16_bf16 v[192:207], v[96:99], v[24:27], v[192:207]
  v_mfma_f32_32x32x16_bf16 v[128:143], v[104:107], v[28:31], v[128:143]
  v_mfma_f32_32x32x16_bf16 v[144:159], v[108:111], v[28:31], v[144:159]
  v_mfma_f32_32x32x16_bf16 v[176:191], v[116:119], v[28:31], v[176:191]
  v_mfma_f32_32x32x16_bf16 v[192:207], v[120:123], v[28:31], v[192:207]
g_loop_done:
  s_load_dwordx2 s[54:55], s[0:1], 48
  s_mul_i32 s58, s52, 1408
  v_lshlrev_b32 v241, 7, v0
  v_add_u32 v241, s58, v241
  v_cmp_gt_u32 vcc, 11, v0
  s_waitcnt lgkmcnt(0)
  s_mov_b32 s60, s54
  s_and_b32 s61, s55, 0xffff
  s_mov_b32 s62, 1409024
  s_mov_b32 s63, 0x20000
  s_and_saveexec_b64 s[56:57], vcc
  buffer_load_dword v246, v241, s[60:63], 0 offen
  s_mov_b64 exec, s[56:57]
  s_load_dwordx2 s[54:55], s[0:1], 16
  s_mul_i32 s58, s52, 512
  v_lshlrev_b32 v241, 7, v0
  v_add_u32 v241, s58, v241
  v_cmp_gt_u32 vcc, 4, v0
  s_waitcnt lgkmcnt(0)
  s_mov_b32 s60, s54
  s_and_b32 s61, s55, 0xffff
  s_mov_b32 s62, 524288
  s_mov_b32 s63, 0x20000
  s_and_saveexec_b64 s[56:57], vcc
  buffer_load_dword v247, v241, s[60:63], 0 offen
  s_mov_b64 exec, s[56:57]
  s_setprio 2
  s_nop 7
  s_nop 7
  s_mov_b32 s24, 3222493025
  s_mov_b32 s25, 3184710632
  s_mul_i32 s26, s9, 43
  s_add_u32 s26, s26, s38
  s_lshl_b32 s26, s26, 13
  s_lshl_b32 s27, s8, 11
  s_add_u32 s26, s26, s27
  s_add_u32 s26, s26, 6291456
  v_lshlrev_b32 v12, 4, v0
  v_add_u32 v12, s26, v12
  s_mov_b32 s28, 3184710632
  s_mov_b32 s29, 3184710632
  v_mov_b32 v40, s24
  v_mov_b32 v41, s24
  v_mov_b32 v42, 1.0
  v_mov_b32 v43, 1.0
  v_pk_mul_f32 v[32:33], v[128:129], v[128:129]
  v_pk_mul_f32 v[34:35], v[130:131], v[130:131]
  v_pk_mul_f32 v[36:37], v[132:133], v[132:133]
  v_pk_mul_f32 v[38:39], v[134:135], v[134:135]
  v_pk_fma_f32 v[32:33], v[32:33], s[28:29], v[40:41]
  v_pk_fma_f32 v[34:35], v[34:35], s[28:29], v[40:41]
  v_pk_fma_f32 v[36:37], v[36:37], s[28:29], v[40:41]
  v_pk_fma_f32 v[38:39], v[38:39], s[28:29], v[40:41]
  v_pk_mul_f32 v[32:33], v[32:33], v[128:129]
  v_pk_mul_f32 v[34:35], v[34:35], v[130:131]
  v_pk_mul_f32 v[36:37], v[36:37], v[132:133]
  v_pk_mul_f32 v[38:39], v[38:39], v[134:135]
  v_exp_f32 v32, v32
  v_exp_f32 v33, v33
  v_exp_f32 v34, v34
  v_exp_f32 v35, v35
  v_exp_f32 v36, v36
  v_exp_f32 v37, v37
  v_exp_f32 v38, v38
  v_exp_f32 v39, v39
  v_pk_mul_f32 v[176:177], v[176:177], v[128:129]
  v_pk_mul_f32 v[178:179], v[178:179], v[130:131]
  v_pk_mul_f32 v[180:181], v[180:181], v[132:133]
  v_pk_mul_f32 v[182:183], v[182:183], v[134:135]
  v_pk_add_f32 v[32:33], v[32:33], v[42:43]
  v_pk_add_f32 v[34:35], v[34:35], v[42:43]
  v_pk_add_f32 v[36:37], v[36:37], v[42:43]
  v_pk_add_f32 v[38:39], v[38:39], v[42:43]
  v_rcp_f32 v32, v32
  v_rcp_f32 v33, v33
  v_rcp_f32 v34, v34
  v_rcp_f32 v35, v35
  v_rcp_f32 v36, v36
  v_rcp_f32 v37, v37
  v_rcp_f32 v38, v38
  v_rcp_f32 v39, v39
  s_nop 0
  v_pk_mul_f32 v[176:177], v[176:177], v[32:33]
  v_pk_mul_f32 v[178:179], v[178:179], v[34:35]
  v_pk_mul_f32 v[180:181], v[180:181], v[36:37]
  v_pk_mul_f32 v[182:183], v[182:183], v[38:39]
  v_pk_mul_f32 v[32:33], v[136:137], v[136:137]
  v_pk_mul_f32 v[34:35], v[138:139], v[138:139]
  v_pk_mul_f32 v[36:37], v[140:141], v[140:141]
  v_pk_mul_f32 v[38:39], v[142:143], v[142:143]
  v_pk_fma_f32 v[32:33], v[32:33], s[28:29], v[40:41]
  v_pk_fma_f32 v[34:35], v[34:35], s[28:29], v[40:41]
  v_pk_fma_f32 v[36:37], v[36:37], s[28:29], v[40:41]
  v_pk_fma_f32 v[38:39], v[38:39], s[28:29], v[40:41]
  v_pk_mul_f32 v[32:33], v[32:33], v[136:137]
  v_pk_mul_f32 v[34:35], v[34:35], v[138:139]
  v_pk_mul_f32 v[36:37], v[36:37], v[140:141]
  v_pk_mul_f32 v[38:39], v[38:39], v[142:143]
  v_exp_f32 v32, v32
  v_exp_f32 v33, v33
  v_exp_f32 v34, v34
  v_exp_f32 v35, v35
  v_exp_f32 v36, v36
  v_exp_f32 v37, v37
  v_exp_f32 v38, v38
  v_exp_f32 v39, v39
  v_pk_mul_f32 v[184:185], v[184:185], v[136:137]
  v_pk_mul_f32 v[186:187], v[186:187], v[138:139]
  v_pk_mul_f32 v[188:189], v[188:189], v[140:141]
  v_pk_mul_f32 v[190:191], v[190:191], v[142:143]
  v_pk_add_f32 v[32:33], v[32:33], v[42:43]
  v_pk_add_f32 v[34:35], v[34:35], v[42:43]
  v_pk_add_f32 v[36:37], v[36:37], v[42:43]
  v_pk_add_f32 v[38:39], v[38:39], v[42:43]
  v_rcp_f32 v32, v32
  v_rcp_f32 v33, v33
  v_rcp_f32 v34, v34
  v_rcp_f32 v35, v35
  v_rcp_f32 v36, v36
  v_rcp_f32 v37, v37
  v_rcp_f32 v38, v38
  v_rcp_f32 v39, v39
  s_nop 0
  v_pk_mul_f32 v[184:185], v[184:185], v[32:33]
  v_pk_mul_f32 v[186:187], v[186:187], v[34:35]
  v_pk_mul_f32 v[188:189], v[188:189], v[36:37]
  v_pk_mul_f32 v[190:191], v[190:191], v[38:39]
  v_cvt_pk_bf16_f32 v128, v176, v177
  v_cvt_pk_bf16_f32 v129, v178, v179
  v_cvt_pk_bf16_f32 v130, v180, v181
  v_cvt_pk_bf16_f32 v131, v182, v183
  v_cvt_pk_bf16_f32 v132, v184, v185
  v_cvt_pk_bf16_f32 v133, v186, v187
  v_cvt_pk_bf16_f32 v134, v188, v189
  v_cvt_pk_bf16_f32 v135, v190, v191
  global_store_dwordx4 v12, v[128:131], s[4:5] sc1
  global_store_dwordx4 v12, v[132:135], s[4:5] offset:1024 sc1
  v_pk_mul_f32 v[32:33], v[144:145], v[144:145]
  v_pk_mul_f32 v[34:35], v[146:147], v[146:147]
  v_pk_mul_f32 v[36:37], v[148:149], v[148:149]
  v_pk_mul_f32 v[38:39], v[150:151], v[150:151]
  v_pk_fma_f32 v[32:33], v[32:33], s[28:29], v[40:41]
  v_pk_fma_f32 v[34:35], v[34:35], s[28:29], v[40:41]
  v_pk_fma_f32 v[36:37], v[36:37], s[28:29], v[40:41]
  v_pk_fma_f32 v[38:39], v[38:39], s[28:29], v[40:41]
  v_pk_mul_f32 v[32:33], v[32:33], v[144:145]
  v_pk_mul_f32 v[34:35], v[34:35], v[146:147]
  v_pk_mul_f32 v[36:37], v[36:37], v[148:149]
  v_pk_mul_f32 v[38:39], v[38:39], v[150:151]
  v_exp_f32 v32, v32
  v_exp_f32 v33, v33
  v_exp_f32 v34, v34
  v_exp_f32 v35, v35
  v_exp_f32 v36, v36
  v_exp_f32 v37, v37
  v_exp_f32 v38, v38
  v_exp_f32 v39, v39
  v_pk_mul_f32 v[192:193], v[192:193], v[144:145]
  v_pk_mul_f32 v[194:195], v[194:195], v[146:147]
  v_pk_mul_f32 v[196:197], v[196:197], v[148:149]
  v_pk_mul_f32 v[198:199], v[198:199], v[150:151]
  v_pk_add_f32 v[32:33], v[32:33], v[42:43]
  v_pk_add_f32 v[34:35], v[34:35], v[42:43]
  v_pk_add_f32 v[36:37], v[36:37], v[42:43]
  v_pk_add_f32 v[38:39], v[38:39], v[42:43]
  v_rcp_f32 v32, v32
  v_rcp_f32 v33, v33
  v_rcp_f32 v34, v34
  v_rcp_f32 v35, v35
  v_rcp_f32 v36, v36
  v_rcp_f32 v37, v37
  v_rcp_f32 v38, v38
  v_rcp_f32 v39, v39
  s_nop 0
  v_pk_mul_f32 v[192:193], v[192:193], v[32:33]
  v_pk_mul_f32 v[194:195], v[194:195], v[34:35]
  v_pk_mul_f32 v[196:197], v[196:197], v[36:37]
  v_pk_mul_f32 v[198:199], v[198:199], v[38:39]
  v_pk_mul_f32 v[32:33], v[152:153], v[152:153]
  v_pk_mul_f32 v[34:35], v[154:155], v[154:155]
  v_pk_mul_f32 v[36:37], v[156:157], v[156:157]
  v_pk_mul_f32 v[38:39], v[158:159], v[158:159]
  v_pk_fma_f32 v[32:33], v[32:33], s[28:29], v[40:41]
  v_pk_fma_f32 v[34:35], v[34:35], s[28:29], v[40:41]
  v_pk_fma_f32 v[36:37], v[36:37], s[28:29], v[40:41]
  v_pk_fma_f32 v[38:39], v[38:39], s[28:29], v[40:41]
  v_pk_mul_f32 v[32:33], v[32:33], v[152:153]
  v_pk_mul_f32 v[34:35], v[34:35], v[154:155]
  v_pk_mul_f32 v[36:37], v[36:37], v[156:157]
  v_pk_mul_f32 v[38:39], v[38:39], v[158:159]
  v_exp_f32 v32, v32
  v_exp_f32 v33, v33
  v_exp_f32 v34, v34
  v_exp_f32 v35, v35
  v_exp_f32 v36, v36
  v_exp_f32 v37, v37
  v_exp_f32 v38, v38
  v_exp_f32 v39, v39
  v_pk_mul_f32 v[200:201], v[200:201], v[152:153]
  v_pk_mul_f32 v[202:203], v[202:203], v[154:155]
  v_pk_mul_f32 v[204:205], v[204:205], v[156:157]
  v_pk_mul_f32 v[206:207], v[206:207], v[158:159]
  v_pk_add_f32 v[32:33], v[32:33], v[42:43]
  v_pk_add_f32 v[34:35], v[34:35], v[42:43]
  v_pk_add_f32 v[36:37], v[36:37], v[42:43]
  v_pk_add_f32 v[38:39], v[38:39], v[42:43]
  v_rcp_f32 v32, v32
  v_rcp_f32 v33, v33
  v_rcp_f32 v34, v34
  v_rcp_f32 v35, v35
  v_rcp_f32 v36, v36
  v_rcp_f32 v37, v37
  v_rcp_f32 v38, v38
  v_rcp_f32 v39, v39
  s_nop 0
  v_pk_mul_f32 v[200:201], v[200:201], v[32:33]
  v_pk_mul_f32 v[202:203], v[202:203], v[34:35]
  v_pk_mul_f32 v[204:205], v[204:205], v[36:37]
  v_pk_mul_f32 v[206:207], v[206:207], v[38:39]
  v_cvt_pk_bf16_f32 v144, v192, v193
  v_cvt_pk_bf16_f32 v145, v194, v195
  v_cvt_pk_bf16_f32 v146, v196, v197
  v_cvt_pk_bf16_f32 v147, v198, v199
  v_cvt_pk_bf16_f32 v148, v200, v201
  v_cvt_pk_bf16_f32 v149, v202, v203
  v_cvt_pk_bf16_f32 v150, v204, v205
  v_cvt_pk_bf16_f32 v151, v206, v207
  v_add_u32 v12, 8192, v12
  global_store_dwordx4 v12, v[144:147], s[4:5] sc1
  global_store_dwordx4 v12, v[148:151], s[4:5] offset:1024 sc1
  s_cmp_lt_u32 s11, 3
  s_cbranch_scc1 g_skip
  v_pk_mul_f32 v[32:33], v[160:161], v[160:161]
  v_pk_mul_f32 v[34:35], v[162:163], v[162:163]
  v_pk_mul_f32 v[36:37], v[164:165], v[164:165]
  v_pk_mul_f32 v[38:39], v[166:167], v[166:167]
  v_pk_fma_f32 v[32:33], v[32:33], s[28:29], v[40:41]
  v_pk_fma_f32 v[34:35], v[34:35], s[28:29], v[40:41]
  v_pk_fma_f32 v[36:37], v[36:37], s[28:29], v[40:41]
  v_pk_fma_f32 v[38:39], v[38:39], s[28:29], v[40:41]
  v_pk_mul_f32 v[32:33], v[32:33], v[160:161]
  v_pk_mul_f32 v[34:35], v[34:35], v[162:163]
  v_pk_mul_f32 v[36:37], v[36:37], v[164:165]
  v_pk_mul_f32 v[38:39], v[38:39], v[166:167]
  v_exp_f32 v32, v32
  v_exp_f32 v33, v33
  v_exp_f32 v34, v34
  v_exp_f32 v35, v35
  v_exp_f32 v36, v36
  v_exp_f32 v37, v37
  v_exp_f32 v38, v38
  v_exp_f32 v39, v39
  v_pk_mul_f32 v[208:209], v[208:209], v[160:161]
  v_pk_mul_f32 v[210:211], v[210:211], v[162:163]
  v_pk_mul_f32 v[212:213], v[212:213], v[164:165]
  v_pk_mul_f32 v[214:215], v[214:215], v[166:167]
  v_pk_add_f32 v[32:33], v[32:33], v[42:43]
  v_pk_add_f32 v[34:35], v[34:35], v[42:43]
  v_pk_add_f32 v[36:37], v[36:37], v[42:43]
  v_pk_add_f32 v[38:39], v[38:39], v[42:43]
  v_rcp_f32 v32, v32
  v_rcp_f32 v33, v33
  v_rcp_f32 v34, v34
  v_rcp_f32 v35, v35
  v_rcp_f32 v36, v36
  v_rcp_f32 v37, v37
  v_rcp_f32 v38, v38
  v_rcp_f32 v39, v39
  s_nop 0
  v_pk_mul_f32 v[208:209], v[208:209], v[32:33]
  v_pk_mul_f32 v[210:211], v[210:211], v[34:35]
  v_pk_mul_f32 v[212:213], v[212:213], v[36:37]
  v_pk_mul_f32 v[214:215], v[214:215], v[38:39]
  v_pk_mul_f32 v[32:33], v[168:169], v[168:169]
  v_pk_mul_f32 v[34:35], v[170:171], v[170:171]
  v_pk_mul_f32 v[36:37], v[172:173], v[172:173]
  v_pk_mul_f32 v[38:39], v[174:175], v[174:175]
  v_pk_fma_f32 v[32:33], v[32:33], s[28:29], v[40:41]
  v_pk_fma_f32 v[34:35], v[34:35], s[28:29], v[40:41]
  v_pk_fma_f32 v[36:37], v[36:37], s[28:29], v[40:41]
  v_pk_fma_f32 v[38:39], v[38:39], s[28:29], v[40:41]
  v_pk_mul_f32 v[32:33], v[32:33], v[168:169]
  v_pk_mul_f32 v[34:35], v[34:35], v[170:171]
  v_pk_mul_f32 v[36:37], v[36:37], v[172:173]
  v_pk_mul_f32 v[38:39], v[38:39], v[174:175]
  v_exp_f32 v32, v32
  v_exp_f32 v33, v33
  v_exp_f32 v34, v34
  v_exp_f32 v35, v35
  v_exp_f32 v36, v36
  v_exp_f32 v37, v37
  v_exp_f32 v38, v38
  v_exp_f32 v39, v39
  v_pk_mul_f32 v[216:217], v[216:217], v[168:169]
  v_pk_mul_f32 v[218:219], v[218:219], v[170:171]
  v_pk_mul_f32 v[220:221], v[220:221], v[172:173]
  v_pk_mul_f32 v[222:223], v[222:223], v[174:175]
  v_pk_add_f32 v[32:33], v[32:33], v[42:43]
  v_pk_add_f32 v[34:35], v[34:35], v[42:43]
  v_pk_add_f32 v[36:37], v[36:37], v[42:43]
  v_pk_add_f32 v[38:39], v[38:39], v[42:43]
  v_rcp_f32 v32, v32
  v_rcp_f32 v33, v33
  v_rcp_f32 v34, v34
  v_rcp_f32 v35, v35
  v_rcp_f32 v36, v36
  v_rcp_f32 v37, v37
  v_rcp_f32 v38, v38
  v_rcp_f32 v39, v39
  s_nop 0
  v_pk_mul_f32 v[216:217], v[216:217], v[32:33]
  v_pk_mul_f32 v[218:219], v[218:219], v[34:35]
  v_pk_mul_f32 v[220:221], v[220:221], v[36:37]
  v_pk_mul_f32 v[222:223], v[222:223], v[38:39]
  v_cvt_pk_bf16_f32 v160, v208, v209
  v_cvt_pk_bf16_f32 v161, v210, v211
  v_cvt_pk_bf16_f32 v162, v212, v213
  v_cvt_pk_bf16_f32 v163, v214, v215
  v_cvt_pk_bf16_f32 v164, v216, v217
  v_cvt_pk_bf16_f32 v165, v218, v219
  v_cvt_pk_bf16_f32 v166, v220, v221
  v_cvt_pk_bf16_f32 v167, v222, v223
  v_add_u32 v12, 8192, v12
  global_store_dwordx4 v12, v[160:163], s[4:5] sc1
  global_store_dwordx4 v12, v[164:167], s[4:5] offset:1024 sc1
g_skip:
  s_setprio 0
  s_lshl_b32 s50, s9, 2
  s_waitcnt vmcnt(0)
  s_barrier
  s_cmp_lg_u32 s8, 0
  s_cbranch_scc1 sig_7
  v_add_u32 v12, s50, v0
  v_lshlrev_b32 v12, 8, v12
  v_add_u32 v12, 18972672, v12
  v_mov_b32 v13, 1
  s_mov_b64 exec, 15
  global_atomic_add v12, v13, s[4:5] sc1
  s_mov_b64 exec, -1
sig_7:
  s_load_dwordx2 s[32:33], s[0:1], 48
  s_and_b32 s9, s3, 3
  s_lshl_b32 s9, s9, 3
  s_bfe_u32 s24, s3, 0x30003
  s_add_u32 s9, s9, s24
  s_bfe_u32 s10, s3, 0x10002
  s_lshl_b32 s10, s10, 2
  s_lshr_b32 s24, s3, 6
  s_add_u32 s10, s10, s24
  v_lshlrev_b32 v1, 4, v0
  v_lshrrev_b32 v12, 2, v0
  v_lshlrev_b32 v12, 10, v12
  v_and_b32 v13, 3, v0
  v_lshlrev_b32 v13, 4, v13
  s_lshl_b32 s24, s10, 7
  v_add3_u32 v12, v12, v13, s24
  v_add_u32 v2, 4096, v12
  v_add_u32 v3, 3136, v12
  v_add_u32 v4, 18432, v12
  v_add_u32 v5, 17472, v12
  s_mul_i32 s23, s8, 20480
  v_lshrrev_b32 v12, 5, v0
  v_lshlrev_b32 v12, 2, v12
  v_bfe_u32 v13, v0, 2, 2
  v_add_u32 v12, v12, v13
  v_lshlrev_b32 v12, 6, v12
  v_bfe_u32 v13, v0, 4, 1
  v_lshlrev_b32 v13, 5, v13
  v_and_b32 v14, 3, v0
  v_lshlrev_b32 v14, 3, v14
  v_add3_u32 v12, v12, v13, v14
  v_add_u32 v6, s23, v12
  s_waitcnt lgkmcnt(0)
  s_lshr_b32 s24, s9, 1
  s_mul_i32 s24, s24, 352256
  s_add_u32 s24, s24, 6291456
  s_add_u32 s12, s4, s24
  s_addc_u32 s13, s5, 0
  s_and_b32 s13, s13, 0xffff
  s_mov_b32 s14, 352256
  s_mov_b32 s15, 0x20000
  s_mul_i32 s20, s8, 90112
  s_and_b32 s24, s9, 1
  s_lshl_b32 s24, s24, 12
  s_add_u32 s20, s20, s24
  s_sub_u32 s16, s32, 4096
  s_subb_u32 s17, s33, 0
  s_and_b32 s17, s17, 0xffff
  s_mov_b32 s18, 1413120
  s_mov_b32 s19, 0x20000
  s_mul_i32 s21, s8, 360448
  s_add_u32 m0, s23, 0
  s_nop 0
  buffer_load_dwordx4 v2, s[16:19], s21 offen lds
  buffer_load_dwordx4 v3, s[16:19], s21 offen offset:1024 lds
  buffer_load_dwordx4 v4, s[16:19], s21 offen offset:2048 lds
  buffer_load_dwordx4 v5, s[16:19], s21 offen offset:3072 lds
  s_add_u32 s21, s21, 32768
  s_add_u32 m0, s23, 4096
  s_nop 0
  buffer_load_dwordx4 v2, s[16:19], s21 offen lds
  buffer_load_dwordx4 v3, s[16:19], s21 offen offset:1024 lds
  buffer_load_dwordx4 v4, s[16:19], s21 offen offset:2048 lds
  buffer_load_dwordx4 v5, s[16:19], s21 offen offset:3072 lds
  s_add_u32 s21, s21, 32768
  s_add_u32 m0, s23, 8192
  s_nop 0
  buffer_load_dwordx4 v2, s[16:19], s21 offen lds
  buffer_load_dwordx4 v3, s[16:19], s21 offen offset:1024 lds
  buffer_load_dwordx4 v4, s[16:19], s21 offen offset:2048 lds
  buffer_load_dwordx4 v5, s[16:19], s21 offen offset:3072 lds
  s_add_u32 s21, s21, 32768
  s_add_u32 m0, s23, 12288
  s_nop 0
  buffer_load_dwordx4 v2, s[16:19], s21 offen lds
  buffer_load_dwordx4 v3, s[16:19], s21 offen offset:1024 lds
  buffer_load_dwordx4 v4, s[16:19], s21 offen offset:2048 lds
  buffer_load_dwordx4 v5, s[16:19], s21 offen offset:3072 lds
  s_add_u32 s21, s21, 32768
  s_add_u32 m0, s23, 16384
  s_nop 0
  buffer_load_dwordx4 v2, s[16:19], s21 offen lds
  buffer_load_dwordx4 v3, s[16:19], s21 offen offset:1024 lds
  buffer_load_dwordx4 v4, s[16:19], s21 offen offset:2048 lds
  buffer_load_dwordx4 v5, s[16:19], s21 offen offset:3072 lds
  s_add_u32 s21, s21, 32768
  v_mov_b32 v96, 0
  v_mov_b32 v97, 0
  v_mov_b32 v98, 0
  v_mov_b32 v99, 0
  v_mov_b32 v100, 0
  v_mov_b32 v101, 0
  v_mov_b32 v102, 0
  v_mov_b32 v103, 0
  v_mov_b32 v104, 0
  v_mov_b32 v105, 0
  v_mov_b32 v106, 0
  v_mov_b32 v107, 0
  v_mov_b32 v108, 0
  v_mov_b32 v109, 0
  v_mov_b32 v110, 0
  v_mov_b32 v111, 0
  v_mov_b32 v112, 0
  v_mov_b32 v113, 0
  v_mov_b32 v114, 0
  v_mov_b32 v115, 0
  v_mov_b32 v116, 0
  v_mov_b32 v117, 0
  v_mov_b32 v118, 0
  v_mov_b32 v119, 0
  v_mov_b32 v120, 0
  v_mov_b32 v121, 0
  v_mov_b32 v122, 0
  v_mov_b32 v123, 0
  v_mov_b32 v124, 0
  v_mov_b32 v125, 0
  v_mov_b32 v126, 0
  v_mov_b32 v127, 0
  v_mov_b32 v128, 0
  v_mov_b32 v129, 0
  v_mov_b32 v130, 0
  v_mov_b32 v131, 0
  v_mov_b32 v132, 0
  v_mov_b32 v133, 0
  v_mov_b32 v134, 0
  v_mov_b32 v135, 0
  v_mov_b32 v136, 0
  v_mov_b32 v137, 0
  v_mov_b32 v138, 0
  v_mov_b32 v139, 0
  v_mov_b32 v140, 0
  v_mov_b32 v141, 0
  v_mov_b32 v142, 0
  v_mov_b32 v143, 0
  v_mov_b32 v144, 0
  v_mov_b32 v145, 0
  v_mov_b32 v146, 0
  v_mov_b32 v147, 0
  v_mov_b32 v148, 0
  v_mov_b32 v149, 0
  v_mov_b32 v150, 0
  v_mov_b32 v151, 0
  v_mov_b32 v152, 0
  v_mov_b32 v153, 0
  v_mov_b32 v154, 0
  v_mov_b32 v155, 0
  v_mov_b32 v156, 0
  v_mov_b32 v157, 0
  v_mov_b32 v158, 0
  v_mov_b32 v159, 0
  s_lshr_b32 s50, s9, 1
  s_lshl_b32 s50, s50, 2
  s_and_b32 s51, s10, 3
  s_add_u32 s50, s50, s51
  s_cmp_lg_u32 s8, 0
  s_cbranch_scc1 wt_8_done
  v_mov_b32 v12, s50
  v_lshlrev_b32 v12, 8, v12
  v_add_u32 v12, 18972672, v12
  s_mov_b32 s25, 100000
  s_mov_b64 exec, 1
wt_8_poll:
  global_load_dword v13, v12, s[4:5] sc1
  s_waitcnt vmcnt(0)
  v_readfirstlane_b32 s24, v13
  s_sub_u32 s25, s25, 1
  s_cmp_eq_u32 s25, 0
  s_cbranch_scc1 wt_8_out
  s_cmp_ge_u32 s24, 16
  s_cbranch_scc1 wt_8_out
  s_sleep 4
  s_branch wt_8_poll
wt_8_out:
  s_mov_b64 exec, -1
wt_8_done:
  s_barrier
  buffer_load_dwordx4 v[16:19], v1, s[12:15], s20 offen sc1
  buffer_load_dwordx4 v[20:23], v1, s[12:15], s20 offen offset:1024 sc1
  buffer_load_dwordx4 v[24:27], v1, s[12:15], s20 offen offset:2048 sc1
  buffer_load_dwordx4 v[28:31], v1, s[12:15], s20 offen offset:3072 sc1
  s_add_u32 s20, s20, 8192
  buffer_load_dwordx4 v[32:35], v1, s[12:15], s20 offen sc1
  buffer_load_dwordx4 v[36:39], v1, s[12:15], s20 offen offset:1024 sc1
  buffer_load_dwordx4 v[40:43], v1, s[12:15], s20 offen offset:2048 sc1
  buffer_load_dwordx4 v[44:47], v1, s[12:15], s20 offen offset:3072 sc1
  s_add_u32 s20, s20, 8192
  buffer_load_dwordx4 v[48:51], v1, s[12:15], s20 offen sc1
  buffer_load_dwordx4 v[52:55], v1, s[12:15], s20 offen offset:1024 sc1
  buffer_load_dwordx4 v[56:59], v1, s[12:15], s20 offen offset:2048 sc1
  buffer_load_dwordx4 v[60:63], v1, s[12:15], s20 offen offset:3072 sc1
  s_add_u32 s20, s20, 8192
  buffer_load_dwordx4 v[64:67], v1, s[12:15], s20 offen sc1
  buffer_load_dwordx4 v[68:71], v1, s[12:15], s20 offen offset:1024 sc1
  buffer_load_dwordx4 v[72:75], v1, s[12:15], s20 offen offset:2048 sc1
  buffer_load_dwordx4 v[76:79], v1, s[12:15], s20 offen offset:3072 sc1
  s_add_u32 s20, s20, 8192
  buffer_load_dwordx4 v[80:83], v1, s[12:15], s20 offen sc1
  buffer_load_dwordx4 v[84:87], v1, s[12:15], s20 offen offset:1024 sc1
  buffer_load_dwordx4 v[88:91], v1, s[12:15], s20 offen offset:2048 sc1
  buffer_load_dwordx4 v[92:95], v1, s[12:15], s20 offen offset:3072 sc1
  s_add_u32 s20, s20, 8192
  s_waitcnt vmcnt(16)
  ds_read_b64_tr_b16 v[160:161], v6 offset:0
  ds_read_b64_tr_b16 v[162:163], v6 offset:512
  ds_read_b64_tr_b16 v[164:165], v6 offset:1024
  ds_read_b64_tr_b16 v[166:167], v6 offset:1536
  ds_read_b64_tr_b16 v[168:169], v6 offset:2048
  ds_read_b64_tr_b16 v[170:171], v6 offset:2560
  ds_read_b64_tr_b16 v[172:173], v6 offset:3072
  ds_read_b64_tr_b16 v[174:175], v6 offset:3584
  s_waitcnt vmcnt(12) lgkmcnt(0)
  v_mfma_f32_32x32x16_bf16 v[96:111], v[160:163], v[16:19], v[96:111]
  ds_read_b64_tr_b16 v[176:177], v6 offset:4096
  v_mfma_f32_32x32x16_bf16 v[112:127], v[164:167], v[16:19], v[112:127]
  ds_read_b64_tr_b16 v[178:179], v6 offset:4608
  v_mfma_f32_32x32x16_bf16 v[128:143], v[160:163], v[24:27], v[128:143]
  ds_read_b64_tr_b16 v[180:181], v6 offset:5120
  v_mfma_f32_32x32x16_bf16 v[144:159], v[164:167], v[24:27], v[144:159]
  ds_read_b64_tr_b16 v[182:183], v6 offset:5632
  v_mfma_f32_32x32x16_bf16 v[96:111], v[168:171], v[20:23], v[96:111]
  ds_read_b64_tr_b16 v[184:185], v6 offset:6144
  v_mfma_f32_32x32x16_bf16 v[112:127], v[172:175], v[20:23], v[112:127]
  ds_read_b64_tr_b16 v[186:187], v6 offset:6656
  v_mfma_f32_32x32x16_bf16 v[128:143], v[168:171], v[28:31], v[128:143]
  ds_read_b64_tr_b16 v[188:189], v6 offset:7168
  v_mfma_f32_32x32x16_bf16 v[144:159], v[172:175], v[28:31], v[144:159]
  ds_read_b64_tr_b16 v[190:191], v6 offset:7680
  s_add_u32 m0, s23, 0
  s_nop 0
  buffer_load_dwordx4 v2, s[16:19], s21 offen lds
  buffer_load_dwordx4 v3, s[16:19], s21 offen offset:1024 lds
  buffer_load_dwordx4 v4, s[16:19], s21 offen offset:2048 lds
  buffer_load_dwordx4 v5, s[16:19], s21 offen offset:3072 lds
  s_add_u32 s21, s21, 32768
  buffer_load_dwordx4 v[16:19], v1, s[12:15], s20 offen sc1
  buffer_load_dwordx4 v[20:23], v1, s[12:15], s20 offen offset:1024 sc1
  buffer_load_dwordx4 v[24:27], v1, s[12:15], s20 offen offset:2048 sc1
  buffer_load_dwordx4 v[28:31], v1, s[12:15], s20 offen offset:3072 sc1
  s_add_u32 s20, s20, 8192
  s_waitcnt vmcnt(16) lgkmcnt(0)
  v_mfma_f32_32x32x16_bf16 v[96:111], v[176:179], v[32:35], v[96:111]
  ds_read_b64_tr_b16 v[160:161], v6 offset:8192
  v_mfma_f32_32x32x16_bf16 v[112:127], v[180:183], v[32:35], v[112:127]
  ds_read_b64_tr_b16 v[162:163], v6 offset:8704
  v_mfma_f32_32x32x16_bf16 v[128:143], v[176:179], v[40:43], v[128:143]
  ds_read_b64_tr_b16 v[164:165], v6 offset:9216
  v_mfma_f32_32x32x16_bf16 v[144:159], v[180:183], v[40:43], v[144:159]
  ds_read_b64_tr_b16 v[166:167], v6 offset:9728
  v_mfma_f32_32x32x16_bf16 v[96:111], v[184:187], v[36:39], v[96:111]
  ds_read_b64_tr_b16 v[168:169], v6 offset:10240
  v_mfma_f32_32x32x16_bf16 v[112:127], v[188:191], v[36:39], v[112:127]
  ds_read_b64_tr_b16 v[170:171], v6 offset:10752
  v_mfma_f32_32x32x16_bf16 v[128:143], v[184:187], v[44:47], v[128:143]
  ds_read_b64_tr_b16 v[172:173], v6 offset:11264
  v_mfma_f32_32x32x16_bf16 v[144:159], v[188:191], v[44:47], v[144:159]
  ds_read_b64_tr_b16 v[174:175], v6 offset:11776
  s_add_u32 m0, s23, 4096
  s_nop 0
  buffer_load_dwordx4 v2, s[16:19], s21 offen lds
  buffer_load_dwordx4 v3, s[16:19], s21 offen offset:1024 lds
  buffer_load_dwordx4 v4, s[16:19], s21 offen offset:2048 lds
  buffer_load_dwordx4 v5, s[16:19], s21 offen offset:3072 lds
  s_add_u32 s21, s21, 32768
  buffer_load_dwordx4 v[32:35], v1, s[12:15], s20 offen sc1
  buffer_load_dwordx4 v[36:39], v1, s[12:15], s20 offen offset:1024 sc1
  buffer_load_dwordx4 v[40:43], v1, s[12:15], s20 offen offset:2048 sc1
  buffer_load_dwordx4 v[44:47], v1, s[12:15], s20 offen offset:3072 sc1
  s_add_u32 s20, s20, 8192
  s_waitcnt vmcnt(20) lgkmcnt(0)
  v_mfma_f32_32x32x16_bf16 v[96:111], v[160:163], v[48:51], v[96:111]
  ds_read_b64_tr_b16 v[176:177], v6 offset:12288
  v_mfma_f32_32x32x16_bf16 v[112:127], v[164:167], v[48:51], v[112:127]
  ds_read_b64_tr_b16 v[178:179], v6 offset:12800
  v_mfma_f32_32x32x16_bf16 v[128:143], v[160:163], v[56:59], v[128:143]
  ds_read_b64_tr_b16 v[180:181], v6 offset:13312
  v_mfma_f32_32x32x16_bf16 v[144:159], v[164:167], v[56:59], v[144:159]
  ds_read_b64_tr_b16 v[182:183], v6 offset:13824
  v_mfma_f32_32x32x16_bf16 v[96:111], v[168:171], v[52:55], v[96:111]
  ds_read_b64_tr_b16 v[184:185], v6 offset:14336
  v_mfma_f32_32x32x16_bf16 v[112:127], v[172:175], v[52:55], v[112:127]
  ds_read_b64_tr_b16 v[186:187], v6 offset:14848
  v_mfma_f32_32x32x16_bf16 v[128:143], v[168:171], v[60:63], v[128:143]
  ds_read_b64_tr_b16 v[188:189], v6 offset:15360
  v_mfma_f32_32x32x16_bf16 v[144:159], v[172:175], v[60:63], v[144:159]
  ds_read_b64_tr_b16 v[190:191], v6 offset:15872
  s_add_u32 m0, s23, 8192
  s_nop 0
  buffer_load_dwordx4 v2, s[16:19], s21 offen lds
  buffer_load_dwordx4 v3, s[16:19], s21 offen offset:1024 lds
  buffer_load_dwordx4 v4, s[16:19], s21 offen offset:2048 lds
  buffer_load_dwordx4 v5, s[16:19], s21 offen offset:3072 lds
  s_add_u32 s21, s21, 32768
  buffer_load_dwordx4 v[48:51], v1, s[12:15], s20 offen sc1
  buffer_load_dwordx4 v[52:55], v1, s[12:15], s20 offen offset:1024 sc1
  buffer_load_dwordx4 v[56:59], v1, s[12:15], s20 offen offset:2048 sc1
  buffer_load_dwordx4 v[60:63], v1, s[12:15], s20 offen offset:3072 sc1
  s_add_u32 s20, s20, 8192
  s_waitcnt vmcnt(24) lgkmcnt(0)
  v_mfma_f32_32x32x16_bf16 v[96:111], v[176:179], v[64:67], v[96:111]
  ds_read_b64_tr_b16 v[160:161], v6 offset:16384
  v_mfma_f32_32x32x16_bf16 v[112:127], v[180:183], v[64:67], v[112:127]
  ds_read_b64_tr_b16 v[162:163], v6 offset:16896
  v_mfma_f32_32x32x16_bf16 v[128:143], v[176:179], v[72:75], v[128:143]
  ds_read_b64_tr_b16 v[164:165], v6 offset:17408
  v_mfma_f32_32x32x16_bf16 v[144:159], v[180:183], v[72:75], v[144:159]
  ds_read_b64_tr_b16 v[166:167], v6 offset:17920
  v_mfma_f32_32x32x16_bf16 v[96:111], v[184:187], v[68:71], v[96:111]
  ds_read_b64_tr_b16 v[168:169], v6 offset:18432
  v_mfma_f32_32x32x16_bf16 v[112:127], v[188:191], v[68:71], v[112:127]
  ds_read_b64_tr_b16 v[170:171], v6 offset:18944
  v_mfma_f32_32x32x16_bf16 v[128:143], v[184:187], v[76:79], v[128:143]
  ds_read_b64_tr_b16 v[172:173], v6 offset:19456
  v_mfma_f32_32x32x16_bf16 v[144:159], v[188:191], v[76:79], v[144:159]
  ds_read_b64_tr_b16 v[174:175], v6 offset:19968
  s_add_u32 m0, s23, 12288
  s_nop 0
  buffer_load_dwordx4 v2, s[16:19], s21 offen lds
  buffer_load_dwordx4 v3, s[16:19], s21 offen offset:1024 lds
  buffer_load_dwordx4 v4, s[16:19], s21 offen offset:2048 lds
  buffer_load_dwordx4 v5, s[16:19], s21 offen offset:3072 lds
  s_add_u32 s21, s21, 32768
  buffer_load_dwordx4 v[64:67], v1, s[12:15], s20 offen sc1
  buffer_load_dwordx4 v[68:71], v1, s[12:15], s20 offen offset:1024 sc1
  buffer_load_dwordx4 v[72:75], v1, s[12:15], s20 offen offset:2048 sc1
  buffer_load_dwordx4 v[76:79], v1, s[12:15], s20 offen offset:3072 sc1
  s_add_u32 s20, s20, 8192
  s_waitcnt vmcnt(24) lgkmcnt(0)
  v_mfma_f32_32x32x16_bf16 v[96:111], v[160:163], v[80:83], v[96:111]
  ds_read_b64_tr_b16 v[176:177], v6 offset:0
  v_mfma_f32_32x32x16_bf16 v[112:127], v[164:167], v[80:83], v[112:127]
  ds_read_b64_tr_b16 v[178:179], v6 offset:512
  v_mfma_f32_32x32x16_bf16 v[128:143], v[160:163], v[88:91], v[128:143]
  ds_read_b64_tr_b16 v[180:181], v6 offset:1024
  v_mfma_f32_32x32x16_bf16 v[144:159], v[164:167], v[88:91], v[144:159]
  ds_read_b64_tr_b16 v[182:183], v6 offset:1536
  v_mfma_f32_32x32x16_bf16 v[96:111], v[168:171], v[84:87], v[96:111]
  ds_read_b64_tr_b16 v[184:185], v6 offset:2048
  v_mfma_f32_32x32x16_bf16 v[112:127], v[172:175], v[84:87], v[112:127]
  ds_read_b64_tr_b16 v[186:187], v6 offset:2560
  v_mfma_f32_32x32x16_bf16 v[128:143], v[168:171], v[92:95], v[128:143]
  ds_read_b64_tr_b16 v[188:189], v6 offset:3072
  v_mfma_f32_32x32x16_bf16 v[144:159], v[172:175], v[92:95], v[144:159]
  ds_read_b64_tr_b16 v[190:191], v6 offset:3584
  s_add_u32 m0, s23, 16384
  s_nop 0
  buffer_load_dwordx4 v2, s[16:19], s21 offen lds
  buffer_load_dwordx4 v3, s[16:19], s21 offen offset:1024 lds
  buffer_load_dwordx4 v4, s[16:19], s21 offen offset:2048 lds
  buffer_load_dwordx4 v5, s[16:19], s21 offen offset:3072 lds
  s_add_u32 s21, s21, 32768
  buffer_load_dwordx4 v[80:83], v1, s[12:15], s20 offen sc1
  buffer_load_dwordx4 v[84:87], v1, s[12:15], s20 offen offset:1024 sc1
  buffer_load_dwordx4 v[88:91], v1, s[12:15], s20 offen offset:2048 sc1
  buffer_load_dwordx4 v[92:95], v1, s[12:15], s20 offen offset:3072 sc1
  s_add_u32 s20, s20, 8192
  s_waitcnt vmcnt(24) lgkmcnt(0)
  v_mfma_f32_32x32x16_bf16 v[96:111], v[176:179], v[16:19], v[96:111]
  ds_read_b64_tr_b16 v[160:161], v6 offset:4096
  v_mfma_f32_32x32x16_bf16 v[112:127], v[180:183], v[16:19], v[112:127]
  ds_read_b64_tr_b16 v[162:163], v6 offset:4608
  v_mfma_f32_32x32x16_bf16 v[128:143], v[176:179], v[24:27], v[128:143]
  ds_read_b64_tr_b16 v[164:165], v6 offset:5120
  v_mfma_f32_32x32x16_bf16 v[144:159], v[180:183], v[24:27], v[144:159]
  ds_read_b64_tr_b16 v[166:167], v6 offset:5632
  v_mfma_f32_32x32x16_bf16 v[96:111], v[184:187], v[20:23], v[96:111]
  ds_read_b64_tr_b16 v[168:169], v6 offset:6144
  v_mfma_f32_32x32x16_bf16 v[112:127], v[188:191], v[20:23], v[112:127]
  ds_read_b64_tr_b16 v[170:171], v6 offset:6656
  v_mfma_f32_32x32x16_bf16 v[128:143], v[184:187], v[28:31], v[128:143]
  ds_read_b64_tr_b16 v[172:173], v6 offset:7168
  v_mfma_f32_32x32x16_bf16 v[144:159], v[188:191], v[28:31], v[144:159]
  ds_read_b64_tr_b16 v[174:175], v6 offset:7680
  s_add_u32 m0, s23, 0
  s_nop 0
  buffer_load_dwordx4 v2, s[16:19], s21 offen lds
  buffer_load_dwordx4 v3, s[16:19], s21 offen offset:1024 lds
  buffer_load_dwordx4 v4, s[16:19], s21 offen offset:2048 lds
  buffer_load_dwordx4 v5, s[16:19], s21 offen offset:3072 lds
  s_add_u32 s21, s21, 32768
  buffer_load_dwordx4 v[16:19], v1, s[12:15], s20 offen sc1
  buffer_load_dwordx4 v[20:23], v1, s[12:15], s20 offen offset:1024 sc1
  buffer_load_dwordx4 v[24:27], v1, s[12:15], s20 offen offset:2048 sc1
  buffer_load_dwordx4 v[28:31], v1, s[12:15], s20 offen offset:3072 sc1
  s_add_u32 s20, s20, 8192
  s_waitcnt vmcnt(24) lgkmcnt(0)
  v_mfma_f32_32x32x16_bf16 v[96:111], v[160:163], v[32:35], v[96:111]
  ds_read_b64_tr_b16 v[176:177], v6 offset:8192
  v_mfma_f32_32x32x16_bf16 v[112:127], v[164:167], v[32:35], v[112:127]
  ds_read_b64_tr_b16 v[178:179], v6 offset:8704
  v_mfma_f32_32x32x16_bf16 v[128:143], v[160:163], v[40:43], v[128:143]
  ds_read_b64_tr_b16 v[180:181], v6 offset:9216
  v_mfma_f32_32x32x16_bf16 v[144:159], v[164:167], v[40:43], v[144:159]
  ds_read_b64_tr_b16 v[182:183], v6 offset:9728
  v_mfma_f32_32x32x16_bf16 v[96:111], v[168:171], v[36:39], v[96:111]
  ds_read_b64_tr_b16 v[184:185], v6 offset:10240
  v_mfma_f32_32x32x16_bf16 v[112:127], v[172:175], v[36:39], v[112:127]
  ds_read_b64_tr_b16 v[186:187], v6 offset:10752
  v_mfma_f32_32x32x16_bf16 v[128:143], v[168:171], v[44:47], v[128:143]
  ds_read_b64_tr_b16 v[188:189], v6 offset:11264
  v_mfma_f32_32x32x16_bf16 v[144:159], v[172:175], v[44:47], v[144:159]
  ds_read_b64_tr_b16 v[190:191], v6 offset:11776
  s_waitcnt vmcnt(16) lgkmcnt(0)
  v_mfma_f32_32x32x16_bf16 v[96:111], v[176:179], v[48:51], v[96:111]
  ds_read_b64_tr_b16 v[160:161], v6 offset:12288
  v_mfma_f32_32x32x16_bf16 v[112:127], v[180:183], v[48:51], v[112:127]
  ds_read_b64_tr_b16 v[162:163], v6 offset:12800
  v_mfma_f32_32x32x16_bf16 v[128:143], v[176:179], v[56:59], v[128:143]
  ds_read_b64_tr_b16 v[164:165], v6 offset:13312
  v_mfma_f32_32x32x16_bf16 v[144:159], v[180:183], v[56:59], v[144:159]
  ds_read_b64_tr_b16 v[166:167], v6 offset:13824
  v_mfma_f32_32x32x16_bf16 v[96:111], v[184:187], v[52:55], v[96:111]
  ds_read_b64_tr_b16 v[168:169], v6 offset:14336
  v_mfma_f32_32x32x16_bf16 v[112:127], v[188:191], v[52:55], v[112:127]
  ds_read_b64_tr_b16 v[170:171], v6 offset:14848
  v_mfma_f32_32x32x16_bf16 v[128:143], v[184:187], v[60:63], v[128:143]
  ds_read_b64_tr_b16 v[172:173], v6 offset:15360
  v_mfma_f32_32x32x16_bf16 v[144:159], v[188:191], v[60:63], v[144:159]
  ds_read_b64_tr_b16 v[174:175], v6 offset:15872
  s_waitcnt vmcnt(8) lgkmcnt(0)
  v_mfma_f32_32x32x16_bf16 v[96:111], v[160:163], v[64:67], v[96:111]
  ds_read_b64_tr_b16 v[176:177], v6 offset:16384
  v_mfma_f32_32x32x16_bf16 v[112:127], v[164:167], v[64:67], v[112:127]
  ds_read_b64_tr_b16 v[178:179], v6 offset:16896
  v_mfma_f32_32x32x16_bf16 v[128:143], v[160:163], v[72:75], v[128:143]
  ds_read_b64_tr_b16 v[180:181], v6 offset:17408
  v_mfma_f32_32x32x16_bf16 v[144:159], v[164:167], v[72:75], v[144:159]
  ds_read_b64_tr_b16 v[182:183], v6 offset:17920
  v_mfma_f32_32x32x16_bf16 v[96:111], v[168:171], v[68:71], v[96:111]
  ds_read_b64_tr_b16 v[184:185], v6 offset:18432
  v_mfma_f32_32x32x16_bf16 v[112:127], v[172:175], v[68:71], v[112:127]
  ds_read_b64_tr_b16 v[186:187], v6 offset:18944
  v_mfma_f32_32x32x16_bf16 v[128:143], v[168:171], v[76:79], v[128:143]
  ds_read_b64_tr_b16 v[188:189], v6 offset:19456
  v_mfma_f32_32x32x16_bf16 v[144:159], v[172:175], v[76:79], v[144:159]
  ds_read_b64_tr_b16 v[190:191], v6 offset:19968
  s_waitcnt vmcnt(0) lgkmcnt(0)
  v_mfma_f32_32x32x16_bf16 v[96:111], v[176:179], v[80:83], v[96:111]
  ds_read_b64_tr_b16 v[160:161], v6 offset:0
  v_mfma_f32_32x32x16_bf16 v[112:127], v[180:183], v[80:83], v[112:127]
  ds_read_b64_tr_b16 v[162:163], v6 offset:512
  v_mfma_f32_32x32x16_bf16 v[128:143], v[176:179], v[88:91], v[128:143]
  ds_read_b64_tr_b16 v[164:165], v6 offset:1024
  v_mfma_f32_32x32x16_bf16 v[144:159], v[180:183], v[88:91], v[144:159]
  ds_read_b64_tr_b16 v[166:167], v6 offset:1536
  v_mfma_f32_32x32x16_bf16 v[96:111], v[184:187], v[84:87], v[96:111]
  ds_read_b64_tr_b16 v[168:169], v6 offset:2048
  v_mfma_f32_32x32x16_bf16 v[112:127], v[188:191], v[84:87], v[112:127]
  ds_read_b64_tr_b16 v[170:171], v6 offset:2560
  v_mfma_f32_32x32x16_bf16 v[128:143], v[184:187], v[92:95], v[128:143]
  ds_read_b64_tr_b16 v[172:173], v6 offset:3072
  v_mfma_f32_32x32x16_bf16 v[144:159], v[188:191], v[92:95], v[144:159]
  ds_read_b64_tr_b16 v[174:175], v6 offset:3584
  s_waitcnt lgkmcnt(0)
  v_mfma_f32_32x32x16_bf16 v[96:111], v[160:163], v[16:19], v[96:111]
  v_mfma_f32_32x32x16_bf16 v[112:127], v[164:167], v[16:19], v[112:127]
  v_mfma_f32_32x32x16_bf16 v[128:143], v[160:163], v[24:27], v[128:143]
  v_mfma_f32_32x32x16_bf16 v[144:159], v[164:167], v[24:27], v[144:159]
  v_mfma_f32_32x32x16_bf16 v[96:111], v[168:171], v[20:23], v[96:111]
  v_mfma_f32_32x32x16_bf16 v[112:127], v[172:175], v[20:23], v[112:127]
  v_mfma_f32_32x32x16_bf16 v[128:143], v[168:171], v[28:31], v[128:143]
  v_mfma_f32_32x32x16_bf16 v[144:159], v[172:175], v[28:31], v[144:159]
  s_setprio 0
  s_nop 7
  s_nop 7
  s_barrier
  s_lshl_b32 s24, s8, 12
  v_add_u32 v12, s24, v1
  ds_write_b128 v12, v[96:99] offset:0
  ds_write_b128 v12, v[100:103] offset:1024
  ds_write_b128 v12, v[104:107] offset:2048
  ds_write_b128 v12, v[108:111] offset:3072
  ds_write_b128 v12, v[112:115] offset:16384
  ds_write_b128 v12, v[116:119] offset:17408
  ds_write_b128 v12, v[120:123] offset:18432
  ds_write_b128 v12, v[124:127] offset:19456
  ds_write_b128 v12, v[128:131] offset:32768
  ds_write_b128 v12, v[132:135] offset:33792
  ds_write_b128 v12, v[136:139] offset:34816
  ds_write_b128 v12, v[140:143] offset:35840
  ds_write_b128 v12, v[144:147] offset:49152
  ds_write_b128 v12, v[148:151] offset:50176
  ds_write_b128 v12, v[152:155] offset:51200
  ds_write_b128 v12, v[156:159] offset:52224
  s_waitcnt lgkmcnt(0)
  s_barrier
  s_lshl_b32 s24, s8, 14
  v_add_u32 v12, s24, v1
  ds_read_b128 v[96:99], v12 offset:0
  ds_read_b128 v[100:103], v12 offset:1024
  ds_read_b128 v[104:107], v12 offset:2048
  ds_read_b128 v[108:111], v12 offset:3072
  ds_read_b128 v[112:115], v12 offset:4096
  ds_read_b128 v[116:119], v12 offset:5120
  ds_read_b128 v[120:123], v12 offset:6144
  ds_read_b128 v[124:127], v12 offset:7168
  ds_read_b128 v[128:131], v12 offset:8192
  ds_read_b128 v[132:135], v12 offset:9216
  ds_read_b128 v[136:139], v12 offset:10240
  ds_read_b128 v[140:143], v12 offset:11264
  ds_read_b128 v[144:147], v12 offset:12288
  ds_read_b128 v[148:151], v12 offset:13312
  ds_read_b128 v[152:155], v12 offset:14336
  ds_read_b128 v[156:159], v12 offset:15360
  s_waitcnt lgkmcnt(0)
  v_add_f32 v232, v96, v112
  v_add_f32 v128, v128, v144
  v_add_f32 v233, v97, v113
  v_add_f32 v129, v129, v145
  v_add_f32 v234, v98, v114
  v_add_f32 v130, v130, v146
  v_add_f32 v235, v99, v115
  v_add_f32 v131, v131, v147
  v_add_f32 v236, v100, v116
  v_add_f32 v132, v132, v148
  v_add_f32 v237, v101, v117
  v_add_f32 v133, v133, v149
  v_add_f32 v238, v102, v118
  v_add_f32 v134, v134, v150
  v_add_f32 v239, v103, v119
  v_add_f32 v135, v135, v151
  v_add_f32 v240, v104, v120
  v_add_f32 v136, v136, v152
  v_add_f32 v241, v105, v121
  v_add_f32 v137, v137, v153
  v_add_f32 v242, v106, v122
  v_add_f32 v138, v138, v154
  v_add_f32 v243, v107, v123
  v_add_f32 v139, v139, v155
  v_add_f32 v244, v108, v124
  v_add_f32 v140, v140, v156
  v_add_f32 v245, v109, v125
  v_add_f32 v141, v141, v157
  v_add_f32 v246, v110, v126
  v_add_f32 v142, v142, v158
  v_add_f32 v247, v111, v127
  v_add_f32 v143, v143, v159
  v_add_f32 v232, v232, v128
  v_add_f32 v233, v233, v129
  v_add_f32 v234, v234, v130
  v_add_f32 v235, v235, v131
  v_add_f32 v236, v236, v132
  v_add_f32 v237, v237, v133
  v_add_f32 v238, v238, v134
  v_add_f32 v239, v239, v135
  v_add_f32 v240, v240, v136
  v_add_f32 v241, v241, v137
  v_add_f32 v242, v242, v138
  v_add_f32 v243, v243, v139
  v_add_f32 v244, v244, v140
  v_add_f32 v245, v245, v141
  v_add_f32 v246, v246, v142
  v_add_f32 v247, v247, v143
  s_load_dwordx2 s[32:33], s[0:1], 16
  s_load_dwordx2 s[34:35], s[0:1], 64
  s_and_b32 s9, s3, 3
  s_lshl_b32 s9, s9, 3
  s_bfe_u32 s24, s3, 0x30003
  s_add_u32 s9, s9, s24
  s_bfe_u32 s10, s3, 0x10002
  s_lshl_b32 s10, s10, 2
  s_lshr_b32 s24, s3, 6
  s_add_u32 s10, s10, s24
  v_lshlrev_b32 v1, 4, v0
  v_lshrrev_b32 v12, 2, v0
  v_lshlrev_b32 v12, 10, v12
  v_and_b32 v13, 3, v0
  v_lshlrev_b32 v13, 4, v13
  s_lshl_b32 s24, s10, 7
  v_add3_u32 v12, v12, v13, s24
  v_add_u32 v2, 4096, v12
  v_add_u32 v3, 3136, v12
  v_add_u32 v4, 18432, v12
  v_add_u32 v5, 17472, v12
  s_mul_i32 s23, s8, 20480
  v_lshrrev_b32 v12, 5, v0
  v_lshlrev_b32 v12, 2, v12
  v_bfe_u32 v13, v0, 2, 2
  v_add_u32 v12, v12, v13
  v_lshlrev_b32 v12, 6, v12
  v_bfe_u32 v13, v0, 4, 1
  v_lshlrev_b32 v13, 5, v13
  v_and_b32 v14, 3, v0
  v_lshlrev_b32 v14, 3, v14
  v_add3_u32 v12, v12, v13, v14
  v_add_u32 v6, s23, v12
  v_subrev_u32 v6, s23, v6
  s_and_b32 s24, s8, 1
  s_lshl_b32 s24, s24, 10
  v_add_u32 v6, s24, v6
  v_add_u32 v7, 32768, v6
  s_waitcnt lgkmcnt(0)
  s_lshr_b32 s24, s9, 1
  s_mul_i32 s24, s24, 131072
  s_add_u32 s24, s24, 12582912
  s_add_u32 s12, s4, s24
  s_addc_u32 s13, s5, 0
  s_and_b32 s13, s13, 0xffff
  s_mov_b32 s14, 131072
  s_mov_b32 s15, 0x20000
  s_mul_i32 s20, s8, 0
  s_and_b32 s24, s9, 1
  s_lshl_b32 s24, s24, 12
  s_add_u32 s20, s20, s24
  s_sub_u32 s16, s32, 4096
  s_subb_u32 s17, s33, 0
  s_and_b32 s17, s17, 0xffff
  s_mov_b32 s18, 528384
  s_mov_b32 s19, 0x20000
  s_mul_i32 s21, s8, 0
  s_lshl_b32 s21, s8, 17
  s_lshl_b32 s23, s8, 14
  s_barrier
  s_add_u32 m0, s23, 0
  s_nop 0
  buffer_load_dwordx4 v2, s[16:19], s21 offen lds
  buffer_load_dwordx4 v3, s[16:19], s21 offen offset:1024 lds
  buffer_load_dwordx4 v4, s[16:19], s21 offen offset:2048 lds
  buffer_load_dwordx4 v5, s[16:19], s21 offen offset:3072 lds
  s_add_u32 s21, s21, 32768
  s_add_u32 m0, s23, 4096
  s_nop 0
  buffer_load_dwordx4 v2, s[16:19], s21 offen lds
  buffer_load_dwordx4 v3, s[16:19], s21 offen offset:1024 lds
  buffer_load_dwordx4 v4, s[16:19], s21 offen offset:2048 lds
  buffer_load_dwordx4 v5, s[16:19], s21 offen offset:3072 lds
  s_add_u32 s21, s21, 32768
  s_add_u32 m0, s23, 8192
  s_nop 0
  buffer_load_dwordx4 v2, s[16:19], s21 offen lds
  buffer_load_dwordx4 v3, s[16:19], s21 offen offset:1024 lds
  buffer_load_dwordx4 v4, s[16:19], s21 offen offset:2048 lds
  buffer_load_dwordx4 v5, s[16:19], s21 offen offset:3072 lds
  s_add_u32 s21, s21, 32768
  s_add_u32 m0, s23, 12288
  s_nop 0
  buffer_load_dwordx4 v2, s[16:19], s21 offen lds
  buffer_load_dwordx4 v3, s[16:19], s21 offen offset:1024 lds
  buffer_load_dwordx4 v4, s[16:19], s21 offen offset:2048 lds
  buffer_load_dwordx4 v5, s[16:19], s21 offen offset:3072 lds
  s_add_u32 s21, s21, 32768
  v_mov_b32 v208, 0
  v_mov_b32 v209, 0
  v_mov_b32 v210, 0
  v_mov_b32 v211, 0
  v_mov_b32 v212, 0
  v_mov_b32 v213, 0
  v_mov_b32 v214, 0
  v_mov_b32 v215, 0
  v_mov_b32 v216, 0
  v_mov_b32 v217, 0
  v_mov_b32 v218, 0
  v_mov_b32 v219, 0
  v_mov_b32 v220, 0
  v_mov_b32 v221, 0
  v_mov_b32 v222, 0
  v_mov_b32 v223, 0
  s_waitcnt vmcnt(0)
  s_barrier
  ds_read_b64_tr_b16 v[16:17], v6 offset:0
  ds_read_b64_tr_b16 v[18:19], v6 offset:512
  ds_read_b64_tr_b16 v[20:21], v6 offset:2048
  ds_read_b64_tr_b16 v[22:23], v6 offset:2560
  ds_read_b64_tr_b16 v[24:25], v6 offset:4096
  ds_read_b64_tr_b16 v[26:27], v6 offset:4608
  ds_read_b64_tr_b16 v[28:29], v6 offset:6144
  ds_read_b64_tr_b16 v[30:31], v6 offset:6656
  ds_read_b64_tr_b16 v[32:33], v6 offset:8192
  ds_read_b64_tr_b16 v[34:35], v6 offset:8704
  ds_read_b64_tr_b16 v[36:37], v6 offset:10240
  ds_read_b64_tr_b16 v[38:39], v6 offset:10752
  s_waitcnt lgkmcnt(4)
  ds_read_b64_tr_b16 v[40:41], v6 offset:12288
  ds_read_b64_tr_b16 v[42:43], v6 offset:12800
  ds_read_b64_tr_b16 v[44:45], v6 offset:14336
  ds_read_b64_tr_b16 v[46:47], v6 offset:14848
  ds_read_b64_tr_b16 v[48:49], v6 offset:16384
  ds_read_b64_tr_b16 v[50:51], v6 offset:16896
  ds_read_b64_tr_b16 v[52:53], v6 offset:18432
  ds_read_b64_tr_b16 v[54:55], v6 offset:18944
  ds_read_b64_tr_b16 v[56:57], v6 offset:20480
  ds_read_b64_tr_b16 v[58:59], v6 offset:20992
  ds_read_b64_tr_b16 v[60:61], v6 offset:22528
  ds_read_b64_tr_b16 v[62:63], v6 offset:23040
  s_waitcnt lgkmcnt(4)
  ds_read_b64_tr_b16 v[64:65], v6 offset:24576
  ds_read_b64_tr_b16 v[66:67], v6 offset:25088
  ds_read_b64_tr_b16 v[68:69], v6 offset:26624
  ds_read_b64_tr_b16 v[70:71], v6 offset:27136
  ds_read_b64_tr_b16 v[72:73], v6 offset:28672
  ds_read_b64_tr_b16 v[74:75], v6 offset:29184
  ds_read_b64_tr_b16 v[76:77], v6 offset:30720
  ds_read_b64_tr_b16 v[78:79], v6 offset:31232
  ds_read_b64_tr_b16 v[80:81], v7 offset:0
  ds_read_b64_tr_b16 v[82:83], v7 offset:512
  ds_read_b64_tr_b16 v[84:85], v7 offset:2048
  ds_read_b64_tr_b16 v[86:87], v7 offset:2560
  s_waitcnt lgkmcnt(4)
  ds_read_b64_tr_b16 v[88:89], v7 offset:4096
  ds_read_b64_tr_b16 v[90:91], v7 offset:4608
  ds_read_b64_tr_b16 v[92:93], v7 offset:6144
  ds_read_b64_tr_b16 v[94:95], v7 offset:6656
  ds_read_b64_tr_b16 v[96:97], v7 offset:8192
  ds_read_b64_tr_b16 v[98:99], v7 offset:8704
  ds_read_b64_tr_b16 v[100:101], v7 offset:10240
  ds_read_b64_tr_b16 v[102:103], v7 offset:10752
  ds_read_b64_tr_b16 v[104:105], v7 offset:12288
  ds_read_b64_tr_b16 v[106:107], v7 offset:12800
  ds_read_b64_tr_b16 v[108:109], v7 offset:14336
  ds_read_b64_tr_b16 v[110:111], v7 offset:14848
  s_waitcnt lgkmcnt(4)
  ds_read_b64_tr_b16 v[112:113], v7 offset:16384
  ds_read_b64_tr_b16 v[114:115], v7 offset:16896
  ds_read_b64_tr_b16 v[116:117], v7 offset:18432
  ds_read_b64_tr_b16 v[118:119], v7 offset:18944
  ds_read_b64_tr_b16 v[120:121], v7 offset:20480
  ds_read_b64_tr_b16 v[122:123], v7 offset:20992
  ds_read_b64_tr_b16 v[124:125], v7 offset:22528
  ds_read_b64_tr_b16 v[126:127], v7 offset:23040
  ds_read_b64_tr_b16 v[128:129], v7 offset:24576
  ds_read_b64_tr_b16 v[130:131], v7 offset:25088
  ds_read_b64_tr_b16 v[132:133], v7 offset:26624
  ds_read_b64_tr_b16 v[134:135], v7 offset:27136
  s_waitcnt lgkmcnt(4)
  ds_read_b64_tr_b16 v[136:137], v7 offset:28672
  ds_read_b64_tr_b16 v[138:139], v7 offset:29184
  ds_read_b64_tr_b16 v[140:141], v7 offset:30720
  ds_read_b64_tr_b16 v[142:143], v7 offset:31232
  s_waitcnt lgkmcnt(0)
  s_lshl_b32 s24, s8, 13
  s_add_u32 s20, s20, s24
  s_lshl_b32 s23, s8, 12
  s_lshr_b32 s24, s8, 1
  s_lshl_b32 s24, s24, 11
  v_add_u32 v2, s24, v1
  v_add_u32 v3, 32768, v2
  s_lshr_b32 s50, s9, 1
  s_lshl_b32 s50, s50, 2
  s_and_b32 s51, s10, 3
  s_add_u32 s50, s50, s51
  s_cmp_lg_u32 s8, 0
  s_cbranch_scc1 wf_9_done
  v_mov_b32 v12, s50
  v_lshlrev_b32 v12, 8, v12
  v_add_u32 v12, 18989056, v12
  s_mov_b32 s25, 200000
  s_mov_b64 exec, 1
  global_load_dword v13, v12, s[4:5] sc1
wf_9_poll:
  s_sleep 3
  global_load_dword v14, v12, s[4:5] sc1
  s_waitcnt vmcnt(1)
  v_readfirstlane_b32 s24, v13
  s_cmp_ge_u32 s24, 32
  s_cbranch_scc1 wf_9_out
  s_sleep 3
  global_load_dword v13, v12, s[4:5] sc1
  s_waitcnt vmcnt(1)
  v_readfirstlane_b32 s24, v14
  s_cmp_ge_u32 s24, 32
  s_cbranch_scc1 wf_9_out
  s_sub_u32 s25, s25, 1
  s_cmp_lg_u32 s25, 0
  s_cbranch_scc1 wf_9_poll
wf_9_out:
  s_waitcnt vmcnt(0)
  s_mov_b64 exec, -1
wf_9_done:
  s_barrier
  s_lshl_b32 s24, s9, 6
  s_lshr_b32 s25, s8, 1
  s_lshl_b32 s25, s25, 5
  s_add_u32 s24, s24, s25
  s_lshl_b32 s24, s24, 6
  s_add_u32 s24, s24, 19136512
  v_bfe_u32 v12, v0, 1, 4
  v_lshlrev_b32 v12, 7, v12
  v_and_b32 v8, 1, v0
  v_lshlrev_b32 v8, 2, v8
  v_add3_u32 v12, v12, v8, s24
  global_load_dword v8, v12, s[4:5] sc1
  s_add_u32 m0, s23, 0
  s_nop 0
  buffer_load_dwordx4 v1, s[12:15], s20 offen sc1 lds
  buffer_load_dwordx4 v1, s[12:15], s20 offen offset:1024 sc1 lds
  buffer_load_dwordx4 v1, s[12:15], s20 offen offset:2048 sc1 lds
  buffer_load_dwordx4 v1, s[12:15], s20 offen offset:3072 sc1 lds
  s_add_u32 s20, s20, 32768
  s_add_u32 m0, s23, 16384
  s_nop 0
  buffer_load_dwordx4 v1, s[12:15], s20 offen sc1 lds
  buffer_load_dwordx4 v1, s[12:15], s20 offen offset:1024 sc1 lds
  buffer_load_dwordx4 v1, s[12:15], s20 offen offset:2048 sc1 lds
  buffer_load_dwordx4 v1, s[12:15], s20 offen offset:3072 sc1 lds
  s_add_u32 s20, s20, 32768
  s_add_u32 m0, s23, 32768
  s_nop 0
  buffer_load_dwordx4 v1, s[12:15], s20 offen sc1 lds
  buffer_load_dwordx4 v1, s[12:15], s20 offen offset:1024 sc1 lds
  buffer_load_dwordx4 v1, s[12:15], s20 offen offset:2048 sc1 lds
  buffer_load_dwordx4 v1, s[12:15], s20 offen offset:3072 sc1 lds
  s_add_u32 s20, s20, 32768
  s_add_u32 m0, s23, 49152
  s_nop 0
  buffer_load_dwordx4 v1, s[12:15], s20 offen sc1 lds
  buffer_load_dwordx4 v1, s[12:15], s20 offen offset:1024 sc1 lds
  buffer_load_dwordx4 v1, s[12:15], s20 offen offset:2048 sc1 lds
  buffer_load_dwordx4 v1, s[12:15], s20 offen offset:3072 sc1 lds
  s_add_u32 s20, s20, 32768
  s_waitcnt vmcnt(12)
  s_barrier
  ds_read_b128 v[144:147], v2 offset:0
  ds_read_b128 v[148:151], v2 offset:1024
  ds_read_b128 v[152:155], v2 offset:4096
  ds_read_b128 v[156:159], v2 offset:5120
  ds_read_b128 v[160:163], v2 offset:8192
  ds_read_b128 v[164:167], v2 offset:9216
  ds_read_b128 v[168:171], v2 offset:12288
  ds_read_b128 v[172:175], v2 offset:13312
  s_waitcnt vmcnt(8)
  s_barrier
  ds_read_b128 v[176:179], v2 offset:16384
  ds_read_b128 v[180:183], v2 offset:17408
  ds_read_b128 v[184:187], v2 offset:20480
  ds_read_b128 v[188:191], v2 offset:21504
  ds_read_b128 v[192:195], v2 offset:24576
  ds_read_b128 v[196:199], v2 offset:25600
  ds_read_b128 v[200:203], v2 offset:28672
  ds_read_b128 v[204:207], v2 offset:29696
  s_waitcnt lgkmcnt(8)
  v_mfma_f32_32x32x16_bf16 v[208:223], v[16:19], v[144:147], v[208:223]
  v_mfma_f32_32x32x16_bf16 v[208:223], v[20:23], v[148:151], v[208:223]
  v_mfma_f32_32x32x16_bf16 v[208:223], v[24:27], v[152:155], v[208:223]
  v_mfma_f32_32x32x16_bf16 v[208:223], v[28:31], v[156:159], v[208:223]
  v_mfma_f32_32x32x16_bf16 v[208:223], v[32:35], v[160:163], v[208:223]
  v_mfma_f32_32x32x16_bf16 v[208:223], v[36:39], v[164:167], v[208:223]
  v_mfma_f32_32x32x16_bf16 v[208:223], v[40:43], v[168:171], v[208:223]
  v_mfma_f32_32x32x16_bf16 v[208:223], v[44:47], v[172:175], v[208:223]
  s_waitcnt vmcnt(4)
  s_barrier
  ds_read_b128 v[144:147], v3 offset:0
  ds_read_b128 v[148:151], v3 offset:1024
  ds_read_b128 v[152:155], v3 offset:4096
  ds_read_b128 v[156:159], v3 offset:5120
  ds_read_b128 v[160:163], v3 offset:8192
  ds_read_b128 v[164:167], v3 offset:9216
  ds_read_b128 v[168:171], v3 offset:12288
  ds_read_b128 v[172:175], v3 offset:13312
  s_waitcnt lgkmcnt(8)
  v_mfma_f32_32x32x16_bf16 v[208:223], v[48:51], v[176:179], v[208:223]
  v_mfma_f32_32x32x16_bf16 v[208:223], v[52:55], v[180:183], v[208:223]
  v_mfma_f32_32x32x16_bf16 v[208:223], v[56:59], v[184:187], v[208:223]
  v_mfma_f32_32x32x16_bf16 v[208:223], v[60:63], v[188:191], v[208:223]
  v_mfma_f32_32x32x16_bf16 v[208:223], v[64:67], v[192:195], v[208:223]
  v_mfma_f32_32x32x16_bf16 v[208:223], v[68:71], v[196:199], v[208:223]
  v_mfma_f32_32x32x16_bf16 v[208:223], v[72:75], v[200:203], v[208:223]
  v_mfma_f32_32x32x16_bf16 v[208:223], v[76:79], v[204:207], v[208:223]
  s_waitcnt vmcnt(0)
  s_barrier
  ds_read_b128 v[176:179], v3 offset:16384
  ds_read_b128 v[180:183], v3 offset:17408
  ds_read_b128 v[184:187], v3 offset:20480
  ds_read_b128 v[188:191], v3 offset:21504
  ds_read_b128 v[192:195], v3 offset:24576
  ds_read_b128 v[196:199], v3 offset:25600
  ds_read_b128 v[200:203], v3 offset:28672
  ds_read_b128 v[204:207], v3 offset:29696
  s_waitcnt lgkmcnt(8)
  v_mfma_f32_32x32x16_bf16 v[208:223], v[80:83], v[144:147], v[208:223]
  v_mfma_f32_32x32x16_bf16 v[208:223], v[84:87], v[148:151], v[208:223]
  v_mfma_f32_32x32x16_bf16 v[208:223], v[88:91], v[152:155], v[208:223]
  v_mfma_f32_32x32x16_bf16 v[208:223], v[92:95], v[156:159], v[208:223]
  v_mfma_f32_32x32x16_bf16 v[208:223], v[96:99], v[160:163], v[208:223]
  v_mfma_f32_32x32x16_bf16 v[208:223], v[100:103], v[164:167], v[208:223]
  v_mfma_f32_32x32x16_bf16 v[208:223], v[104:107], v[168:171], v[208:223]
  v_mfma_f32_32x32x16_bf16 v[208:223], v[108:111], v[172:175], v[208:223]
  s_waitcnt lgkmcnt(0)
  v_mfma_f32_32x32x16_bf16 v[208:223], v[112:115], v[176:179], v[208:223]
  v_mfma_f32_32x32x16_bf16 v[208:223], v[116:119], v[180:183], v[208:223]
  v_mfma_f32_32x32x16_bf16 v[208:223], v[120:123], v[184:187], v[208:223]
  v_mfma_f32_32x32x16_bf16 v[208:223], v[124:127], v[188:191], v[208:223]
  v_mfma_f32_32x32x16_bf16 v[208:223], v[128:131], v[192:195], v[208:223]
  v_mfma_f32_32x32x16_bf16 v[208:223], v[132:135], v[196:199], v[208:223]
  v_mfma_f32_32x32x16_bf16 v[208:223], v[136:139], v[200:203], v[208:223]
  v_mfma_f32_32x32x16_bf16 v[208:223], v[140:143], v[204:207], v[208:223]
  s_lshl_b32 s24, s9, 6
  s_lshr_b32 s25, s8, 1
  s_lshl_b32 s25, s25, 5
  s_add_u32 s24, s24, s25
  s_lshl_b32 s24, s24, 10
  s_lshl_b32 s25, s10, 7
  s_add_u32 s24, s24, s25
  s_and_b32 s25, s8, 1
  s_lshl_b32 s25, s25, 6
  s_add_u32 s24, s24, s25
  v_and_b32 v12, 31, v0
  v_lshlrev_b32 v12, 10, v12
  v_lshrrev_b32 v13, 5, v0
  v_lshlrev_b32 v13, 4, v13
  v_add3_u32 v12, v12, v13, s24
  s_nop 7
  v_sub_f32 v208, v208, v232
  v_sub_f32 v209, v209, v233
  v_sub_f32 v210, v210, v234
  v_sub_f32 v211, v211, v235
  v_sub_f32 v212, v212, v236
  v_sub_f32 v213, v213, v237
  v_sub_f32 v214, v214, v238
  v_sub_f32 v215, v215, v239
  v_sub_f32 v216, v216, v240
  v_sub_f32 v217, v217, v241
  v_sub_f32 v218, v218, v242
  v_sub_f32 v219, v219, v243
  v_sub_f32 v220, v220, v244
  v_sub_f32 v221, v221, v245
  v_sub_f32 v222, v222, v246
  v_sub_f32 v223, v223, v247
  v_fma_f32 v208, v208, v8, v232
  v_fma_f32 v209, v209, v8, v233
  v_fma_f32 v210, v210, v8, v234
  v_fma_f32 v211, v211, v8, v235
  v_fma_f32 v212, v212, v8, v236
  v_fma_f32 v213, v213, v8, v237
  v_fma_f32 v214, v214, v8, v238
  v_fma_f32 v215, v215, v8, v239
  v_fma_f32 v216, v216, v8, v240
  v_fma_f32 v217, v217, v8, v241
  v_fma_f32 v218, v218, v8, v242
  v_fma_f32 v219, v219, v8, v243
  v_fma_f32 v220, v220, v8, v244
  v_fma_f32 v221, v221, v8, v245
  v_fma_f32 v222, v222, v8, v246
  v_fma_f32 v223, v223, v8, v247
  v_cvt_pk_bf16_f32 v144, v208, v209
  v_cvt_pk_bf16_f32 v145, v210, v211
  v_cvt_pk_bf16_f32 v146, v212, v213
  v_cvt_pk_bf16_f32 v147, v214, v215
  s_nop 1
  v_permlane32_swap_b32 v144, v146
  v_permlane32_swap_b32 v145, v147
  global_store_dwordx4 v12, v[144:147], s[34:35]
  v_cvt_pk_bf16_f32 v148, v216, v217
  v_cvt_pk_bf16_f32 v149, v218, v219
  v_cvt_pk_bf16_f32 v150, v220, v221
  v_cvt_pk_bf16_f32 v151, v222, v223
  s_nop 1
  v_permlane32_swap_b32 v148, v150
  v_permlane32_swap_b32 v149, v151
  global_store_dwordx4 v12, v[148:151], s[34:35] offset:32
k_done:
  s_endpgm
k_code_end:
.section .rodata,"a"
.p2align 6
.amdhsa_kernel gated_mix__mha_block__glu_gated_geglu__prompt_kernel
  .amdhsa_next_free_vgpr 256
  .amdhsa_next_free_sgpr 102
  .amdhsa_accum_offset 256
  .amdhsa_group_segment_fixed_size 0
  .amdhsa_kernarg_size 88
  .amdhsa_user_sgpr_count 2
  .amdhsa_user_sgpr_kernarg_segment_ptr 1
  .amdhsa_system_sgpr_workgroup_id_x 1
  .amdhsa_float_denorm_mode_32 3
.end_amdhsa_kernel
```
